```python
import torch

def _softmax(x, axis=-1):
    return torch.softmax(x, dim=axis)

def _gelu(x):
    return torch.nn.functional.gelu(x, approximate='tanh')

def _silu(x):
    return torch.nn.functional.silu(x)

def _sigmoid(x):
    return torch.sigmoid(x)

def _layernorm(x, axis=-1, eps=1e-05):
    m = x.mean(dim=axis, keepdim=True)
    v = x.var(dim=axis, keepdim=True, unbiased=False)
    return (x - m) / torch.sqrt(v + eps)

def _scatter_add(tgt, idx, src, axis=0):
    return tgt.clone().index_add_(axis, idx, src)

def _segment_sum(src, seg, n):
    out = torch.zeros((n,) + src.shape[1:], dtype=src.dtype)
    return out.index_add_(0, seg, src)

def _pad(x, pw):
    flat = tuple((v for pair in reversed(pw) for v in pair))
    return torch.nn.functional.pad(x, flat)
kernel_name = 'interleave_layers__memory_aug_recurrent_mem_tr__spectral_gfnet__prompt'

def setup_inputs():

    _w = lambda a: (lambda t: t.to(torch.bfloat16) if t.is_floating_point() else t)(torch.as_tensor(a))

    def _A_setup():
        B, S, Dm = (1, 2048, 512)
        H, Dh = (32, 128)
        M, seg = (8, 32)
        seg = min(seg, S)
        S = S // seg * seg
        return {'x': _w((lambda *s: torch.randn(*s, dtype=torch.bfloat16) * 0.05)(B, S, Dm)), 'mem0': _w((lambda *s: torch.randn(*s, dtype=torch.bfloat16) * 0.2)(B, M, Dm)), 'Wq': _w((lambda *s: torch.randn(*s, dtype=torch.bfloat16) * 1.6)(Dm, H, Dh) * Dm ** (-0.5)), 'Wk': _w((lambda *s: torch.randn(*s, dtype=torch.bfloat16) * 1.6)(Dm, H, Dh) * Dm ** (-0.5)), 'Wv': _w((lambda *s: torch.randn(*s, dtype=torch.bfloat16) * 0.2)(Dm, H, Dh) * Dm ** (-0.5)), 'Wo': _w((lambda *s: torch.randn(*s, dtype=torch.bfloat16) * 0.2)(H, Dh, Dm) * (H * Dh) ** (-0.5)), 'seg_len': seg}
    _A_in = _A_setup()

    def _B_setup():
        B, S, D = (1, 2048, 512)
        Df = D // 2 + 1
        return {'x': _w((lambda *s: torch.randn(*s, dtype=torch.bfloat16) * 0.05)(B, S, D)), 'w_r': _w((lambda *s: torch.randn(*s, dtype=torch.bfloat16) * 0.4)(S, Df) * 0.02), 'w_i': _w((lambda *s: torch.randn(*s, dtype=torch.bfloat16) * 0.4)(S, Df) * 0.02)}
    _B_in = _B_setup()
    return {'A_x': _A_in['x'], 'A_mem0': _A_in['mem0'], 'A_Wq': _A_in['Wq'], 'A_Wk': _A_in['Wk'], 'A_Wv': _A_in['Wv'], 'A_Wo': _A_in['Wo'], 'A_seg_len': _A_in['seg_len'], 'B_x': _B_in['x'], 'B_w_r': _B_in['w_r'], 'B_w_i': _B_in['w_i']}

def reference(A_x, A_mem0, A_Wq, A_Wk, A_Wv, A_Wo, A_seg_len, B_x, B_w_r, B_w_i):

    def _A_ref(x, mem0, Wq, Wk, Wv, Wo, seg_len):
        B, S, Dm = x.shape
        H, Dh = (Wq.shape[1], Wq.shape[2])
        M = mem0.shape[1]
        scale = Dh ** (-0.5)
        n_seg = S // seg_len
        L = M + seg_len
        idx = torch.arange(L)
        mask = (idx[:, None] < M) | (idx[:, None] >= idx[None, :])
        mem = mem0
        outs = []
        for s in range(n_seg):
            xs = x[:, s * seg_len:(s + 1) * seg_len, :].clone()
            h = torch.concatenate([mem, xs], axis=1)
            q = torch.einsum('btd,dhe->bhte', h, Wq)
            k = torch.einsum('btd,dhe->bhte', h, Wk)
            v = torch.einsum('btd,dhe->bhte', h, Wv)
            scores = torch.einsum('bhqe,bhke->bhqk', q, k) * scale
            scores = torch.where(mask[None, None], scores, -1000000000.0)
            p = _softmax(scores, axis=-1)
            o = torch.einsum('bhqk,bhke->bhqe', p, v)
            o = torch.einsum('bhte,hed->btd', o, Wo)
            mem = o[:, :M, :].clone()
            outs.append(o[:, M:, :])
        return torch.concatenate(outs, axis=1)

    def _B_ref(x, w_r, w_i):
        B, S, D = x.shape
        X = (lambda x, axes=(-2, -1): torch.fft.rfft2(x.float(), dim=axes))(x, axes=(-2, -1))
        W = w_r + 1j * w_i
        X = X * W
        y = (lambda x, s, axes=(-2, -1): torch.fft.irfft2(x, s=s, dim=axes).to(torch.bfloat16))(X, (S, D), axes=(-2, -1))
        return y
    x = A_x
    x = x + _A_ref(_layernorm(x, axis=-1), A_mem0, A_Wq, A_Wk, A_Wv, A_Wo, A_seg_len)
    x = x + _B_ref(_layernorm(x, axis=-1), B_w_r, B_w_i)
    x = x + _A_ref(_layernorm(x, axis=-1), A_mem0, A_Wq, A_Wk, A_Wv, A_Wo, A_seg_len)
    x = x + _B_ref(_layernorm(x, axis=-1), B_w_r, B_w_i)
    return x
```

```asm
; @launch grid=(256,1,1) block=(256,1,1) lds=163840
.amdgcn_target "amdgcn-amd-amdhsa--gfx950"
.text
.globl interleave_layers__memory_aug_recurrent_mem_tr__spectral_gfnet__prompt_kernel
.p2align 8
.type interleave_layers__memory_aug_recurrent_mem_tr__spectral_gfnet__prompt_kernel,@function
interleave_layers__memory_aug_recurrent_mem_tr__spectral_gfnet__prompt_kernel:
  s_getpc_b64 s[12:13]
L_pc:
  s_lshr_b32 s3, s2, 3
  s_and_b32 s3, s3, 31
  s_lshl_b32 s3, s3, 12
  v_and_b32 v1, 63, v0
  v_lshlrev_b32 v1, 6, v1
  v_add_u32 v1, s3, v1
  v_min_u32 v1, L_end - L_pc, v1
  global_load_dword v127, v1, s[12:13]
  s_cmp_ge_u32 s2, 256
  s_cbranch_scc1 L_end
  s_load_dwordx2 s[8:9], s[0:1], 96
  s_load_dwordx2 s[96:97], s[0:1], 88
  s_getreg_b32 s98, hwreg(HW_REG_XCC_ID)
  s_and_b32 s98, s98, 7
  v_lshrrev_b32 v1, 6, v0
  s_nop 0
  v_readfirstlane_b32 s4, v1
  s_mov_b32 s39, 0
  s_waitcnt lgkmcnt(0)
  s_mov_b32 s10, 0x10000000
  s_mov_b32 s11, 0x20000
  s_cmp_eq_u32 s4, 0
  s_cbranch_scc0 L_r1
  v_mov_b32 v4, 0
  v_mov_b32 v5, 0
  v_mov_b32 v6, 0
  v_mov_b32 v7, 0
  s_lshl_b32 s3, s2, 9
  s_add_u32 s3, s3, 270336
  v_lshlrev_b32 v2, 4, v0
  s_mov_b64 exec, 0xffffffff
  buffer_store_dwordx4 v[4:7], v2, s[8:11], s3 offen sc1
  s_mov_b64 exec, 1
  s_lshr_b32 s3, s98, 1
  s_lshl_b32 s3, s3, 6
  s_and_b32 s6, s98, 1
  s_lshl_b32 s6, s6, 2
  s_add_u32 s82, s3, s6
  v_mov_b32 v2, s82
  v_mov_b32 v3, 1
  global_atomic_add v4, v2, v3, s[96:97] sc0
  s_waitcnt vmcnt(0)
  v_readfirstlane_b32 s5, v4
  s_nop 3
  s_cmp_lt_u32 s5, 32
  s_cbranch_scc1 L_r0
  s_mov_b64 exec, -1
  v_lshlrev_b32 v2, 2, v0
L_ov:
  global_load_dword v4, v2, s[96:97] sc1
  s_waitcnt vmcnt(0)
  s_mov_b32 s3, 0
  v_readlane_b32 s64, v4, 0
  s_nop 3
  s_add_u32 s3, s3, s64
  v_readlane_b32 s65, v4, 1
  s_nop 3
  s_add_u32 s3, s3, s65
  v_readlane_b32 s66, v4, 16
  s_nop 3
  s_add_u32 s3, s3, s66
  v_readlane_b32 s67, v4, 17
  s_nop 3
  s_add_u32 s3, s3, s67
  v_readlane_b32 s68, v4, 32
  s_nop 3
  s_add_u32 s3, s3, s68
  v_readlane_b32 s69, v4, 33
  s_nop 3
  s_add_u32 s3, s3, s69
  v_readlane_b32 s70, v4, 48
  s_nop 3
  s_add_u32 s3, s3, s70
  v_readlane_b32 s71, v4, 49
  s_nop 3
  s_add_u32 s3, s3, s71
  s_add_u32 s39, s39, 1
  s_cmp_gt_u32 s39, 0x10000
  s_cbranch_scc1 L_abort
  s_cmp_lt_u32 s3, 256
  s_cbranch_scc1 L_ov
  s_mov_b64 exec, 1
  v_mov_b32 v2, 16
  global_atomic_add v4, v2, v3, s[96:97] sc0
  s_waitcnt vmcnt(0)
  v_readfirstlane_b32 s3, v4
  s_min_u32 s6, s64, 32
  s_nop 2
  s_add_u32 s5, s6, s3
  s_mov_b32 s98, 0
  s_cmp_lt_u32 s5, 32
  s_cbranch_scc1 L_r0
  s_sub_u32 s3, s5, 32
  s_min_u32 s6, s65, 32
  s_add_u32 s5, s6, s3
  s_mov_b32 s98, 1
  s_cmp_lt_u32 s5, 32
  s_cbranch_scc1 L_r0
  s_sub_u32 s3, s5, 32
  s_min_u32 s6, s66, 32
  s_add_u32 s5, s6, s3
  s_mov_b32 s98, 2
  s_cmp_lt_u32 s5, 32
  s_cbranch_scc1 L_r0
  s_sub_u32 s3, s5, 32
  s_min_u32 s6, s67, 32
  s_add_u32 s5, s6, s3
  s_mov_b32 s98, 3
  s_cmp_lt_u32 s5, 32
  s_cbranch_scc1 L_r0
  s_sub_u32 s3, s5, 32
  s_min_u32 s6, s68, 32
  s_add_u32 s5, s6, s3
  s_mov_b32 s98, 4
  s_cmp_lt_u32 s5, 32
  s_cbranch_scc1 L_r0
  s_sub_u32 s3, s5, 32
  s_min_u32 s6, s69, 32
  s_add_u32 s5, s6, s3
  s_mov_b32 s98, 5
  s_cmp_lt_u32 s5, 32
  s_cbranch_scc1 L_r0
  s_sub_u32 s3, s5, 32
  s_min_u32 s6, s70, 32
  s_add_u32 s5, s6, s3
  s_mov_b32 s98, 6
  s_cmp_lt_u32 s5, 32
  s_cbranch_scc1 L_r0
  s_sub_u32 s3, s5, 32
  s_min_u32 s6, s71, 32
  s_add_u32 s5, s6, s3
  s_mov_b32 s98, 7
  s_cmp_lt_u32 s5, 32
  s_cbranch_scc1 L_r0
  s_sub_u32 s3, s5, 32
  s_branch L_abort
L_r0:
  s_mov_b64 exec, 1
  s_lshl_b32 s3, s98, 8
  s_or_b32 s3, s3, s5
  v_mov_b32 v4, s3
  v_mov_b32 v2, 28672
  ds_write_b32 v2, v4
  s_waitcnt lgkmcnt(0)
  s_mov_b64 exec, -1
L_r1:
  s_barrier
  v_mov_b32 v2, 28672
  ds_read_b32 v4, v2
  s_waitcnt lgkmcnt(0)
  v_readfirstlane_b32 s3, v4
  s_nop 3
  s_and_b32 s5, s3, 31
  s_lshr_b32 s98, s3, 8
  s_and_b32 s98, s98, 7
  s_barrier
  s_cmp_eq_u32 s98, 0
  s_cbranch_scc0 L_worker
  s_cmp_eq_u32 s4, 0
  s_cbranch_scc0 L_ar_1
  s_add_u32 s3, s82, 8
  v_mov_b32 v116, s3
  v_mov_b32 v117, 1
  s_mov_b64 exec, 1
  global_atomic_add v116, v117, s[96:97]
  s_mov_b64 exec, -1
L_ar_1:
  v_and_b32 v116, 63, v0
  v_lshlrev_b32 v3, 4, v116
  s_lshr_b32 s27, s4, 1
  s_lshl_b32 s27, s27, 3
  s_and_b32 s28, s4, 1
  s_lshl_b32 s28, s28, 2
  s_or_b32 s27, s27, s28
  v_and_b32 v117, 15, v116
  v_xor_b32 v117, s27, v117
  v_bfe_u32 v118, v116, 5, 1
  v_lshlrev_b32 v118, 1, v118
  v_xor_b32 v119, v117, v118
  v_bfe_u32 v118, v116, 4, 1
  v_lshlrev_b32 v118, 1, v118
  v_xor_b32 v120, v117, v118
  v_lshrrev_b32 v118, 4, v116
  v_lshlrev_b32 v119, 4, v119
  v_lshl_add_u32 v119, v118, 13, v119
  s_lshl_b32 s27, s5, 8
  s_lshl_b32 s28, s4, 17
  s_add_u32 s27, s27, s28
  v_add_u32 v119, s27, v119
  v_lshlrev_b32 v120, 4, v120
  v_lshl_add_u32 v120, v118, 10, v120
  s_and_b32 s27, s4, 1
  s_lshl_b32 s27, s27, 15
  s_lshr_b32 s28, s4, 1
  s_lshl_b32 s28, s28, 14
  s_add_u32 s27, s27, s28
  s_lshl_b32 s28, s5, 17
  s_add_u32 s27, s27, s28
  v_add_u32 v120, s27, v120
  s_lshl_b32 s29, s4, 2
  v_bfe_u32 v117, v116, 3, 1
  v_lshlrev_b32 v122, 13, v117
  v_bfe_u32 v117, v116, 2, 1
  v_lshl_add_u32 v122, v117, 12, v122
  v_bfe_u32 v117, v116, 5, 1
  v_lshl_add_u32 v122, v117, 10, v122
  v_bfe_u32 v117, v116, 4, 1
  v_lshl_add_u32 v122, v117, 9, v122
  v_and_b32 v118, 3, v116
  v_or_b32 v118, s29, v118
  v_bfe_u32 v117, v116, 3, 1
  v_lshlrev_b32 v117, 3, v117
  v_xor_b32 v118, v118, v117
  v_bfe_u32 v117, v116, 2, 1
  v_lshlrev_b32 v117, 2, v117
  v_xor_b32 v118, v118, v117
  v_bfe_u32 v117, v116, 4, 1
  v_lshlrev_b32 v117, 1, v117
  v_xor_b32 v118, v118, v117
  v_lshl_add_u32 v122, v118, 4, v122
  v_add_u32 v122, 32768, v122
  v_bfe_u32 v117, v116, 3, 1
  v_lshlrev_b32 v124, 13, v117
  v_bfe_u32 v117, v116, 2, 1
  v_lshl_add_u32 v124, v117, 12, v124
  v_bfe_u32 v117, v116, 5, 1
  v_lshl_add_u32 v124, v117, 10, v124
  v_bfe_u32 v117, v116, 4, 1
  v_lshl_add_u32 v124, v117, 9, v124
  v_bfe_u32 v118, v116, 1, 1
  v_or_b32 v118, s29, v118
  v_bfe_u32 v117, v116, 3, 1
  v_lshlrev_b32 v117, 3, v117
  v_xor_b32 v118, v118, v117
  v_bfe_u32 v117, v116, 2, 1
  v_lshlrev_b32 v117, 2, v117
  v_xor_b32 v118, v118, v117
  v_bfe_u32 v117, v116, 4, 1
  v_lshlrev_b32 v117, 1, v117
  v_xor_b32 v118, v118, v117
  v_lshl_add_u32 v124, v118, 4, v124
  v_bfe_u32 v117, v116, 0, 1
  v_lshl_add_u32 v124, v117, 3, v124
  v_add_u32 v124, 32768, v124
  s_mov_b32 s29, 0
  v_bfe_u32 v117, v116, 3, 1
  v_lshlrev_b32 v126, 13, v117
  v_bfe_u32 v117, v116, 4, 1
  v_lshl_add_u32 v126, v117, 12, v126
  v_bfe_u32 v117, v116, 5, 1
  v_lshl_add_u32 v126, v117, 10, v126
  v_bfe_u32 v117, v116, 2, 1
  v_lshl_add_u32 v126, v117, 8, v126
  v_bfe_u32 v118, v116, 1, 1
  v_or_b32 v118, s29, v118
  v_bfe_u32 v117, v116, 3, 1
  v_lshlrev_b32 v117, 3, v117
  v_xor_b32 v118, v118, v117
  v_bfe_u32 v117, v116, 4, 1
  v_lshlrev_b32 v117, 2, v117
  v_xor_b32 v118, v118, v117
  v_bfe_u32 v117, v116, 2, 1
  v_lshlrev_b32 v117, 1, v117
  v_xor_b32 v118, v118, v117
  v_lshl_add_u32 v126, v118, 4, v126
  v_bfe_u32 v117, v116, 0, 1
  v_lshl_add_u32 v126, v117, 3, v126
  v_add_u32 v126, 32768, v126
  s_lshl_b32 s29, s4, 2
  v_xor_b32 v125, 32, v124
  v_lshrrev_b32 v121, 2, v116
  v_lshlrev_b32 v121, 8, v121
  v_and_b32 v118, 3, v116
  v_or_b32 v118, s29, v118
  v_bfe_u32 v117, v116, 3, 1
  v_lshlrev_b32 v117, 1, v117
  v_xor_b32 v118, v118, v117
  v_lshl_add_u32 v121, v118, 4, v121
  v_add_u32 v121, 32768, v121
  s_mov_b32 s80, 0x05040100
  s_mov_b32 s81, 0x07060302
  s_load_dwordx2 s[64:65], s[0:1], 16
  s_load_dwordx2 s[68:69], s[0:1], 24
  s_load_dwordx2 s[72:73], s[0:1], 32
  s_load_dwordx2 s[76:77], s[0:1], 40
  s_lshl_b32 s38, s4, 12
  s_add_u32 s38, s38, 32768
  s_waitcnt lgkmcnt(0)
  s_mov_b32 s66, 0x400000
  s_mov_b32 s67, 0x20000
  s_mov_b32 s70, 0x400000
  s_mov_b32 s71, 0x20000
  s_mov_b32 s74, 0x400000
  s_mov_b32 s75, 0x20000
  s_mov_b32 s78, 0x400000
  s_mov_b32 s79, 0x20000
  s_add_u32 m0, s38, 0
  s_mov_b32 s28, 0
  buffer_load_dwordx4 v119, s[64:67], s28 offen nt lds
  s_add_u32 m0, s38, 1024
  s_mov_b32 s28, 32768
  buffer_load_dwordx4 v119, s[64:67], s28 offen nt lds
  s_add_u32 m0, s38, 2048
  s_mov_b32 s28, 65536
  buffer_load_dwordx4 v119, s[64:67], s28 offen nt lds
  s_add_u32 m0, s38, 3072
  s_mov_b32 s28, 98304
  buffer_load_dwordx4 v119, s[64:67], s28 offen nt lds
  s_add_u32 m0, s38, 16384
  s_mov_b32 s28, 524288
  buffer_load_dwordx4 v119, s[64:67], s28 offen nt lds
  s_add_u32 m0, s38, 17408
  s_mov_b32 s28, 557056
  buffer_load_dwordx4 v119, s[64:67], s28 offen nt lds
  s_add_u32 m0, s38, 18432
  s_mov_b32 s28, 589824
  buffer_load_dwordx4 v119, s[64:67], s28 offen nt lds
  s_add_u32 m0, s38, 19456
  s_mov_b32 s28, 622592
  buffer_load_dwordx4 v119, s[64:67], s28 offen nt lds
  s_add_u32 m0, s38, 32768
  s_mov_b32 s28, 1048576
  buffer_load_dwordx4 v119, s[64:67], s28 offen nt lds
  s_add_u32 m0, s38, 33792
  s_mov_b32 s28, 1081344
  buffer_load_dwordx4 v119, s[64:67], s28 offen nt lds
  s_add_u32 m0, s38, 34816
  s_mov_b32 s28, 1114112
  buffer_load_dwordx4 v119, s[64:67], s28 offen nt lds
  s_add_u32 m0, s38, 35840
  s_mov_b32 s28, 1146880
  buffer_load_dwordx4 v119, s[64:67], s28 offen nt lds
  s_add_u32 m0, s38, 49152
  s_mov_b32 s28, 1572864
  buffer_load_dwordx4 v119, s[64:67], s28 offen nt lds
  s_add_u32 m0, s38, 50176
  s_mov_b32 s28, 1605632
  buffer_load_dwordx4 v119, s[64:67], s28 offen nt lds
  s_add_u32 m0, s38, 51200
  s_mov_b32 s28, 1638400
  buffer_load_dwordx4 v119, s[64:67], s28 offen nt lds
  s_add_u32 m0, s38, 52224
  s_mov_b32 s28, 1671168
  buffer_load_dwordx4 v119, s[64:67], s28 offen nt lds
  s_add_u32 m0, s38, 65536
  s_mov_b32 s28, 2097152
  buffer_load_dwordx4 v119, s[64:67], s28 offen nt lds
  s_add_u32 m0, s38, 66560
  s_mov_b32 s28, 2129920
  buffer_load_dwordx4 v119, s[64:67], s28 offen nt lds
  s_add_u32 m0, s38, 67584
  s_mov_b32 s28, 2162688
  buffer_load_dwordx4 v119, s[64:67], s28 offen nt lds
  s_add_u32 m0, s38, 68608
  s_mov_b32 s28, 2195456
  buffer_load_dwordx4 v119, s[64:67], s28 offen nt lds
  s_add_u32 m0, s38, 81920
  s_mov_b32 s28, 2621440
  buffer_load_dwordx4 v119, s[64:67], s28 offen nt lds
  s_add_u32 m0, s38, 82944
  s_mov_b32 s28, 2654208
  buffer_load_dwordx4 v119, s[64:67], s28 offen nt lds
  s_add_u32 m0, s38, 83968
  s_mov_b32 s28, 2686976
  buffer_load_dwordx4 v119, s[64:67], s28 offen nt lds
  s_add_u32 m0, s38, 84992
  s_mov_b32 s28, 2719744
  buffer_load_dwordx4 v119, s[64:67], s28 offen nt lds
  s_add_u32 m0, s38, 98304
  s_mov_b32 s28, 3145728
  buffer_load_dwordx4 v119, s[64:67], s28 offen nt lds
  s_add_u32 m0, s38, 99328
  s_mov_b32 s28, 3178496
  buffer_load_dwordx4 v119, s[64:67], s28 offen nt lds
  s_add_u32 m0, s38, 100352
  s_mov_b32 s28, 3211264
  buffer_load_dwordx4 v119, s[64:67], s28 offen nt lds
  s_add_u32 m0, s38, 101376
  s_mov_b32 s28, 3244032
  buffer_load_dwordx4 v119, s[64:67], s28 offen nt lds
  v_and_b32 v92, 63, v0
  v_lshrrev_b32 v93, 4, v92
  v_and_b32 v94, 15, v92
  v_lshlrev_b32 v3, 4, v92
  v_lshlrev_b32 v19, 2, v92
  v_lshlrev_b32 v17, 6, v92
  s_lshr_b32 s27, s4, 1
  s_lshl_b32 s27, s27, 12
  v_add_u32 v17, s27, v17
  v_bfe_u32 v95, v94, 1, 1
  v_mov_b32 v96, 0xaaaaaaaa
  v_mul_lo_u32 v95, v95, v96
  v_add_u32 v1, 0x44444444, v95
  s_mov_b32 s32, 0x33333333
  s_mov_b32 s33, 0x33333333
  s_mov_b32 s34, 0xcccccccc
  s_mov_b32 s35, 0xcccccccc
  s_mov_b32 s36, 0x00ff00ff
  s_mov_b32 s37, 0
  s_mov_b32 s32, 0xf0f0f0f0
  s_mov_b32 s33, 0xf0f0f0f0
  v_lshrrev_b32 v95, 2, v94
  s_lshl_b32 s27, s4, 3
  v_add_u32 v95, s27, v95
  v_lshlrev_b32 v95, 13, v95
  s_lshl_b32 s27, s5, 6
  v_add_u32 v95, s27, v95
  v_and_b32 v96, 3, v94
  v_lshl_add_u32 v95, v96, 4, v95
  v_lshl_add_u32 v2, v93, 11, v95
  s_mov_b32 s22, 32768
  s_lshl_b32 s19, s5, 13
  s_lshl_b32 s28, s4, 11
  s_add_u32 s20, s19, s28
  s_lshl_b32 s21, s4, 11
  s_add_u32 s21, s21, 262144
  v_lshlrev_b32 v95, 5, v93
  v_lshl_add_u32 v95, v94, 2, v95
  s_lshl_b32 s27, s5, 8
  s_lshl_b32 s28, s4, 6
  s_add_u32 s27, s27, s28
  s_add_u32 s27, s27, 262144
  v_add_u32 v4, s27, v95
  v_and_b32 v96, 3, v94
  v_cmp_eq_u32 vcc, 3, v96
  s_nop 1
  v_cndmask_b32 v0, 0, 1, vcc
  s_add_u32 s27, s4, 0
  s_and_b32 s27, s27, 3
  s_lshl_b32 s27, s27, 11
  s_add_u32 s27, s27, 16384
  v_add_u32 v5, s27, v3
  s_add_u32 s27, s4, 1
  s_and_b32 s27, s27, 3
  s_lshl_b32 s27, s27, 11
  s_add_u32 s27, s27, 16384
  v_add_u32 v6, s27, v3
  s_add_u32 s27, s4, 2
  s_and_b32 s27, s27, 3
  s_lshl_b32 s27, s27, 11
  s_add_u32 s27, s27, 16384
  v_add_u32 v7, s27, v3
  s_add_u32 s27, s4, 3
  s_and_b32 s27, s27, 3
  s_lshl_b32 s27, s27, 11
  s_add_u32 s27, s27, 16384
  v_add_u32 v8, s27, v3
  s_lshl_b32 s27, s4, 9
  v_lshlrev_b32 v95, 7, v93
  v_lshl_add_u32 v95, v94, 2, v95
  v_add_u32 v95, s27, v95
  v_add_u32 v9, 28672, v95
  v_add_u32 v12, 24576, v95
  v_lshrrev_b32 v95, 2, v94
  v_lshlrev_b32 v95, 7, v95
  v_and_b32 v96, 1, v94
  v_lshl_add_u32 v95, v96, 6, v95
  v_lshl_add_u32 v95, v93, 4, v95
  v_mov_b32 v11, v95
  s_mul_i32 s27, s4, 32768
  s_add_u32 s27, s27, 32768
  v_add_u32 v13, s27, v3
  s_lshr_b32 s28, s4, 1
  s_lshl_b32 s28, s28, 10
  s_and_b32 s29, s4, 1
  s_lshl_b32 s29, s29, 3
  s_add_u32 s28, s28, s29
  s_add_u32 s28, s28, 30720
  v_add_u32 v14, s28, v3
  s_lshl_b32 s28, s4, 9
  s_add_u32 s28, s28, 26624
  v_lshlrev_b32 v95, 4, v94
  v_lshl_add_u32 v95, v93, 2, v95
  v_add_u32 v15, s28, v95
  s_lshl_b32 s28, s4, 10
  s_add_u32 s29, s28, 24576
  v_add_u32 v16, s29, v3
  s_lshl_b32 s62, s4, 11
  s_add_u32 s63, s62, 16384
  s_add_u32 s62, s62, 0
  v_mov_b32 v20, 0
  v_mov_b32 v21, 0
  v_mov_b32 v22, 0
  v_mov_b32 v23, 0
  v_mov_b32 v24, 0
  v_mov_b32 v25, 0
  v_mov_b32 v26, 0
  v_mov_b32 v27, 0
  v_mov_b32 v28, 0
  v_mov_b32 v29, 0
  v_mov_b32 v30, 0
  v_mov_b32 v31, 0
  v_mov_b32 v32, 0
  v_mov_b32 v33, 0
  v_mov_b32 v34, 0
  v_mov_b32 v35, 0
  v_and_b32 v95, 1, v94
  v_lshlrev_b32 v95, 4, v95
  v_mov_b32 v30, 0x3f80
  v_lshlrev_b32 v30, v95, v30
  v_lshrrev_b32 v31, 1, v94
  s_mov_b32 s6, 0x3e0293ee
  s_mov_b32 s7, s6
  v_mov_b32 v100, 0
  v_mov_b32 v101, 0
  v_mov_b32 v102, 0
  v_mov_b32 v103, 0
  buffer_store_dwordx4 v[100:103], v3, s[8:11], s20 offen sc1
  buffer_store_dwordx4 v[100:103], v3, s[8:11], s20 offen offset:1024 sc1
  s_mov_b64 exec, s[36:37]
  buffer_store_dword v100, v4, s[8:11], 0 offen sc1
  s_mov_b64 exec, -1
  s_waitcnt vmcnt(24)
  s_barrier
  s_add_u32 m0, s38, 114688
  s_mov_b32 s28, 3670016
  buffer_load_dwordx4 v119, s[64:67], s28 offen nt lds
  s_add_u32 m0, s38, 115712
  s_mov_b32 s28, 3702784
  buffer_load_dwordx4 v119, s[64:67], s28 offen nt lds
  s_add_u32 m0, s38, 116736
  s_mov_b32 s28, 3735552
  buffer_load_dwordx4 v119, s[64:67], s28 offen nt lds
  s_add_u32 m0, s38, 117760
  s_mov_b32 s28, 3768320
  buffer_load_dwordx4 v119, s[64:67], s28 offen nt lds
  v_xor_b32 v116, 0, v121
  ds_read_b128 v[68:71], v116 offset:0
  v_xor_b32 v116, 64, v121
  ds_read_b128 v[72:75], v116 offset:4096
  v_xor_b32 v116, 128, v121
  ds_read_b128 v[76:79], v116 offset:8192
  v_xor_b32 v116, 192, v121
  ds_read_b128 v[80:83], v116 offset:12288
  s_waitcnt lgkmcnt(0)
  v_perm_b32 v84, v69, v68, s80
  v_perm_b32 v85, v71, v70, s80
  v_perm_b32 v86, v69, v68, s81
  v_perm_b32 v87, v71, v70, s81
  v_xor_b32 v116, 0, v121
  ds_write_b128 v116, v[84:87] offset:0
  v_perm_b32 v88, v73, v72, s80
  v_perm_b32 v89, v75, v74, s80
  v_perm_b32 v90, v73, v72, s81
  v_perm_b32 v91, v75, v74, s81
  v_xor_b32 v116, 64, v121
  ds_write_b128 v116, v[88:91] offset:4096
  v_perm_b32 v92, v77, v76, s80
  v_perm_b32 v93, v79, v78, s80
  v_perm_b32 v94, v77, v76, s81
  v_perm_b32 v95, v79, v78, s81
  v_xor_b32 v116, 128, v121
  ds_write_b128 v116, v[92:95] offset:8192
  v_perm_b32 v96, v81, v80, s80
  v_perm_b32 v97, v83, v82, s80
  v_perm_b32 v98, v81, v80, s81
  v_perm_b32 v99, v83, v82, s81
  v_xor_b32 v116, 192, v121
  ds_write_b128 v116, v[96:99] offset:12288
  s_lshl_b32 s27, s4, 13
  v_add_u32 v118, s27, v3
  s_cmp_eq_u32 s4, 0
  s_cbranch_scc0 L_lw_3
  ds_read_b64_tr_b16 v[68:69], v122 offset:0
  ds_read_b64_tr_b16 v[70:71], v122 offset:256
  ds_read_b64_tr_b16 v[72:73], v122 offset:2048
  ds_read_b64_tr_b16 v[74:75], v122 offset:2304
  ds_read_b64_tr_b16 v[76:77], v122 offset:8
  ds_read_b64_tr_b16 v[78:79], v122 offset:264
  ds_read_b64_tr_b16 v[80:81], v122 offset:2056
  ds_read_b64_tr_b16 v[82:83], v122 offset:2312
  s_waitcnt lgkmcnt(0)
  ds_write_b128 v118, v[68:71] offset:0
  ds_write_b128 v118, v[72:75] offset:1024
  ds_write_b128 v118, v[76:79] offset:2048
  ds_write_b128 v118, v[80:83] offset:3072
  s_branch L_lw_2
L_lw_3:
  s_cmp_eq_u32 s4, 1
  s_cbranch_scc0 L_lw_4
  ds_read_b64_tr_b16 v[208:209], v122 offset:0
  ds_read_b64_tr_b16 v[210:211], v122 offset:256
  ds_read_b64_tr_b16 v[212:213], v122 offset:2048
  ds_read_b64_tr_b16 v[214:215], v122 offset:2304
  ds_read_b64_tr_b16 v[216:217], v122 offset:8
  ds_read_b64_tr_b16 v[218:219], v122 offset:264
  ds_read_b64_tr_b16 v[220:221], v122 offset:2056
  ds_read_b64_tr_b16 v[222:223], v122 offset:2312
  s_branch L_lw_2
L_lw_4:
  s_cmp_eq_u32 s4, 2
  s_cbranch_scc0 L_lw_5
  ds_read_b64_tr_b16 v[176:177], v122 offset:0
  ds_read_b64_tr_b16 v[178:179], v122 offset:256
  ds_read_b64_tr_b16 v[180:181], v122 offset:2048
  ds_read_b64_tr_b16 v[182:183], v122 offset:2304
  ds_read_b64_tr_b16 v[184:185], v122 offset:8
  ds_read_b64_tr_b16 v[186:187], v122 offset:264
  ds_read_b64_tr_b16 v[188:189], v122 offset:2056
  ds_read_b64_tr_b16 v[190:191], v122 offset:2312
  s_branch L_lw_2
L_lw_5:
  ds_read_b64_tr_b16 v[144:145], v122 offset:0
  ds_read_b64_tr_b16 v[146:147], v122 offset:256
  ds_read_b64_tr_b16 v[148:149], v122 offset:2048
  ds_read_b64_tr_b16 v[150:151], v122 offset:2304
  ds_read_b64_tr_b16 v[152:153], v122 offset:8
  ds_read_b64_tr_b16 v[154:155], v122 offset:264
  ds_read_b64_tr_b16 v[156:157], v122 offset:2056
  ds_read_b64_tr_b16 v[158:159], v122 offset:2312
L_lw_2:
  s_waitcnt lgkmcnt(0)
  s_waitcnt vmcnt(24)
  s_barrier
  s_add_u32 m0, s38, 0
  s_mov_b32 s28, 0
  buffer_load_dwordx4 v119, s[68:71], s28 offen nt lds
  s_add_u32 m0, s38, 1024
  s_mov_b32 s28, 32768
  buffer_load_dwordx4 v119, s[68:71], s28 offen nt lds
  s_add_u32 m0, s38, 2048
  s_mov_b32 s28, 65536
  buffer_load_dwordx4 v119, s[68:71], s28 offen nt lds
  s_add_u32 m0, s38, 3072
  s_mov_b32 s28, 98304
  buffer_load_dwordx4 v119, s[68:71], s28 offen nt lds
  v_xor_b32 v116, 0, v121
  ds_read_b128 v[68:71], v116 offset:16384
  v_xor_b32 v116, 64, v121
  ds_read_b128 v[72:75], v116 offset:20480
  v_xor_b32 v116, 128, v121
  ds_read_b128 v[76:79], v116 offset:24576
  v_xor_b32 v116, 192, v121
  ds_read_b128 v[80:83], v116 offset:28672
  s_waitcnt lgkmcnt(0)
  v_perm_b32 v84, v69, v68, s80
  v_perm_b32 v85, v71, v70, s80
  v_perm_b32 v86, v69, v68, s81
  v_perm_b32 v87, v71, v70, s81
  v_xor_b32 v116, 0, v121
  ds_write_b128 v116, v[84:87] offset:16384
  v_perm_b32 v88, v73, v72, s80
  v_perm_b32 v89, v75, v74, s80
  v_perm_b32 v90, v73, v72, s81
  v_perm_b32 v91, v75, v74, s81
  v_xor_b32 v116, 64, v121
  ds_write_b128 v116, v[88:91] offset:20480
  v_perm_b32 v92, v77, v76, s80
  v_perm_b32 v93, v79, v78, s80
  v_perm_b32 v94, v77, v76, s81
  v_perm_b32 v95, v79, v78, s81
  v_xor_b32 v116, 128, v121
  ds_write_b128 v116, v[92:95] offset:24576
  v_perm_b32 v96, v81, v80, s80
  v_perm_b32 v97, v83, v82, s80
  v_perm_b32 v98, v81, v80, s81
  v_perm_b32 v99, v83, v82, s81
  v_xor_b32 v116, 192, v121
  ds_write_b128 v116, v[96:99] offset:28672
  s_cmp_eq_u32 s4, 0
  s_cbranch_scc0 L_lw_8
  ds_read_b64_tr_b16 v[128:129], v122 offset:16384
  ds_read_b64_tr_b16 v[130:131], v122 offset:16640
  ds_read_b64_tr_b16 v[132:133], v122 offset:18432
  ds_read_b64_tr_b16 v[134:135], v122 offset:18688
  ds_read_b64_tr_b16 v[136:137], v122 offset:16392
  ds_read_b64_tr_b16 v[138:139], v122 offset:16648
  ds_read_b64_tr_b16 v[140:141], v122 offset:18440
  ds_read_b64_tr_b16 v[142:143], v122 offset:18696
  s_branch L_lw_7
L_lw_8:
  s_cmp_eq_u32 s4, 1
  s_cbranch_scc0 L_lw_9
  ds_read_b64_tr_b16 v[224:225], v122 offset:16384
  ds_read_b64_tr_b16 v[226:227], v122 offset:16640
  ds_read_b64_tr_b16 v[228:229], v122 offset:18432
  ds_read_b64_tr_b16 v[230:231], v122 offset:18688
  ds_read_b64_tr_b16 v[232:233], v122 offset:16392
  ds_read_b64_tr_b16 v[234:235], v122 offset:16648
  ds_read_b64_tr_b16 v[236:237], v122 offset:18440
  ds_read_b64_tr_b16 v[238:239], v122 offset:18696
  s_branch L_lw_7
L_lw_9:
  s_cmp_eq_u32 s4, 2
  s_cbranch_scc0 L_lw_10
  ds_read_b64_tr_b16 v[192:193], v122 offset:16384
  ds_read_b64_tr_b16 v[194:195], v122 offset:16640
  ds_read_b64_tr_b16 v[196:197], v122 offset:18432
  ds_read_b64_tr_b16 v[198:199], v122 offset:18688
  ds_read_b64_tr_b16 v[200:201], v122 offset:16392
  ds_read_b64_tr_b16 v[202:203], v122 offset:16648
  ds_read_b64_tr_b16 v[204:205], v122 offset:18440
  ds_read_b64_tr_b16 v[206:207], v122 offset:18696
  s_branch L_lw_7
L_lw_10:
  ds_read_b64_tr_b16 v[160:161], v122 offset:16384
  ds_read_b64_tr_b16 v[162:163], v122 offset:16640
  ds_read_b64_tr_b16 v[164:165], v122 offset:18432
  ds_read_b64_tr_b16 v[166:167], v122 offset:18688
  ds_read_b64_tr_b16 v[168:169], v122 offset:16392
  ds_read_b64_tr_b16 v[170:171], v122 offset:16648
  ds_read_b64_tr_b16 v[172:173], v122 offset:18440
  ds_read_b64_tr_b16 v[174:175], v122 offset:18696
L_lw_7:
  s_waitcnt lgkmcnt(0)
  s_waitcnt vmcnt(24)
  s_barrier
  s_add_u32 m0, s38, 16384
  s_mov_b32 s28, 524288
  buffer_load_dwordx4 v119, s[68:71], s28 offen nt lds
  s_add_u32 m0, s38, 17408
  s_mov_b32 s28, 557056
  buffer_load_dwordx4 v119, s[68:71], s28 offen nt lds
  s_add_u32 m0, s38, 18432
  s_mov_b32 s28, 589824
  buffer_load_dwordx4 v119, s[68:71], s28 offen nt lds
  s_add_u32 m0, s38, 19456
  s_mov_b32 s28, 622592
  buffer_load_dwordx4 v119, s[68:71], s28 offen nt lds
  v_xor_b32 v116, 0, v121
  ds_read_b128 v[68:71], v116 offset:32768
  v_xor_b32 v116, 64, v121
  ds_read_b128 v[72:75], v116 offset:36864
  v_xor_b32 v116, 128, v121
  ds_read_b128 v[76:79], v116 offset:40960
  v_xor_b32 v116, 192, v121
  ds_read_b128 v[80:83], v116 offset:45056
  s_waitcnt lgkmcnt(0)
  v_perm_b32 v84, v69, v68, s80
  v_perm_b32 v85, v71, v70, s80
  v_perm_b32 v86, v69, v68, s81
  v_perm_b32 v87, v71, v70, s81
  v_xor_b32 v116, 0, v121
  ds_write_b128 v116, v[84:87] offset:32768
  v_perm_b32 v88, v73, v72, s80
  v_perm_b32 v89, v75, v74, s80
  v_perm_b32 v90, v73, v72, s81
  v_perm_b32 v91, v75, v74, s81
  v_xor_b32 v116, 64, v121
  ds_write_b128 v116, v[88:91] offset:36864
  v_perm_b32 v92, v77, v76, s80
  v_perm_b32 v93, v79, v78, s80
  v_perm_b32 v94, v77, v76, s81
  v_perm_b32 v95, v79, v78, s81
  v_xor_b32 v116, 128, v121
  ds_write_b128 v116, v[92:95] offset:40960
  v_perm_b32 v96, v81, v80, s80
  v_perm_b32 v97, v83, v82, s80
  v_perm_b32 v98, v81, v80, s81
  v_perm_b32 v99, v83, v82, s81
  v_xor_b32 v116, 192, v121
  ds_write_b128 v116, v[96:99] offset:45056
  s_cmp_eq_u32 s4, 0
  s_cbranch_scc0 L_lw_13
  ds_read_b64_tr_b16 v[144:145], v122 offset:32768
  ds_read_b64_tr_b16 v[146:147], v122 offset:33024
  ds_read_b64_tr_b16 v[148:149], v122 offset:34816
  ds_read_b64_tr_b16 v[150:151], v122 offset:35072
  ds_read_b64_tr_b16 v[152:153], v122 offset:32776
  ds_read_b64_tr_b16 v[154:155], v122 offset:33032
  ds_read_b64_tr_b16 v[156:157], v122 offset:34824
  ds_read_b64_tr_b16 v[158:159], v122 offset:35080
  s_branch L_lw_12
L_lw_13:
  s_cmp_eq_u32 s4, 1
  s_cbranch_scc0 L_lw_14
  ds_read_b64_tr_b16 v[68:69], v122 offset:32768
  ds_read_b64_tr_b16 v[70:71], v122 offset:33024
  ds_read_b64_tr_b16 v[72:73], v122 offset:34816
  ds_read_b64_tr_b16 v[74:75], v122 offset:35072
  ds_read_b64_tr_b16 v[76:77], v122 offset:32776
  ds_read_b64_tr_b16 v[78:79], v122 offset:33032
  ds_read_b64_tr_b16 v[80:81], v122 offset:34824
  ds_read_b64_tr_b16 v[82:83], v122 offset:35080
  s_waitcnt lgkmcnt(0)
  ds_write_b128 v118, v[68:71] offset:0
  ds_write_b128 v118, v[72:75] offset:1024
  ds_write_b128 v118, v[76:79] offset:2048
  ds_write_b128 v118, v[80:83] offset:3072
  s_branch L_lw_12
L_lw_14:
  s_cmp_eq_u32 s4, 2
  s_cbranch_scc0 L_lw_15
  ds_read_b64_tr_b16 v[208:209], v122 offset:32768
  ds_read_b64_tr_b16 v[210:211], v122 offset:33024
  ds_read_b64_tr_b16 v[212:213], v122 offset:34816
  ds_read_b64_tr_b16 v[214:215], v122 offset:35072
  ds_read_b64_tr_b16 v[216:217], v122 offset:32776
  ds_read_b64_tr_b16 v[218:219], v122 offset:33032
  ds_read_b64_tr_b16 v[220:221], v122 offset:34824
  ds_read_b64_tr_b16 v[222:223], v122 offset:35080
  s_branch L_lw_12
L_lw_15:
  ds_read_b64_tr_b16 v[176:177], v122 offset:32768
  ds_read_b64_tr_b16 v[178:179], v122 offset:33024
  ds_read_b64_tr_b16 v[180:181], v122 offset:34816
  ds_read_b64_tr_b16 v[182:183], v122 offset:35072
  ds_read_b64_tr_b16 v[184:185], v122 offset:32776
  ds_read_b64_tr_b16 v[186:187], v122 offset:33032
  ds_read_b64_tr_b16 v[188:189], v122 offset:34824
  ds_read_b64_tr_b16 v[190:191], v122 offset:35080
L_lw_12:
  s_waitcnt lgkmcnt(0)
  s_waitcnt vmcnt(24)
  s_barrier
  s_add_u32 m0, s38, 32768
  s_mov_b32 s28, 1048576
  buffer_load_dwordx4 v119, s[68:71], s28 offen nt lds
  s_add_u32 m0, s38, 33792
  s_mov_b32 s28, 1081344
  buffer_load_dwordx4 v119, s[68:71], s28 offen nt lds
  s_add_u32 m0, s38, 34816
  s_mov_b32 s28, 1114112
  buffer_load_dwordx4 v119, s[68:71], s28 offen nt lds
  s_add_u32 m0, s38, 35840
  s_mov_b32 s28, 1146880
  buffer_load_dwordx4 v119, s[68:71], s28 offen nt lds
  v_xor_b32 v116, 0, v121
  ds_read_b128 v[68:71], v116 offset:49152
  v_xor_b32 v116, 64, v121
  ds_read_b128 v[72:75], v116 offset:53248
  v_xor_b32 v116, 128, v121
  ds_read_b128 v[76:79], v116 offset:57344
  v_xor_b32 v116, 192, v121
  ds_read_b128 v[80:83], v116 offset:61440
  s_waitcnt lgkmcnt(0)
  v_perm_b32 v84, v69, v68, s80
  v_perm_b32 v85, v71, v70, s80
  v_perm_b32 v86, v69, v68, s81
  v_perm_b32 v87, v71, v70, s81
  v_xor_b32 v116, 0, v121
  ds_write_b128 v116, v[84:87] offset:49152
  v_perm_b32 v88, v73, v72, s80
  v_perm_b32 v89, v75, v74, s80
  v_perm_b32 v90, v73, v72, s81
  v_perm_b32 v91, v75, v74, s81
  v_xor_b32 v116, 64, v121
  ds_write_b128 v116, v[88:91] offset:53248
  v_perm_b32 v92, v77, v76, s80
  v_perm_b32 v93, v79, v78, s80
  v_perm_b32 v94, v77, v76, s81
  v_perm_b32 v95, v79, v78, s81
  v_xor_b32 v116, 128, v121
  ds_write_b128 v116, v[92:95] offset:57344
  v_perm_b32 v96, v81, v80, s80
  v_perm_b32 v97, v83, v82, s80
  v_perm_b32 v98, v81, v80, s81
  v_perm_b32 v99, v83, v82, s81
  v_xor_b32 v116, 192, v121
  ds_write_b128 v116, v[96:99] offset:61440
  s_cmp_eq_u32 s4, 0
  s_cbranch_scc0 L_lw_18
  ds_read_b64_tr_b16 v[160:161], v122 offset:49152
  ds_read_b64_tr_b16 v[162:163], v122 offset:49408
  ds_read_b64_tr_b16 v[164:165], v122 offset:51200
  ds_read_b64_tr_b16 v[166:167], v122 offset:51456
  ds_read_b64_tr_b16 v[168:169], v122 offset:49160
  ds_read_b64_tr_b16 v[170:171], v122 offset:49416
  ds_read_b64_tr_b16 v[172:173], v122 offset:51208
  ds_read_b64_tr_b16 v[174:175], v122 offset:51464
  s_branch L_lw_17
L_lw_18:
  s_cmp_eq_u32 s4, 1
  s_cbranch_scc0 L_lw_19
  ds_read_b64_tr_b16 v[128:129], v122 offset:49152
  ds_read_b64_tr_b16 v[130:131], v122 offset:49408
  ds_read_b64_tr_b16 v[132:133], v122 offset:51200
  ds_read_b64_tr_b16 v[134:135], v122 offset:51456
  ds_read_b64_tr_b16 v[136:137], v122 offset:49160
  ds_read_b64_tr_b16 v[138:139], v122 offset:49416
  ds_read_b64_tr_b16 v[140:141], v122 offset:51208
  ds_read_b64_tr_b16 v[142:143], v122 offset:51464
  s_branch L_lw_17
L_lw_19:
  s_cmp_eq_u32 s4, 2
  s_cbranch_scc0 L_lw_20
  ds_read_b64_tr_b16 v[224:225], v122 offset:49152
  ds_read_b64_tr_b16 v[226:227], v122 offset:49408
  ds_read_b64_tr_b16 v[228:229], v122 offset:51200
  ds_read_b64_tr_b16 v[230:231], v122 offset:51456
  ds_read_b64_tr_b16 v[232:233], v122 offset:49160
  ds_read_b64_tr_b16 v[234:235], v122 offset:49416
  ds_read_b64_tr_b16 v[236:237], v122 offset:51208
  ds_read_b64_tr_b16 v[238:239], v122 offset:51464
  s_branch L_lw_17
L_lw_20:
  ds_read_b64_tr_b16 v[192:193], v122 offset:49152
  ds_read_b64_tr_b16 v[194:195], v122 offset:49408
  ds_read_b64_tr_b16 v[196:197], v122 offset:51200
  ds_read_b64_tr_b16 v[198:199], v122 offset:51456
  ds_read_b64_tr_b16 v[200:201], v122 offset:49160
  ds_read_b64_tr_b16 v[202:203], v122 offset:49416
  ds_read_b64_tr_b16 v[204:205], v122 offset:51208
  ds_read_b64_tr_b16 v[206:207], v122 offset:51464
L_lw_17:
  s_waitcnt lgkmcnt(0)
  s_waitcnt vmcnt(24)
  s_barrier
  s_add_u32 m0, s38, 49152
  s_mov_b32 s28, 1572864
  buffer_load_dwordx4 v119, s[68:71], s28 offen nt lds
  s_add_u32 m0, s38, 50176
  s_mov_b32 s28, 1605632
  buffer_load_dwordx4 v119, s[68:71], s28 offen nt lds
  s_add_u32 m0, s38, 51200
  s_mov_b32 s28, 1638400
  buffer_load_dwordx4 v119, s[68:71], s28 offen nt lds
  s_add_u32 m0, s38, 52224
  s_mov_b32 s28, 1671168
  buffer_load_dwordx4 v119, s[68:71], s28 offen nt lds
  v_add_u32 v121, 65536, v121
  v_add_u32 v122, 65536, v122
  v_add_u32 v124, 65536, v124
  v_add_u32 v125, 65536, v125
  v_add_u32 v126, 65536, v126
  v_xor_b32 v116, 0, v121
  ds_read_b128 v[68:71], v116 offset:0
  v_xor_b32 v116, 64, v121
  ds_read_b128 v[72:75], v116 offset:4096
  v_xor_b32 v116, 128, v121
  ds_read_b128 v[76:79], v116 offset:8192
  v_xor_b32 v116, 192, v121
  ds_read_b128 v[80:83], v116 offset:12288
  s_waitcnt lgkmcnt(0)
  v_perm_b32 v84, v69, v68, s80
  v_perm_b32 v85, v71, v70, s80
  v_perm_b32 v86, v69, v68, s81
  v_perm_b32 v87, v71, v70, s81
  v_xor_b32 v116, 0, v121
  ds_write_b128 v116, v[84:87] offset:0
  v_perm_b32 v88, v73, v72, s80
  v_perm_b32 v89, v75, v74, s80
  v_perm_b32 v90, v73, v72, s81
  v_perm_b32 v91, v75, v74, s81
  v_xor_b32 v116, 64, v121
  ds_write_b128 v116, v[88:91] offset:4096
  v_perm_b32 v92, v77, v76, s80
  v_perm_b32 v93, v79, v78, s80
  v_perm_b32 v94, v77, v76, s81
  v_perm_b32 v95, v79, v78, s81
  v_xor_b32 v116, 128, v121
  ds_write_b128 v116, v[92:95] offset:8192
  v_perm_b32 v96, v81, v80, s80
  v_perm_b32 v97, v83, v82, s80
  v_perm_b32 v98, v81, v80, s81
  v_perm_b32 v99, v83, v82, s81
  v_xor_b32 v116, 192, v121
  ds_write_b128 v116, v[96:99] offset:12288
  s_cmp_eq_u32 s4, 0
  s_cbranch_scc0 L_lw_23
  ds_read_b64_tr_b16 v[176:177], v122 offset:0
  ds_read_b64_tr_b16 v[178:179], v122 offset:256
  ds_read_b64_tr_b16 v[180:181], v122 offset:2048
  ds_read_b64_tr_b16 v[182:183], v122 offset:2304
  ds_read_b64_tr_b16 v[184:185], v122 offset:8
  ds_read_b64_tr_b16 v[186:187], v122 offset:264
  ds_read_b64_tr_b16 v[188:189], v122 offset:2056
  ds_read_b64_tr_b16 v[190:191], v122 offset:2312
  s_branch L_lw_22
L_lw_23:
  s_cmp_eq_u32 s4, 1
  s_cbranch_scc0 L_lw_24
  ds_read_b64_tr_b16 v[144:145], v122 offset:0
  ds_read_b64_tr_b16 v[146:147], v122 offset:256
  ds_read_b64_tr_b16 v[148:149], v122 offset:2048
  ds_read_b64_tr_b16 v[150:151], v122 offset:2304
  ds_read_b64_tr_b16 v[152:153], v122 offset:8
  ds_read_b64_tr_b16 v[154:155], v122 offset:264
  ds_read_b64_tr_b16 v[156:157], v122 offset:2056
  ds_read_b64_tr_b16 v[158:159], v122 offset:2312
  s_branch L_lw_22
L_lw_24:
  s_cmp_eq_u32 s4, 2
  s_cbranch_scc0 L_lw_25
  ds_read_b64_tr_b16 v[68:69], v122 offset:0
  ds_read_b64_tr_b16 v[70:71], v122 offset:256
  ds_read_b64_tr_b16 v[72:73], v122 offset:2048
  ds_read_b64_tr_b16 v[74:75], v122 offset:2304
  ds_read_b64_tr_b16 v[76:77], v122 offset:8
  ds_read_b64_tr_b16 v[78:79], v122 offset:264
  ds_read_b64_tr_b16 v[80:81], v122 offset:2056
  ds_read_b64_tr_b16 v[82:83], v122 offset:2312
  s_waitcnt lgkmcnt(0)
  ds_write_b128 v118, v[68:71] offset:0
  ds_write_b128 v118, v[72:75] offset:1024
  ds_write_b128 v118, v[76:79] offset:2048
  ds_write_b128 v118, v[80:83] offset:3072
  s_branch L_lw_22
L_lw_25:
  ds_read_b64_tr_b16 v[208:209], v122 offset:0
  ds_read_b64_tr_b16 v[210:211], v122 offset:256
  ds_read_b64_tr_b16 v[212:213], v122 offset:2048
  ds_read_b64_tr_b16 v[214:215], v122 offset:2304
  ds_read_b64_tr_b16 v[216:217], v122 offset:8
  ds_read_b64_tr_b16 v[218:219], v122 offset:264
  ds_read_b64_tr_b16 v[220:221], v122 offset:2056
  ds_read_b64_tr_b16 v[222:223], v122 offset:2312
L_lw_22:
  s_waitcnt lgkmcnt(0)
  s_waitcnt vmcnt(24)
  s_barrier
  s_add_u32 m0, s38, 65536
  s_mov_b32 s28, 2097152
  buffer_load_dwordx4 v119, s[68:71], s28 offen nt lds
  s_add_u32 m0, s38, 66560
  s_mov_b32 s28, 2129920
  buffer_load_dwordx4 v119, s[68:71], s28 offen nt lds
  s_add_u32 m0, s38, 67584
  s_mov_b32 s28, 2162688
  buffer_load_dwordx4 v119, s[68:71], s28 offen nt lds
  s_add_u32 m0, s38, 68608
  s_mov_b32 s28, 2195456
  buffer_load_dwordx4 v119, s[68:71], s28 offen nt lds
  v_xor_b32 v116, 0, v121
  ds_read_b128 v[68:71], v116 offset:16384
  v_xor_b32 v116, 64, v121
  ds_read_b128 v[72:75], v116 offset:20480
  v_xor_b32 v116, 128, v121
  ds_read_b128 v[76:79], v116 offset:24576
  v_xor_b32 v116, 192, v121
  ds_read_b128 v[80:83], v116 offset:28672
  s_waitcnt lgkmcnt(0)
  v_perm_b32 v84, v69, v68, s80
  v_perm_b32 v85, v71, v70, s80
  v_perm_b32 v86, v69, v68, s81
  v_perm_b32 v87, v71, v70, s81
  v_xor_b32 v116, 0, v121
  ds_write_b128 v116, v[84:87] offset:16384
  v_perm_b32 v88, v73, v72, s80
  v_perm_b32 v89, v75, v74, s80
  v_perm_b32 v90, v73, v72, s81
  v_perm_b32 v91, v75, v74, s81
  v_xor_b32 v116, 64, v121
  ds_write_b128 v116, v[88:91] offset:20480
  v_perm_b32 v92, v77, v76, s80
  v_perm_b32 v93, v79, v78, s80
  v_perm_b32 v94, v77, v76, s81
  v_perm_b32 v95, v79, v78, s81
  v_xor_b32 v116, 128, v121
  ds_write_b128 v116, v[92:95] offset:24576
  v_perm_b32 v96, v81, v80, s80
  v_perm_b32 v97, v83, v82, s80
  v_perm_b32 v98, v81, v80, s81
  v_perm_b32 v99, v83, v82, s81
  v_xor_b32 v116, 192, v121
  ds_write_b128 v116, v[96:99] offset:28672
  s_cmp_eq_u32 s4, 0
  s_cbranch_scc0 L_lw_28
  ds_read_b64_tr_b16 v[192:193], v122 offset:16384
  ds_read_b64_tr_b16 v[194:195], v122 offset:16640
  ds_read_b64_tr_b16 v[196:197], v122 offset:18432
  ds_read_b64_tr_b16 v[198:199], v122 offset:18688
  ds_read_b64_tr_b16 v[200:201], v122 offset:16392
  ds_read_b64_tr_b16 v[202:203], v122 offset:16648
  ds_read_b64_tr_b16 v[204:205], v122 offset:18440
  ds_read_b64_tr_b16 v[206:207], v122 offset:18696
  s_branch L_lw_27
L_lw_28:
  s_cmp_eq_u32 s4, 1
  s_cbranch_scc0 L_lw_29
  ds_read_b64_tr_b16 v[160:161], v122 offset:16384
  ds_read_b64_tr_b16 v[162:163], v122 offset:16640
  ds_read_b64_tr_b16 v[164:165], v122 offset:18432
  ds_read_b64_tr_b16 v[166:167], v122 offset:18688
  ds_read_b64_tr_b16 v[168:169], v122 offset:16392
  ds_read_b64_tr_b16 v[170:171], v122 offset:16648
  ds_read_b64_tr_b16 v[172:173], v122 offset:18440
  ds_read_b64_tr_b16 v[174:175], v122 offset:18696
  s_branch L_lw_27
L_lw_29:
  s_cmp_eq_u32 s4, 2
  s_cbranch_scc0 L_lw_30
  ds_read_b64_tr_b16 v[128:129], v122 offset:16384
  ds_read_b64_tr_b16 v[130:131], v122 offset:16640
  ds_read_b64_tr_b16 v[132:133], v122 offset:18432
  ds_read_b64_tr_b16 v[134:135], v122 offset:18688
  ds_read_b64_tr_b16 v[136:137], v122 offset:16392
  ds_read_b64_tr_b16 v[138:139], v122 offset:16648
  ds_read_b64_tr_b16 v[140:141], v122 offset:18440
  ds_read_b64_tr_b16 v[142:143], v122 offset:18696
  s_branch L_lw_27
L_lw_30:
  ds_read_b64_tr_b16 v[224:225], v122 offset:16384
  ds_read_b64_tr_b16 v[226:227], v122 offset:16640
  ds_read_b64_tr_b16 v[228:229], v122 offset:18432
  ds_read_b64_tr_b16 v[230:231], v122 offset:18688
  ds_read_b64_tr_b16 v[232:233], v122 offset:16392
  ds_read_b64_tr_b16 v[234:235], v122 offset:16648
  ds_read_b64_tr_b16 v[236:237], v122 offset:18440
  ds_read_b64_tr_b16 v[238:239], v122 offset:18696
L_lw_27:
  s_waitcnt lgkmcnt(0)
  s_waitcnt vmcnt(24)
  s_barrier
  s_add_u32 m0, s38, 81920
  s_mov_b32 s28, 2621440
  buffer_load_dwordx4 v119, s[68:71], s28 offen nt lds
  s_add_u32 m0, s38, 82944
  s_mov_b32 s28, 2654208
  buffer_load_dwordx4 v119, s[68:71], s28 offen nt lds
  s_add_u32 m0, s38, 83968
  s_mov_b32 s28, 2686976
  buffer_load_dwordx4 v119, s[68:71], s28 offen nt lds
  s_add_u32 m0, s38, 84992
  s_mov_b32 s28, 2719744
  buffer_load_dwordx4 v119, s[68:71], s28 offen nt lds
  v_xor_b32 v116, 0, v121
  ds_read_b128 v[68:71], v116 offset:32768
  v_xor_b32 v116, 64, v121
  ds_read_b128 v[72:75], v116 offset:36864
  v_xor_b32 v116, 128, v121
  ds_read_b128 v[76:79], v116 offset:40960
  v_xor_b32 v116, 192, v121
  ds_read_b128 v[80:83], v116 offset:45056
  s_waitcnt lgkmcnt(0)
  v_perm_b32 v84, v69, v68, s80
  v_perm_b32 v85, v71, v70, s80
  v_perm_b32 v86, v69, v68, s81
  v_perm_b32 v87, v71, v70, s81
  v_xor_b32 v116, 0, v121
  ds_write_b128 v116, v[84:87] offset:32768
  v_perm_b32 v88, v73, v72, s80
  v_perm_b32 v89, v75, v74, s80
  v_perm_b32 v90, v73, v72, s81
  v_perm_b32 v91, v75, v74, s81
  v_xor_b32 v116, 64, v121
  ds_write_b128 v116, v[88:91] offset:36864
  v_perm_b32 v92, v77, v76, s80
  v_perm_b32 v93, v79, v78, s80
  v_perm_b32 v94, v77, v76, s81
  v_perm_b32 v95, v79, v78, s81
  v_xor_b32 v116, 128, v121
  ds_write_b128 v116, v[92:95] offset:40960
  v_perm_b32 v96, v81, v80, s80
  v_perm_b32 v97, v83, v82, s80
  v_perm_b32 v98, v81, v80, s81
  v_perm_b32 v99, v83, v82, s81
  v_xor_b32 v116, 192, v121
  ds_write_b128 v116, v[96:99] offset:45056
  s_cmp_eq_u32 s4, 0
  s_cbranch_scc0 L_lw_33
  ds_read_b64_tr_b16 v[208:209], v122 offset:32768
  ds_read_b64_tr_b16 v[210:211], v122 offset:33024
  ds_read_b64_tr_b16 v[212:213], v122 offset:34816
  ds_read_b64_tr_b16 v[214:215], v122 offset:35072
  ds_read_b64_tr_b16 v[216:217], v122 offset:32776
  ds_read_b64_tr_b16 v[218:219], v122 offset:33032
  ds_read_b64_tr_b16 v[220:221], v122 offset:34824
  ds_read_b64_tr_b16 v[222:223], v122 offset:35080
  s_branch L_lw_32
L_lw_33:
  s_cmp_eq_u32 s4, 1
  s_cbranch_scc0 L_lw_34
  ds_read_b64_tr_b16 v[176:177], v122 offset:32768
  ds_read_b64_tr_b16 v[178:179], v122 offset:33024
  ds_read_b64_tr_b16 v[180:181], v122 offset:34816
  ds_read_b64_tr_b16 v[182:183], v122 offset:35072
  ds_read_b64_tr_b16 v[184:185], v122 offset:32776
  ds_read_b64_tr_b16 v[186:187], v122 offset:33032
  ds_read_b64_tr_b16 v[188:189], v122 offset:34824
  ds_read_b64_tr_b16 v[190:191], v122 offset:35080
  s_branch L_lw_32
L_lw_34:
  s_cmp_eq_u32 s4, 2
  s_cbranch_scc0 L_lw_35
  ds_read_b64_tr_b16 v[144:145], v122 offset:32768
  ds_read_b64_tr_b16 v[146:147], v122 offset:33024
  ds_read_b64_tr_b16 v[148:149], v122 offset:34816
  ds_read_b64_tr_b16 v[150:151], v122 offset:35072
  ds_read_b64_tr_b16 v[152:153], v122 offset:32776
  ds_read_b64_tr_b16 v[154:155], v122 offset:33032
  ds_read_b64_tr_b16 v[156:157], v122 offset:34824
  ds_read_b64_tr_b16 v[158:159], v122 offset:35080
  s_branch L_lw_32
L_lw_35:
  ds_read_b64_tr_b16 v[68:69], v122 offset:32768
  ds_read_b64_tr_b16 v[70:71], v122 offset:33024
  ds_read_b64_tr_b16 v[72:73], v122 offset:34816
  ds_read_b64_tr_b16 v[74:75], v122 offset:35072
  ds_read_b64_tr_b16 v[76:77], v122 offset:32776
  ds_read_b64_tr_b16 v[78:79], v122 offset:33032
  ds_read_b64_tr_b16 v[80:81], v122 offset:34824
  ds_read_b64_tr_b16 v[82:83], v122 offset:35080
  s_waitcnt lgkmcnt(0)
  ds_write_b128 v118, v[68:71] offset:0
  ds_write_b128 v118, v[72:75] offset:1024
  ds_write_b128 v118, v[76:79] offset:2048
  ds_write_b128 v118, v[80:83] offset:3072
L_lw_32:
  s_waitcnt lgkmcnt(0)
  s_waitcnt vmcnt(24)
  s_barrier
  s_add_u32 m0, s38, 98304
  s_mov_b32 s28, 3145728
  buffer_load_dwordx4 v119, s[68:71], s28 offen nt lds
  s_add_u32 m0, s38, 99328
  s_mov_b32 s28, 3178496
  buffer_load_dwordx4 v119, s[68:71], s28 offen nt lds
  s_add_u32 m0, s38, 100352
  s_mov_b32 s28, 3211264
  buffer_load_dwordx4 v119, s[68:71], s28 offen nt lds
  s_add_u32 m0, s38, 101376
  s_mov_b32 s28, 3244032
  buffer_load_dwordx4 v119, s[68:71], s28 offen nt lds
  s_cmp_eq_u32 s4, 0
  s_cbranch_scc0 L_ar_37
  s_mov_b32 s3, 20
  v_mov_b32 v116, s3
  v_mov_b32 v117, 1
  s_mov_b64 exec, 1
  global_atomic_add v116, v117, s[96:97]
  s_mov_b64 exec, -1
L_ar_37:
  v_xor_b32 v116, 0, v121
  ds_read_b128 v[68:71], v116 offset:49152
  v_xor_b32 v116, 64, v121
  ds_read_b128 v[72:75], v116 offset:53248
  v_xor_b32 v116, 128, v121
  ds_read_b128 v[76:79], v116 offset:57344
  v_xor_b32 v116, 192, v121
  ds_read_b128 v[80:83], v116 offset:61440
  s_waitcnt lgkmcnt(0)
  v_perm_b32 v84, v69, v68, s80
  v_perm_b32 v85, v71, v70, s80
  v_perm_b32 v86, v69, v68, s81
  v_perm_b32 v87, v71, v70, s81
  v_xor_b32 v116, 0, v121
  ds_write_b128 v116, v[84:87] offset:49152
  v_perm_b32 v88, v73, v72, s80
  v_perm_b32 v89, v75, v74, s80
  v_perm_b32 v90, v73, v72, s81
  v_perm_b32 v91, v75, v74, s81
  v_xor_b32 v116, 64, v121
  ds_write_b128 v116, v[88:91] offset:53248
  v_perm_b32 v92, v77, v76, s80
  v_perm_b32 v93, v79, v78, s80
  v_perm_b32 v94, v77, v76, s81
  v_perm_b32 v95, v79, v78, s81
  v_xor_b32 v116, 128, v121
  ds_write_b128 v116, v[92:95] offset:57344
  v_perm_b32 v96, v81, v80, s80
  v_perm_b32 v97, v83, v82, s80
  v_perm_b32 v98, v81, v80, s81
  v_perm_b32 v99, v83, v82, s81
  v_xor_b32 v116, 192, v121
  ds_write_b128 v116, v[96:99] offset:61440
  s_cmp_eq_u32 s4, 0
  s_cbranch_scc0 L_lw_39
  ds_read_b64_tr_b16 v[224:225], v122 offset:49152
  ds_read_b64_tr_b16 v[226:227], v122 offset:49408
  ds_read_b64_tr_b16 v[228:229], v122 offset:51200
  ds_read_b64_tr_b16 v[230:231], v122 offset:51456
  ds_read_b64_tr_b16 v[232:233], v122 offset:49160
  ds_read_b64_tr_b16 v[234:235], v122 offset:49416
  ds_read_b64_tr_b16 v[236:237], v122 offset:51208
  ds_read_b64_tr_b16 v[238:239], v122 offset:51464
  s_branch L_lw_38
L_lw_39:
  s_cmp_eq_u32 s4, 1
  s_cbranch_scc0 L_lw_40
  ds_read_b64_tr_b16 v[192:193], v122 offset:49152
  ds_read_b64_tr_b16 v[194:195], v122 offset:49408
  ds_read_b64_tr_b16 v[196:197], v122 offset:51200
  ds_read_b64_tr_b16 v[198:199], v122 offset:51456
  ds_read_b64_tr_b16 v[200:201], v122 offset:49160
  ds_read_b64_tr_b16 v[202:203], v122 offset:49416
  ds_read_b64_tr_b16 v[204:205], v122 offset:51208
  ds_read_b64_tr_b16 v[206:207], v122 offset:51464
  s_branch L_lw_38
L_lw_40:
  s_cmp_eq_u32 s4, 2
  s_cbranch_scc0 L_lw_41
  ds_read_b64_tr_b16 v[160:161], v122 offset:49152
  ds_read_b64_tr_b16 v[162:163], v122 offset:49408
  ds_read_b64_tr_b16 v[164:165], v122 offset:51200
  ds_read_b64_tr_b16 v[166:167], v122 offset:51456
  ds_read_b64_tr_b16 v[168:169], v122 offset:49160
  ds_read_b64_tr_b16 v[170:171], v122 offset:49416
  ds_read_b64_tr_b16 v[172:173], v122 offset:51208
  ds_read_b64_tr_b16 v[174:175], v122 offset:51464
  s_branch L_lw_38
L_lw_41:
  ds_read_b64_tr_b16 v[128:129], v122 offset:49152
  ds_read_b64_tr_b16 v[130:131], v122 offset:49408
  ds_read_b64_tr_b16 v[132:133], v122 offset:51200
  ds_read_b64_tr_b16 v[134:135], v122 offset:51456
  ds_read_b64_tr_b16 v[136:137], v122 offset:49160
  ds_read_b64_tr_b16 v[138:139], v122 offset:49416
  ds_read_b64_tr_b16 v[140:141], v122 offset:51208
  ds_read_b64_tr_b16 v[142:143], v122 offset:51464
L_lw_38:
  s_waitcnt lgkmcnt(0)
  s_waitcnt vmcnt(24)
  s_barrier
  s_add_u32 m0, s38, 114688
  s_mov_b32 s28, 3670016
  buffer_load_dwordx4 v119, s[68:71], s28 offen nt lds
  s_add_u32 m0, s38, 115712
  s_mov_b32 s28, 3702784
  buffer_load_dwordx4 v119, s[68:71], s28 offen nt lds
  s_add_u32 m0, s38, 116736
  s_mov_b32 s28, 3735552
  buffer_load_dwordx4 v119, s[68:71], s28 offen nt lds
  s_add_u32 m0, s38, 117760
  s_mov_b32 s28, 3768320
  buffer_load_dwordx4 v119, s[68:71], s28 offen nt lds
  v_add_u32 v121, 4294901760, v121
  v_add_u32 v122, 4294901760, v122
  v_add_u32 v124, 4294901760, v124
  v_add_u32 v125, 4294901760, v125
  v_add_u32 v126, 4294901760, v126
  v_xor_b32 v116, 0, v121
  ds_read_b128 v[68:71], v116 offset:0
  v_xor_b32 v116, 64, v121
  ds_read_b128 v[72:75], v116 offset:4096
  v_xor_b32 v116, 128, v121
  ds_read_b128 v[76:79], v116 offset:8192
  v_xor_b32 v116, 192, v121
  ds_read_b128 v[80:83], v116 offset:12288
  s_waitcnt lgkmcnt(0)
  v_perm_b32 v84, v69, v68, s80
  v_perm_b32 v85, v71, v70, s80
  v_perm_b32 v86, v69, v68, s81
  v_perm_b32 v87, v71, v70, s81
  v_xor_b32 v116, 0, v121
  ds_write_b128 v116, v[84:87] offset:0
  v_perm_b32 v88, v73, v72, s80
  v_perm_b32 v89, v75, v74, s80
  v_perm_b32 v90, v73, v72, s81
  v_perm_b32 v91, v75, v74, s81
  v_xor_b32 v116, 64, v121
  ds_write_b128 v116, v[88:91] offset:4096
  v_perm_b32 v92, v77, v76, s80
  v_perm_b32 v93, v79, v78, s80
  v_perm_b32 v94, v77, v76, s81
  v_perm_b32 v95, v79, v78, s81
  v_xor_b32 v116, 128, v121
  ds_write_b128 v116, v[92:95] offset:8192
  v_perm_b32 v96, v81, v80, s80
  v_perm_b32 v97, v83, v82, s80
  v_perm_b32 v98, v81, v80, s81
  v_perm_b32 v99, v83, v82, s81
  v_xor_b32 v116, 192, v121
  ds_write_b128 v116, v[96:99] offset:12288
  s_cmp_eq_u32 s4, 0
  s_cbranch_scc0 L_lw_44
  ds_read_b64_tr_b16 v[68:69], v122 offset:0
  ds_read_b64_tr_b16 v[70:71], v122 offset:256
  ds_read_b64_tr_b16 v[72:73], v122 offset:2048
  ds_read_b64_tr_b16 v[74:75], v122 offset:2304
  ds_read_b64_tr_b16 v[76:77], v122 offset:8
  ds_read_b64_tr_b16 v[78:79], v122 offset:264
  ds_read_b64_tr_b16 v[80:81], v122 offset:2056
  ds_read_b64_tr_b16 v[82:83], v122 offset:2312
  s_waitcnt lgkmcnt(0)
  ds_write_b128 v118, v[68:71] offset:4096
  ds_write_b128 v118, v[72:75] offset:5120
  ds_write_b128 v118, v[76:79] offset:6144
  ds_write_b128 v118, v[80:83] offset:7168
  s_branch L_lw_43
L_lw_44:
  s_cmp_eq_u32 s4, 1
  s_cbranch_scc0 L_lw_45
  ds_read_b64_tr_b16 a[32:33], v122 offset:0
  ds_read_b64_tr_b16 a[34:35], v122 offset:256
  ds_read_b64_tr_b16 a[36:37], v122 offset:2048
  ds_read_b64_tr_b16 a[38:39], v122 offset:2304
  ds_read_b64_tr_b16 a[40:41], v122 offset:8
  ds_read_b64_tr_b16 a[42:43], v122 offset:264
  ds_read_b64_tr_b16 a[44:45], v122 offset:2056
  ds_read_b64_tr_b16 a[46:47], v122 offset:2312
  s_branch L_lw_43
L_lw_45:
  s_cmp_eq_u32 s4, 2
  s_cbranch_scc0 L_lw_46
  ds_read_b64_tr_b16 a[0:1], v122 offset:0
  ds_read_b64_tr_b16 a[2:3], v122 offset:256
  ds_read_b64_tr_b16 a[4:5], v122 offset:2048
  ds_read_b64_tr_b16 a[6:7], v122 offset:2304
  ds_read_b64_tr_b16 a[8:9], v122 offset:8
  ds_read_b64_tr_b16 a[10:11], v122 offset:264
  ds_read_b64_tr_b16 a[12:13], v122 offset:2056
  ds_read_b64_tr_b16 a[14:15], v122 offset:2312
  s_branch L_lw_43
L_lw_46:
  ds_read_b64_tr_b16 v[36:37], v122 offset:0
  ds_read_b64_tr_b16 v[38:39], v122 offset:256
  ds_read_b64_tr_b16 v[40:41], v122 offset:2048
  ds_read_b64_tr_b16 v[42:43], v122 offset:2304
  ds_read_b64_tr_b16 v[44:45], v122 offset:8
  ds_read_b64_tr_b16 v[46:47], v122 offset:264
  ds_read_b64_tr_b16 v[48:49], v122 offset:2056
  ds_read_b64_tr_b16 v[50:51], v122 offset:2312
L_lw_43:
  s_waitcnt lgkmcnt(0)
  s_waitcnt vmcnt(24)
  s_barrier
  s_add_u32 m0, s38, 0
  s_mov_b32 s28, 0
  buffer_load_dwordx4 v119, s[72:75], s28 offen nt lds
  s_add_u32 m0, s38, 1024
  s_mov_b32 s28, 32768
  buffer_load_dwordx4 v119, s[72:75], s28 offen nt lds
  s_add_u32 m0, s38, 2048
  s_mov_b32 s28, 65536
  buffer_load_dwordx4 v119, s[72:75], s28 offen nt lds
  s_add_u32 m0, s38, 3072
  s_mov_b32 s28, 98304
  buffer_load_dwordx4 v119, s[72:75], s28 offen nt lds
  v_xor_b32 v116, 0, v121
  ds_read_b128 v[68:71], v116 offset:16384
  v_xor_b32 v116, 64, v121
  ds_read_b128 v[72:75], v116 offset:20480
  v_xor_b32 v116, 128, v121
  ds_read_b128 v[76:79], v116 offset:24576
  v_xor_b32 v116, 192, v121
  ds_read_b128 v[80:83], v116 offset:28672
  s_waitcnt lgkmcnt(0)
  v_perm_b32 v84, v69, v68, s80
  v_perm_b32 v85, v71, v70, s80
  v_perm_b32 v86, v69, v68, s81
  v_perm_b32 v87, v71, v70, s81
  v_xor_b32 v116, 0, v121
  ds_write_b128 v116, v[84:87] offset:16384
  v_perm_b32 v88, v73, v72, s80
  v_perm_b32 v89, v75, v74, s80
  v_perm_b32 v90, v73, v72, s81
  v_perm_b32 v91, v75, v74, s81
  v_xor_b32 v116, 64, v121
  ds_write_b128 v116, v[88:91] offset:20480
  v_perm_b32 v92, v77, v76, s80
  v_perm_b32 v93, v79, v78, s80
  v_perm_b32 v94, v77, v76, s81
  v_perm_b32 v95, v79, v78, s81
  v_xor_b32 v116, 128, v121
  ds_write_b128 v116, v[92:95] offset:24576
  v_perm_b32 v96, v81, v80, s80
  v_perm_b32 v97, v83, v82, s80
  v_perm_b32 v98, v81, v80, s81
  v_perm_b32 v99, v83, v82, s81
  v_xor_b32 v116, 192, v121
  ds_write_b128 v116, v[96:99] offset:28672
  s_cmp_eq_u32 s4, 0
  s_cbranch_scc0 L_lw_49
  ds_read_b64_tr_b16 v[240:241], v122 offset:16384
  ds_read_b64_tr_b16 v[242:243], v122 offset:16640
  ds_read_b64_tr_b16 v[244:245], v122 offset:18432
  ds_read_b64_tr_b16 v[246:247], v122 offset:18688
  ds_read_b64_tr_b16 v[248:249], v122 offset:16392
  ds_read_b64_tr_b16 v[250:251], v122 offset:16648
  ds_read_b64_tr_b16 v[252:253], v122 offset:18440
  ds_read_b64_tr_b16 v[254:255], v122 offset:18696
  s_branch L_lw_48
L_lw_49:
  s_cmp_eq_u32 s4, 1
  s_cbranch_scc0 L_lw_50
  ds_read_b64_tr_b16 a[48:49], v122 offset:16384
  ds_read_b64_tr_b16 a[50:51], v122 offset:16640
  ds_read_b64_tr_b16 a[52:53], v122 offset:18432
  ds_read_b64_tr_b16 a[54:55], v122 offset:18688
  ds_read_b64_tr_b16 a[56:57], v122 offset:16392
  ds_read_b64_tr_b16 a[58:59], v122 offset:16648
  ds_read_b64_tr_b16 a[60:61], v122 offset:18440
  ds_read_b64_tr_b16 a[62:63], v122 offset:18696
  s_branch L_lw_48
L_lw_50:
  s_cmp_eq_u32 s4, 2
  s_cbranch_scc0 L_lw_51
  ds_read_b64_tr_b16 a[16:17], v122 offset:16384
  ds_read_b64_tr_b16 a[18:19], v122 offset:16640
  ds_read_b64_tr_b16 a[20:21], v122 offset:18432
  ds_read_b64_tr_b16 a[22:23], v122 offset:18688
  ds_read_b64_tr_b16 a[24:25], v122 offset:16392
  ds_read_b64_tr_b16 a[26:27], v122 offset:16648
  ds_read_b64_tr_b16 a[28:29], v122 offset:18440
  ds_read_b64_tr_b16 a[30:31], v122 offset:18696
  s_branch L_lw_48
L_lw_51:
  ds_read_b64_tr_b16 v[52:53], v122 offset:16384
  ds_read_b64_tr_b16 v[54:55], v122 offset:16640
  ds_read_b64_tr_b16 v[56:57], v122 offset:18432
  ds_read_b64_tr_b16 v[58:59], v122 offset:18688
  ds_read_b64_tr_b16 v[60:61], v122 offset:16392
  ds_read_b64_tr_b16 v[62:63], v122 offset:16648
  ds_read_b64_tr_b16 v[64:65], v122 offset:18440
  ds_read_b64_tr_b16 v[66:67], v122 offset:18696
L_lw_48:
  s_waitcnt lgkmcnt(0)
  s_waitcnt vmcnt(24)
  s_barrier
  s_add_u32 m0, s38, 16384
  s_mov_b32 s28, 524288
  buffer_load_dwordx4 v119, s[72:75], s28 offen nt lds
  s_add_u32 m0, s38, 17408
  s_mov_b32 s28, 557056
  buffer_load_dwordx4 v119, s[72:75], s28 offen nt lds
  s_add_u32 m0, s38, 18432
  s_mov_b32 s28, 589824
  buffer_load_dwordx4 v119, s[72:75], s28 offen nt lds
  s_add_u32 m0, s38, 19456
  s_mov_b32 s28, 622592
  buffer_load_dwordx4 v119, s[72:75], s28 offen nt lds
  v_xor_b32 v116, 0, v121
  ds_read_b128 v[68:71], v116 offset:32768
  v_xor_b32 v116, 64, v121
  ds_read_b128 v[72:75], v116 offset:36864
  v_xor_b32 v116, 128, v121
  ds_read_b128 v[76:79], v116 offset:40960
  v_xor_b32 v116, 192, v121
  ds_read_b128 v[80:83], v116 offset:45056
  s_waitcnt lgkmcnt(0)
  v_perm_b32 v84, v69, v68, s80
  v_perm_b32 v85, v71, v70, s80
  v_perm_b32 v86, v69, v68, s81
  v_perm_b32 v87, v71, v70, s81
  v_xor_b32 v116, 0, v121
  ds_write_b128 v116, v[84:87] offset:32768
  v_perm_b32 v88, v73, v72, s80
  v_perm_b32 v89, v75, v74, s80
  v_perm_b32 v90, v73, v72, s81
  v_perm_b32 v91, v75, v74, s81
  v_xor_b32 v116, 64, v121
  ds_write_b128 v116, v[88:91] offset:36864
  v_perm_b32 v92, v77, v76, s80
  v_perm_b32 v93, v79, v78, s80
  v_perm_b32 v94, v77, v76, s81
  v_perm_b32 v95, v79, v78, s81
  v_xor_b32 v116, 128, v121
  ds_write_b128 v116, v[92:95] offset:40960
  v_perm_b32 v96, v81, v80, s80
  v_perm_b32 v97, v83, v82, s80
  v_perm_b32 v98, v81, v80, s81
  v_perm_b32 v99, v83, v82, s81
  v_xor_b32 v116, 192, v121
  ds_write_b128 v116, v[96:99] offset:45056
  s_cmp_eq_u32 s4, 0
  s_cbranch_scc0 L_lw_54
  ds_read_b64_tr_b16 v[36:37], v122 offset:32768
  ds_read_b64_tr_b16 v[38:39], v122 offset:33024
  ds_read_b64_tr_b16 v[40:41], v122 offset:34816
  ds_read_b64_tr_b16 v[42:43], v122 offset:35072
  ds_read_b64_tr_b16 v[44:45], v122 offset:32776
  ds_read_b64_tr_b16 v[46:47], v122 offset:33032
  ds_read_b64_tr_b16 v[48:49], v122 offset:34824
  ds_read_b64_tr_b16 v[50:51], v122 offset:35080
  s_branch L_lw_53
L_lw_54:
  s_cmp_eq_u32 s4, 1
  s_cbranch_scc0 L_lw_55
  ds_read_b64_tr_b16 v[68:69], v122 offset:32768
  ds_read_b64_tr_b16 v[70:71], v122 offset:33024
  ds_read_b64_tr_b16 v[72:73], v122 offset:34816
  ds_read_b64_tr_b16 v[74:75], v122 offset:35072
  ds_read_b64_tr_b16 v[76:77], v122 offset:32776
  ds_read_b64_tr_b16 v[78:79], v122 offset:33032
  ds_read_b64_tr_b16 v[80:81], v122 offset:34824
  ds_read_b64_tr_b16 v[82:83], v122 offset:35080
  s_waitcnt lgkmcnt(0)
  ds_write_b128 v118, v[68:71] offset:4096
  ds_write_b128 v118, v[72:75] offset:5120
  ds_write_b128 v118, v[76:79] offset:6144
  ds_write_b128 v118, v[80:83] offset:7168
  s_branch L_lw_53
L_lw_55:
  s_cmp_eq_u32 s4, 2
  s_cbranch_scc0 L_lw_56
  ds_read_b64_tr_b16 a[32:33], v122 offset:32768
  ds_read_b64_tr_b16 a[34:35], v122 offset:33024
  ds_read_b64_tr_b16 a[36:37], v122 offset:34816
  ds_read_b64_tr_b16 a[38:39], v122 offset:35072
  ds_read_b64_tr_b16 a[40:41], v122 offset:32776
  ds_read_b64_tr_b16 a[42:43], v122 offset:33032
  ds_read_b64_tr_b16 a[44:45], v122 offset:34824
  ds_read_b64_tr_b16 a[46:47], v122 offset:35080
  s_branch L_lw_53
L_lw_56:
  ds_read_b64_tr_b16 a[0:1], v122 offset:32768
  ds_read_b64_tr_b16 a[2:3], v122 offset:33024
  ds_read_b64_tr_b16 a[4:5], v122 offset:34816
  ds_read_b64_tr_b16 a[6:7], v122 offset:35072
  ds_read_b64_tr_b16 a[8:9], v122 offset:32776
  ds_read_b64_tr_b16 a[10:11], v122 offset:33032
  ds_read_b64_tr_b16 a[12:13], v122 offset:34824
  ds_read_b64_tr_b16 a[14:15], v122 offset:35080
L_lw_53:
  s_waitcnt lgkmcnt(0)
  s_waitcnt vmcnt(24)
  s_barrier
  s_add_u32 m0, s38, 32768
  s_mov_b32 s28, 1048576
  buffer_load_dwordx4 v119, s[72:75], s28 offen nt lds
  s_add_u32 m0, s38, 33792
  s_mov_b32 s28, 1081344
  buffer_load_dwordx4 v119, s[72:75], s28 offen nt lds
  s_add_u32 m0, s38, 34816
  s_mov_b32 s28, 1114112
  buffer_load_dwordx4 v119, s[72:75], s28 offen nt lds
  s_add_u32 m0, s38, 35840
  s_mov_b32 s28, 1146880
  buffer_load_dwordx4 v119, s[72:75], s28 offen nt lds
  v_xor_b32 v116, 0, v121
  ds_read_b128 v[68:71], v116 offset:49152
  v_xor_b32 v116, 64, v121
  ds_read_b128 v[72:75], v116 offset:53248
  v_xor_b32 v116, 128, v121
  ds_read_b128 v[76:79], v116 offset:57344
  v_xor_b32 v116, 192, v121
  ds_read_b128 v[80:83], v116 offset:61440
  s_waitcnt lgkmcnt(0)
  v_perm_b32 v84, v69, v68, s80
  v_perm_b32 v85, v71, v70, s80
  v_perm_b32 v86, v69, v68, s81
  v_perm_b32 v87, v71, v70, s81
  v_xor_b32 v116, 0, v121
  ds_write_b128 v116, v[84:87] offset:49152
  v_perm_b32 v88, v73, v72, s80
  v_perm_b32 v89, v75, v74, s80
  v_perm_b32 v90, v73, v72, s81
  v_perm_b32 v91, v75, v74, s81
  v_xor_b32 v116, 64, v121
  ds_write_b128 v116, v[88:91] offset:53248
  v_perm_b32 v92, v77, v76, s80
  v_perm_b32 v93, v79, v78, s80
  v_perm_b32 v94, v77, v76, s81
  v_perm_b32 v95, v79, v78, s81
  v_xor_b32 v116, 128, v121
  ds_write_b128 v116, v[92:95] offset:57344
  v_perm_b32 v96, v81, v80, s80
  v_perm_b32 v97, v83, v82, s80
  v_perm_b32 v98, v81, v80, s81
  v_perm_b32 v99, v83, v82, s81
  v_xor_b32 v116, 192, v121
  ds_write_b128 v116, v[96:99] offset:61440
  s_cmp_eq_u32 s4, 0
  s_cbranch_scc0 L_lw_59
  ds_read_b64_tr_b16 v[52:53], v122 offset:49152
  ds_read_b64_tr_b16 v[54:55], v122 offset:49408
  ds_read_b64_tr_b16 v[56:57], v122 offset:51200
  ds_read_b64_tr_b16 v[58:59], v122 offset:51456
  ds_read_b64_tr_b16 v[60:61], v122 offset:49160
  ds_read_b64_tr_b16 v[62:63], v122 offset:49416
  ds_read_b64_tr_b16 v[64:65], v122 offset:51208
  ds_read_b64_tr_b16 v[66:67], v122 offset:51464
  s_branch L_lw_58
L_lw_59:
  s_cmp_eq_u32 s4, 1
  s_cbranch_scc0 L_lw_60
  ds_read_b64_tr_b16 v[240:241], v122 offset:49152
  ds_read_b64_tr_b16 v[242:243], v122 offset:49408
  ds_read_b64_tr_b16 v[244:245], v122 offset:51200
  ds_read_b64_tr_b16 v[246:247], v122 offset:51456
  ds_read_b64_tr_b16 v[248:249], v122 offset:49160
  ds_read_b64_tr_b16 v[250:251], v122 offset:49416
  ds_read_b64_tr_b16 v[252:253], v122 offset:51208
  ds_read_b64_tr_b16 v[254:255], v122 offset:51464
  s_branch L_lw_58
L_lw_60:
  s_cmp_eq_u32 s4, 2
  s_cbranch_scc0 L_lw_61
  ds_read_b64_tr_b16 a[48:49], v122 offset:49152
  ds_read_b64_tr_b16 a[50:51], v122 offset:49408
  ds_read_b64_tr_b16 a[52:53], v122 offset:51200
  ds_read_b64_tr_b16 a[54:55], v122 offset:51456
  ds_read_b64_tr_b16 a[56:57], v122 offset:49160
  ds_read_b64_tr_b16 a[58:59], v122 offset:49416
  ds_read_b64_tr_b16 a[60:61], v122 offset:51208
  ds_read_b64_tr_b16 a[62:63], v122 offset:51464
  s_branch L_lw_58
L_lw_61:
  ds_read_b64_tr_b16 a[16:17], v122 offset:49152
  ds_read_b64_tr_b16 a[18:19], v122 offset:49408
  ds_read_b64_tr_b16 a[20:21], v122 offset:51200
  ds_read_b64_tr_b16 a[22:23], v122 offset:51456
  ds_read_b64_tr_b16 a[24:25], v122 offset:49160
  ds_read_b64_tr_b16 a[26:27], v122 offset:49416
  ds_read_b64_tr_b16 a[28:29], v122 offset:51208
  ds_read_b64_tr_b16 a[30:31], v122 offset:51464
L_lw_58:
  s_waitcnt lgkmcnt(0)
  s_waitcnt vmcnt(24)
  s_barrier
  s_add_u32 m0, s38, 49152
  s_mov_b32 s28, 1572864
  buffer_load_dwordx4 v119, s[72:75], s28 offen nt lds
  s_add_u32 m0, s38, 50176
  s_mov_b32 s28, 1605632
  buffer_load_dwordx4 v119, s[72:75], s28 offen nt lds
  s_add_u32 m0, s38, 51200
  s_mov_b32 s28, 1638400
  buffer_load_dwordx4 v119, s[72:75], s28 offen nt lds
  s_add_u32 m0, s38, 52224
  s_mov_b32 s28, 1671168
  buffer_load_dwordx4 v119, s[72:75], s28 offen nt lds
  v_mov_b32 v100, -1
  v_mov_b32 v101, -1
  v_mov_b32 v102, -1
  v_mov_b32 v103, -1
  s_lshl_b32 s27, s5, 2
  s_add_u32 s27, s27, s4
  s_lshl_b32 s27, s27, 10
  s_add_u32 s28, s27, 8388608
  buffer_store_dwordx4 v[100:103], v3, s[8:11], s28 offen sc1
  s_add_u32 s28, s27, 9175040
  buffer_store_dwordx4 v[100:103], v3, s[8:11], s28 offen sc1
  s_add_u32 s28, s27, 9306112
  buffer_store_dwordx4 v[100:103], v3, s[8:11], s28 offen sc1
  s_add_u32 s28, s27, 16777216
  buffer_store_dwordx4 v[100:103], v3, s[8:11], s28 offen sc1
  s_add_u32 s28, s27, 17563648
  buffer_store_dwordx4 v[100:103], v3, s[8:11], s28 offen sc1
  s_add_u32 s28, s27, 17694720
  buffer_store_dwordx4 v[100:103], v3, s[8:11], s28 offen sc1
  s_load_dwordx2 s[12:13], s[0:1], 8
  s_waitcnt lgkmcnt(0)
  s_mov_b32 s14, 8192
  s_mov_b32 s15, 0x20000
  v_lshlrev_b32 v104, 3, v3
  buffer_load_dword v117, v104, s[12:15], 0 offen
  v_add_u32 v121, 65536, v121
  v_add_u32 v122, 65536, v122
  v_add_u32 v124, 65536, v124
  v_add_u32 v125, 65536, v125
  v_add_u32 v126, 65536, v126
  v_xor_b32 v116, 0, v121
  ds_read_b128 v[68:71], v116 offset:0
  v_xor_b32 v116, 64, v121
  ds_read_b128 v[72:75], v116 offset:4096
  v_xor_b32 v116, 128, v121
  ds_read_b128 v[76:79], v116 offset:8192
  v_xor_b32 v116, 192, v121
  ds_read_b128 v[80:83], v116 offset:12288
  s_waitcnt lgkmcnt(0)
  v_perm_b32 v84, v69, v68, s80
  v_perm_b32 v85, v71, v70, s80
  v_perm_b32 v86, v69, v68, s81
  v_perm_b32 v87, v71, v70, s81
  v_xor_b32 v116, 0, v121
  ds_write_b128 v116, v[84:87] offset:0
  v_perm_b32 v88, v73, v72, s80
  v_perm_b32 v89, v75, v74, s80
  v_perm_b32 v90, v73, v72, s81
  v_perm_b32 v91, v75, v74, s81
  v_xor_b32 v116, 64, v121
  ds_write_b128 v116, v[88:91] offset:4096
  v_perm_b32 v92, v77, v76, s80
  v_perm_b32 v93, v79, v78, s80
  v_perm_b32 v94, v77, v76, s81
  v_perm_b32 v95, v79, v78, s81
  v_xor_b32 v116, 128, v121
  ds_write_b128 v116, v[92:95] offset:8192
  v_perm_b32 v96, v81, v80, s80
  v_perm_b32 v97, v83, v82, s80
  v_perm_b32 v98, v81, v80, s81
  v_perm_b32 v99, v83, v82, s81
  v_xor_b32 v116, 192, v121
  ds_write_b128 v116, v[96:99] offset:12288
  s_cmp_eq_u32 s4, 0
  s_cbranch_scc0 L_lw_64
  ds_read_b64_tr_b16 a[0:1], v122 offset:0
  ds_read_b64_tr_b16 a[2:3], v122 offset:256
  ds_read_b64_tr_b16 a[4:5], v122 offset:2048
  ds_read_b64_tr_b16 a[6:7], v122 offset:2304
  ds_read_b64_tr_b16 a[8:9], v122 offset:8
  ds_read_b64_tr_b16 a[10:11], v122 offset:264
  ds_read_b64_tr_b16 a[12:13], v122 offset:2056
  ds_read_b64_tr_b16 a[14:15], v122 offset:2312
  s_branch L_lw_63
L_lw_64:
  s_cmp_eq_u32 s4, 1
  s_cbranch_scc0 L_lw_65
  ds_read_b64_tr_b16 v[36:37], v122 offset:0
  ds_read_b64_tr_b16 v[38:39], v122 offset:256
  ds_read_b64_tr_b16 v[40:41], v122 offset:2048
  ds_read_b64_tr_b16 v[42:43], v122 offset:2304
  ds_read_b64_tr_b16 v[44:45], v122 offset:8
  ds_read_b64_tr_b16 v[46:47], v122 offset:264
  ds_read_b64_tr_b16 v[48:49], v122 offset:2056
  ds_read_b64_tr_b16 v[50:51], v122 offset:2312
  s_branch L_lw_63
L_lw_65:
  s_cmp_eq_u32 s4, 2
  s_cbranch_scc0 L_lw_66
  ds_read_b64_tr_b16 v[68:69], v122 offset:0
  ds_read_b64_tr_b16 v[70:71], v122 offset:256
  ds_read_b64_tr_b16 v[72:73], v122 offset:2048
  ds_read_b64_tr_b16 v[74:75], v122 offset:2304
  ds_read_b64_tr_b16 v[76:77], v122 offset:8
  ds_read_b64_tr_b16 v[78:79], v122 offset:264
  ds_read_b64_tr_b16 v[80:81], v122 offset:2056
  ds_read_b64_tr_b16 v[82:83], v122 offset:2312
  s_waitcnt lgkmcnt(0)
  ds_write_b128 v118, v[68:71] offset:4096
  ds_write_b128 v118, v[72:75] offset:5120
  ds_write_b128 v118, v[76:79] offset:6144
  ds_write_b128 v118, v[80:83] offset:7168
  s_branch L_lw_63
L_lw_66:
  ds_read_b64_tr_b16 a[32:33], v122 offset:0
  ds_read_b64_tr_b16 a[34:35], v122 offset:256
  ds_read_b64_tr_b16 a[36:37], v122 offset:2048
  ds_read_b64_tr_b16 a[38:39], v122 offset:2304
  ds_read_b64_tr_b16 a[40:41], v122 offset:8
  ds_read_b64_tr_b16 a[42:43], v122 offset:264
  ds_read_b64_tr_b16 a[44:45], v122 offset:2056
  ds_read_b64_tr_b16 a[46:47], v122 offset:2312
L_lw_63:
  s_waitcnt lgkmcnt(0)
  s_waitcnt vmcnt(24)
  s_barrier
  s_add_u32 m0, s38, 65536
  s_mov_b32 s28, 2097152
  buffer_load_dwordx4 v119, s[72:75], s28 offen nt lds
  s_add_u32 m0, s38, 66560
  s_mov_b32 s28, 2129920
  buffer_load_dwordx4 v119, s[72:75], s28 offen nt lds
  s_add_u32 m0, s38, 67584
  s_mov_b32 s28, 2162688
  buffer_load_dwordx4 v119, s[72:75], s28 offen nt lds
  s_add_u32 m0, s38, 68608
  s_mov_b32 s28, 2195456
  buffer_load_dwordx4 v119, s[72:75], s28 offen nt lds
  v_xor_b32 v116, 0, v121
  ds_read_b128 v[68:71], v116 offset:16384
  v_xor_b32 v116, 64, v121
  ds_read_b128 v[72:75], v116 offset:20480
  v_xor_b32 v116, 128, v121
  ds_read_b128 v[76:79], v116 offset:24576
  v_xor_b32 v116, 192, v121
  ds_read_b128 v[80:83], v116 offset:28672
  s_waitcnt lgkmcnt(0)
  v_perm_b32 v84, v69, v68, s80
  v_perm_b32 v85, v71, v70, s80
  v_perm_b32 v86, v69, v68, s81
  v_perm_b32 v87, v71, v70, s81
  v_xor_b32 v116, 0, v121
  ds_write_b128 v116, v[84:87] offset:16384
  v_perm_b32 v88, v73, v72, s80
  v_perm_b32 v89, v75, v74, s80
  v_perm_b32 v90, v73, v72, s81
  v_perm_b32 v91, v75, v74, s81
  v_xor_b32 v116, 64, v121
  ds_write_b128 v116, v[88:91] offset:20480
  v_perm_b32 v92, v77, v76, s80
  v_perm_b32 v93, v79, v78, s80
  v_perm_b32 v94, v77, v76, s81
  v_perm_b32 v95, v79, v78, s81
  v_xor_b32 v116, 128, v121
  ds_write_b128 v116, v[92:95] offset:24576
  v_perm_b32 v96, v81, v80, s80
  v_perm_b32 v97, v83, v82, s80
  v_perm_b32 v98, v81, v80, s81
  v_perm_b32 v99, v83, v82, s81
  v_xor_b32 v116, 192, v121
  ds_write_b128 v116, v[96:99] offset:28672
  s_cmp_eq_u32 s4, 0
  s_cbranch_scc0 L_lw_69
  ds_read_b64_tr_b16 a[16:17], v122 offset:16384
  ds_read_b64_tr_b16 a[18:19], v122 offset:16640
  ds_read_b64_tr_b16 a[20:21], v122 offset:18432
  ds_read_b64_tr_b16 a[22:23], v122 offset:18688
  ds_read_b64_tr_b16 a[24:25], v122 offset:16392
  ds_read_b64_tr_b16 a[26:27], v122 offset:16648
  ds_read_b64_tr_b16 a[28:29], v122 offset:18440
  ds_read_b64_tr_b16 a[30:31], v122 offset:18696
  s_branch L_lw_68
L_lw_69:
  s_cmp_eq_u32 s4, 1
  s_cbranch_scc0 L_lw_70
  ds_read_b64_tr_b16 v[52:53], v122 offset:16384
  ds_read_b64_tr_b16 v[54:55], v122 offset:16640
  ds_read_b64_tr_b16 v[56:57], v122 offset:18432
  ds_read_b64_tr_b16 v[58:59], v122 offset:18688
  ds_read_b64_tr_b16 v[60:61], v122 offset:16392
  ds_read_b64_tr_b16 v[62:63], v122 offset:16648
  ds_read_b64_tr_b16 v[64:65], v122 offset:18440
  ds_read_b64_tr_b16 v[66:67], v122 offset:18696
  s_branch L_lw_68
L_lw_70:
  s_cmp_eq_u32 s4, 2
  s_cbranch_scc0 L_lw_71
  ds_read_b64_tr_b16 v[240:241], v122 offset:16384
  ds_read_b64_tr_b16 v[242:243], v122 offset:16640
  ds_read_b64_tr_b16 v[244:245], v122 offset:18432
  ds_read_b64_tr_b16 v[246:247], v122 offset:18688
  ds_read_b64_tr_b16 v[248:249], v122 offset:16392
  ds_read_b64_tr_b16 v[250:251], v122 offset:16648
  ds_read_b64_tr_b16 v[252:253], v122 offset:18440
  ds_read_b64_tr_b16 v[254:255], v122 offset:18696
  s_branch L_lw_68
L_lw_71:
  ds_read_b64_tr_b16 a[48:49], v122 offset:16384
  ds_read_b64_tr_b16 a[50:51], v122 offset:16640
  ds_read_b64_tr_b16 a[52:53], v122 offset:18432
  ds_read_b64_tr_b16 a[54:55], v122 offset:18688
  ds_read_b64_tr_b16 a[56:57], v122 offset:16392
  ds_read_b64_tr_b16 a[58:59], v122 offset:16648
  ds_read_b64_tr_b16 a[60:61], v122 offset:18440
  ds_read_b64_tr_b16 a[62:63], v122 offset:18696
L_lw_68:
  s_waitcnt lgkmcnt(0)
  s_waitcnt vmcnt(24)
  s_barrier
  s_add_u32 m0, s38, 81920
  s_mov_b32 s28, 2621440
  buffer_load_dwordx4 v119, s[72:75], s28 offen nt lds
  s_add_u32 m0, s38, 82944
  s_mov_b32 s28, 2654208
  buffer_load_dwordx4 v119, s[72:75], s28 offen nt lds
  s_add_u32 m0, s38, 83968
  s_mov_b32 s28, 2686976
  buffer_load_dwordx4 v119, s[72:75], s28 offen nt lds
  s_add_u32 m0, s38, 84992
  s_mov_b32 s28, 2719744
  buffer_load_dwordx4 v119, s[72:75], s28 offen nt lds
  v_xor_b32 v116, 0, v121
  ds_read_b128 v[68:71], v116 offset:32768
  v_xor_b32 v116, 64, v121
  ds_read_b128 v[72:75], v116 offset:36864
  v_xor_b32 v116, 128, v121
  ds_read_b128 v[76:79], v116 offset:40960
  v_xor_b32 v116, 192, v121
  ds_read_b128 v[80:83], v116 offset:45056
  s_waitcnt lgkmcnt(0)
  v_perm_b32 v84, v69, v68, s80
  v_perm_b32 v85, v71, v70, s80
  v_perm_b32 v86, v69, v68, s81
  v_perm_b32 v87, v71, v70, s81
  v_xor_b32 v116, 0, v121
  ds_write_b128 v116, v[84:87] offset:32768
  v_perm_b32 v88, v73, v72, s80
  v_perm_b32 v89, v75, v74, s80
  v_perm_b32 v90, v73, v72, s81
  v_perm_b32 v91, v75, v74, s81
  v_xor_b32 v116, 64, v121
  ds_write_b128 v116, v[88:91] offset:36864
  v_perm_b32 v92, v77, v76, s80
  v_perm_b32 v93, v79, v78, s80
  v_perm_b32 v94, v77, v76, s81
  v_perm_b32 v95, v79, v78, s81
  v_xor_b32 v116, 128, v121
  ds_write_b128 v116, v[92:95] offset:40960
  v_perm_b32 v96, v81, v80, s80
  v_perm_b32 v97, v83, v82, s80
  v_perm_b32 v98, v81, v80, s81
  v_perm_b32 v99, v83, v82, s81
  v_xor_b32 v116, 192, v121
  ds_write_b128 v116, v[96:99] offset:45056
  s_cmp_eq_u32 s4, 0
  s_cbranch_scc0 L_lw_74
  ds_read_b64_tr_b16 a[32:33], v122 offset:32768
  ds_read_b64_tr_b16 a[34:35], v122 offset:33024
  ds_read_b64_tr_b16 a[36:37], v122 offset:34816
  ds_read_b64_tr_b16 a[38:39], v122 offset:35072
  ds_read_b64_tr_b16 a[40:41], v122 offset:32776
  ds_read_b64_tr_b16 a[42:43], v122 offset:33032
  ds_read_b64_tr_b16 a[44:45], v122 offset:34824
  ds_read_b64_tr_b16 a[46:47], v122 offset:35080
  s_branch L_lw_73
L_lw_74:
  s_cmp_eq_u32 s4, 1
  s_cbranch_scc0 L_lw_75
  ds_read_b64_tr_b16 a[0:1], v122 offset:32768
  ds_read_b64_tr_b16 a[2:3], v122 offset:33024
  ds_read_b64_tr_b16 a[4:5], v122 offset:34816
  ds_read_b64_tr_b16 a[6:7], v122 offset:35072
  ds_read_b64_tr_b16 a[8:9], v122 offset:32776
  ds_read_b64_tr_b16 a[10:11], v122 offset:33032
  ds_read_b64_tr_b16 a[12:13], v122 offset:34824
  ds_read_b64_tr_b16 a[14:15], v122 offset:35080
  s_branch L_lw_73
L_lw_75:
  s_cmp_eq_u32 s4, 2
  s_cbranch_scc0 L_lw_76
  ds_read_b64_tr_b16 v[36:37], v122 offset:32768
  ds_read_b64_tr_b16 v[38:39], v122 offset:33024
  ds_read_b64_tr_b16 v[40:41], v122 offset:34816
  ds_read_b64_tr_b16 v[42:43], v122 offset:35072
  ds_read_b64_tr_b16 v[44:45], v122 offset:32776
  ds_read_b64_tr_b16 v[46:47], v122 offset:33032
  ds_read_b64_tr_b16 v[48:49], v122 offset:34824
  ds_read_b64_tr_b16 v[50:51], v122 offset:35080
  s_branch L_lw_73
L_lw_76:
  ds_read_b64_tr_b16 v[68:69], v122 offset:32768
  ds_read_b64_tr_b16 v[70:71], v122 offset:33024
  ds_read_b64_tr_b16 v[72:73], v122 offset:34816
  ds_read_b64_tr_b16 v[74:75], v122 offset:35072
  ds_read_b64_tr_b16 v[76:77], v122 offset:32776
  ds_read_b64_tr_b16 v[78:79], v122 offset:33032
  ds_read_b64_tr_b16 v[80:81], v122 offset:34824
  ds_read_b64_tr_b16 v[82:83], v122 offset:35080
  s_waitcnt lgkmcnt(0)
  ds_write_b128 v118, v[68:71] offset:4096
  ds_write_b128 v118, v[72:75] offset:5120
  ds_write_b128 v118, v[76:79] offset:6144
  ds_write_b128 v118, v[80:83] offset:7168
L_lw_73:
  s_waitcnt lgkmcnt(0)
  s_waitcnt vmcnt(24)
  s_barrier
  s_add_u32 m0, s38, 98304
  s_mov_b32 s28, 3145728
  buffer_load_dwordx4 v119, s[72:75], s28 offen nt lds
  s_add_u32 m0, s38, 99328
  s_mov_b32 s28, 3178496
  buffer_load_dwordx4 v119, s[72:75], s28 offen nt lds
  s_add_u32 m0, s38, 100352
  s_mov_b32 s28, 3211264
  buffer_load_dwordx4 v119, s[72:75], s28 offen nt lds
  s_add_u32 m0, s38, 101376
  s_mov_b32 s28, 3244032
  buffer_load_dwordx4 v119, s[72:75], s28 offen nt lds
  v_xor_b32 v116, 0, v121
  ds_read_b128 v[68:71], v116 offset:49152
  v_xor_b32 v116, 64, v121
  ds_read_b128 v[72:75], v116 offset:53248
  v_xor_b32 v116, 128, v121
  ds_read_b128 v[76:79], v116 offset:57344
  v_xor_b32 v116, 192, v121
  ds_read_b128 v[80:83], v116 offset:61440
  s_waitcnt lgkmcnt(0)
  v_perm_b32 v84, v69, v68, s80
  v_perm_b32 v85, v71, v70, s80
  v_perm_b32 v86, v69, v68, s81
  v_perm_b32 v87, v71, v70, s81
  v_xor_b32 v116, 0, v121
  ds_write_b128 v116, v[84:87] offset:49152
  v_perm_b32 v88, v73, v72, s80
  v_perm_b32 v89, v75, v74, s80
  v_perm_b32 v90, v73, v72, s81
  v_perm_b32 v91, v75, v74, s81
  v_xor_b32 v116, 64, v121
  ds_write_b128 v116, v[88:91] offset:53248
  v_perm_b32 v92, v77, v76, s80
  v_perm_b32 v93, v79, v78, s80
  v_perm_b32 v94, v77, v76, s81
  v_perm_b32 v95, v79, v78, s81
  v_xor_b32 v116, 128, v121
  ds_write_b128 v116, v[92:95] offset:57344
  v_perm_b32 v96, v81, v80, s80
  v_perm_b32 v97, v83, v82, s80
  v_perm_b32 v98, v81, v80, s81
  v_perm_b32 v99, v83, v82, s81
  v_xor_b32 v116, 192, v121
  ds_write_b128 v116, v[96:99] offset:61440
  s_cmp_eq_u32 s4, 0
  s_cbranch_scc0 L_lw_79
  ds_read_b64_tr_b16 a[48:49], v122 offset:49152
  ds_read_b64_tr_b16 a[50:51], v122 offset:49408
  ds_read_b64_tr_b16 a[52:53], v122 offset:51200
  ds_read_b64_tr_b16 a[54:55], v122 offset:51456
  ds_read_b64_tr_b16 a[56:57], v122 offset:49160
  ds_read_b64_tr_b16 a[58:59], v122 offset:49416
  ds_read_b64_tr_b16 a[60:61], v122 offset:51208
  ds_read_b64_tr_b16 a[62:63], v122 offset:51464
  s_branch L_lw_78
L_lw_79:
  s_cmp_eq_u32 s4, 1
  s_cbranch_scc0 L_lw_80
  ds_read_b64_tr_b16 a[16:17], v122 offset:49152
  ds_read_b64_tr_b16 a[18:19], v122 offset:49408
  ds_read_b64_tr_b16 a[20:21], v122 offset:51200
  ds_read_b64_tr_b16 a[22:23], v122 offset:51456
  ds_read_b64_tr_b16 a[24:25], v122 offset:49160
  ds_read_b64_tr_b16 a[26:27], v122 offset:49416
  ds_read_b64_tr_b16 a[28:29], v122 offset:51208
  ds_read_b64_tr_b16 a[30:31], v122 offset:51464
  s_branch L_lw_78
L_lw_80:
  s_cmp_eq_u32 s4, 2
  s_cbranch_scc0 L_lw_81
  ds_read_b64_tr_b16 v[52:53], v122 offset:49152
  ds_read_b64_tr_b16 v[54:55], v122 offset:49408
  ds_read_b64_tr_b16 v[56:57], v122 offset:51200
  ds_read_b64_tr_b16 v[58:59], v122 offset:51456
  ds_read_b64_tr_b16 v[60:61], v122 offset:49160
  ds_read_b64_tr_b16 v[62:63], v122 offset:49416
  ds_read_b64_tr_b16 v[64:65], v122 offset:51208
  ds_read_b64_tr_b16 v[66:67], v122 offset:51464
  s_branch L_lw_78
L_lw_81:
  ds_read_b64_tr_b16 v[240:241], v122 offset:49152
  ds_read_b64_tr_b16 v[242:243], v122 offset:49408
  ds_read_b64_tr_b16 v[244:245], v122 offset:51200
  ds_read_b64_tr_b16 v[246:247], v122 offset:51456
  ds_read_b64_tr_b16 v[248:249], v122 offset:49160
  ds_read_b64_tr_b16 v[250:251], v122 offset:49416
  ds_read_b64_tr_b16 v[252:253], v122 offset:51208
  ds_read_b64_tr_b16 v[254:255], v122 offset:51464
L_lw_78:
  s_waitcnt lgkmcnt(0)
  s_waitcnt vmcnt(24)
  s_barrier
  s_add_u32 m0, s38, 114688
  s_mov_b32 s28, 3670016
  buffer_load_dwordx4 v119, s[72:75], s28 offen nt lds
  s_add_u32 m0, s38, 115712
  s_mov_b32 s28, 3702784
  buffer_load_dwordx4 v119, s[72:75], s28 offen nt lds
  s_add_u32 m0, s38, 116736
  s_mov_b32 s28, 3735552
  buffer_load_dwordx4 v119, s[72:75], s28 offen nt lds
  s_add_u32 m0, s38, 117760
  s_mov_b32 s28, 3768320
  buffer_load_dwordx4 v119, s[72:75], s28 offen nt lds
  v_add_u32 v121, 4294901760, v121
  v_add_u32 v122, 4294901760, v122
  v_add_u32 v124, 4294901760, v124
  v_add_u32 v125, 4294901760, v125
  v_add_u32 v126, 4294901760, v126
  s_cmp_eq_u32 s4, 0
  s_cbranch_scc0 L_lw_84
  ds_read_b64_tr_b16 a[64:65], v124 offset:0
  ds_read_b64_tr_b16 a[66:67], v124 offset:256
  ds_read_b64_tr_b16 a[68:69], v124 offset:2048
  ds_read_b64_tr_b16 a[70:71], v124 offset:2304
  ds_read_b64_tr_b16 a[72:73], v125 offset:0
  ds_read_b64_tr_b16 a[74:75], v125 offset:256
  ds_read_b64_tr_b16 a[76:77], v125 offset:2048
  ds_read_b64_tr_b16 a[78:79], v125 offset:2304
  s_branch L_lw_83
L_lw_84:
  s_cmp_eq_u32 s4, 1
  s_cbranch_scc0 L_lw_85
  ds_read_b64_tr_b16 a[144:145], v124 offset:0
  ds_read_b64_tr_b16 a[146:147], v124 offset:256
  ds_read_b64_tr_b16 a[148:149], v124 offset:2048
  ds_read_b64_tr_b16 a[150:151], v124 offset:2304
  ds_read_b64_tr_b16 a[152:153], v125 offset:0
  ds_read_b64_tr_b16 a[154:155], v125 offset:256
  ds_read_b64_tr_b16 a[156:157], v125 offset:2048
  ds_read_b64_tr_b16 a[158:159], v125 offset:2304
  s_branch L_lw_83
L_lw_85:
  s_cmp_eq_u32 s4, 2
  s_cbranch_scc0 L_lw_86
  ds_read_b64_tr_b16 a[112:113], v124 offset:0
  ds_read_b64_tr_b16 a[114:115], v124 offset:256
  ds_read_b64_tr_b16 a[116:117], v124 offset:2048
  ds_read_b64_tr_b16 a[118:119], v124 offset:2304
  ds_read_b64_tr_b16 a[120:121], v125 offset:0
  ds_read_b64_tr_b16 a[122:123], v125 offset:256
  ds_read_b64_tr_b16 a[124:125], v125 offset:2048
  ds_read_b64_tr_b16 a[126:127], v125 offset:2304
  s_branch L_lw_83
L_lw_86:
  ds_read_b64_tr_b16 a[80:81], v124 offset:0
  ds_read_b64_tr_b16 a[82:83], v124 offset:256
  ds_read_b64_tr_b16 a[84:85], v124 offset:2048
  ds_read_b64_tr_b16 a[86:87], v124 offset:2304
  ds_read_b64_tr_b16 a[88:89], v125 offset:0
  ds_read_b64_tr_b16 a[90:91], v125 offset:256
  ds_read_b64_tr_b16 a[92:93], v125 offset:2048
  ds_read_b64_tr_b16 a[94:95], v125 offset:2304
L_lw_83:
  s_waitcnt lgkmcnt(0)
  s_waitcnt vmcnt(24)
  s_barrier
  s_add_u32 m0, s38, 0
  s_mov_b32 s28, 0
  buffer_load_dwordx4 v120, s[76:79], s28 offen nt lds
  s_add_u32 m0, s38, 1024
  s_mov_b32 s28, 4096
  buffer_load_dwordx4 v120, s[76:79], s28 offen nt lds
  s_add_u32 m0, s38, 2048
  s_mov_b32 s28, 8192
  buffer_load_dwordx4 v120, s[76:79], s28 offen nt lds
  s_add_u32 m0, s38, 3072
  s_mov_b32 s28, 12288
  buffer_load_dwordx4 v120, s[76:79], s28 offen nt lds
  s_cmp_eq_u32 s4, 0
  s_cbranch_scc0 L_lw_89
  ds_read_b64_tr_b16 v[20:21], v124 offset:16384
  ds_read_b64_tr_b16 v[22:23], v124 offset:16640
  ds_read_b64_tr_b16 v[24:25], v124 offset:18432
  ds_read_b64_tr_b16 v[26:27], v124 offset:18688
  ds_read_b64_tr_b16 v[28:29], v125 offset:16384
  ds_read_b64_tr_b16 v[30:31], v125 offset:16640
  ds_read_b64_tr_b16 v[32:33], v125 offset:18432
  ds_read_b64_tr_b16 v[34:35], v125 offset:18688
  s_branch L_lw_88
L_lw_89:
  s_cmp_eq_u32 s4, 1
  s_cbranch_scc0 L_lw_90
  ds_read_b64_tr_b16 a[160:161], v124 offset:16384
  ds_read_b64_tr_b16 a[162:163], v124 offset:16640
  ds_read_b64_tr_b16 a[164:165], v124 offset:18432
  ds_read_b64_tr_b16 a[166:167], v124 offset:18688
  ds_read_b64_tr_b16 a[168:169], v125 offset:16384
  ds_read_b64_tr_b16 a[170:171], v125 offset:16640
  ds_read_b64_tr_b16 a[172:173], v125 offset:18432
  ds_read_b64_tr_b16 a[174:175], v125 offset:18688
  s_branch L_lw_88
L_lw_90:
  s_cmp_eq_u32 s4, 2
  s_cbranch_scc0 L_lw_91
  ds_read_b64_tr_b16 a[128:129], v124 offset:16384
  ds_read_b64_tr_b16 a[130:131], v124 offset:16640
  ds_read_b64_tr_b16 a[132:133], v124 offset:18432
  ds_read_b64_tr_b16 a[134:135], v124 offset:18688
  ds_read_b64_tr_b16 a[136:137], v125 offset:16384
  ds_read_b64_tr_b16 a[138:139], v125 offset:16640
  ds_read_b64_tr_b16 a[140:141], v125 offset:18432
  ds_read_b64_tr_b16 a[142:143], v125 offset:18688
  s_branch L_lw_88
L_lw_91:
  ds_read_b64_tr_b16 a[96:97], v124 offset:16384
  ds_read_b64_tr_b16 a[98:99], v124 offset:16640
  ds_read_b64_tr_b16 a[100:101], v124 offset:18432
  ds_read_b64_tr_b16 a[102:103], v124 offset:18688
  ds_read_b64_tr_b16 a[104:105], v125 offset:16384
  ds_read_b64_tr_b16 a[106:107], v125 offset:16640
  ds_read_b64_tr_b16 a[108:109], v125 offset:18432
  ds_read_b64_tr_b16 a[110:111], v125 offset:18688
L_lw_88:
  s_waitcnt lgkmcnt(0)
  s_waitcnt vmcnt(24)
  s_barrier
  s_add_u32 m0, s38, 16384
  s_mov_b32 s28, 256
  buffer_load_dwordx4 v120, s[76:79], s28 offen nt lds
  s_add_u32 m0, s38, 17408
  s_mov_b32 s28, 4352
  buffer_load_dwordx4 v120, s[76:79], s28 offen nt lds
  s_add_u32 m0, s38, 18432
  s_mov_b32 s28, 8448
  buffer_load_dwordx4 v120, s[76:79], s28 offen nt lds
  s_add_u32 m0, s38, 19456
  s_mov_b32 s28, 12544
  buffer_load_dwordx4 v120, s[76:79], s28 offen nt lds
  s_cmp_eq_u32 s4, 0
  s_cbranch_scc0 L_lw_94
  ds_read_b64_tr_b16 a[80:81], v124 offset:32768
  ds_read_b64_tr_b16 a[82:83], v124 offset:33024
  ds_read_b64_tr_b16 a[84:85], v124 offset:34816
  ds_read_b64_tr_b16 a[86:87], v124 offset:35072
  ds_read_b64_tr_b16 a[88:89], v125 offset:32768
  ds_read_b64_tr_b16 a[90:91], v125 offset:33024
  ds_read_b64_tr_b16 a[92:93], v125 offset:34816
  ds_read_b64_tr_b16 a[94:95], v125 offset:35072
  s_branch L_lw_93
L_lw_94:
  s_cmp_eq_u32 s4, 1
  s_cbranch_scc0 L_lw_95
  ds_read_b64_tr_b16 a[64:65], v124 offset:32768
  ds_read_b64_tr_b16 a[66:67], v124 offset:33024
  ds_read_b64_tr_b16 a[68:69], v124 offset:34816
  ds_read_b64_tr_b16 a[70:71], v124 offset:35072
  ds_read_b64_tr_b16 a[72:73], v125 offset:32768
  ds_read_b64_tr_b16 a[74:75], v125 offset:33024
  ds_read_b64_tr_b16 a[76:77], v125 offset:34816
  ds_read_b64_tr_b16 a[78:79], v125 offset:35072
  s_branch L_lw_93
L_lw_95:
  s_cmp_eq_u32 s4, 2
  s_cbranch_scc0 L_lw_96
  ds_read_b64_tr_b16 a[144:145], v124 offset:32768
  ds_read_b64_tr_b16 a[146:147], v124 offset:33024
  ds_read_b64_tr_b16 a[148:149], v124 offset:34816
  ds_read_b64_tr_b16 a[150:151], v124 offset:35072
  ds_read_b64_tr_b16 a[152:153], v125 offset:32768
  ds_read_b64_tr_b16 a[154:155], v125 offset:33024
  ds_read_b64_tr_b16 a[156:157], v125 offset:34816
  ds_read_b64_tr_b16 a[158:159], v125 offset:35072
  s_branch L_lw_93
L_lw_96:
  ds_read_b64_tr_b16 a[112:113], v124 offset:32768
  ds_read_b64_tr_b16 a[114:115], v124 offset:33024
  ds_read_b64_tr_b16 a[116:117], v124 offset:34816
  ds_read_b64_tr_b16 a[118:119], v124 offset:35072
  ds_read_b64_tr_b16 a[120:121], v125 offset:32768
  ds_read_b64_tr_b16 a[122:123], v125 offset:33024
  ds_read_b64_tr_b16 a[124:125], v125 offset:34816
  ds_read_b64_tr_b16 a[126:127], v125 offset:35072
L_lw_93:
  s_waitcnt lgkmcnt(0)
  s_waitcnt vmcnt(24)
  s_barrier
  s_add_u32 m0, s38, 32768
  s_mov_b32 s28, 512
  buffer_load_dwordx4 v120, s[76:79], s28 offen nt lds
  s_add_u32 m0, s38, 33792
  s_mov_b32 s28, 4608
  buffer_load_dwordx4 v120, s[76:79], s28 offen nt lds
  s_add_u32 m0, s38, 34816
  s_mov_b32 s28, 8704
  buffer_load_dwordx4 v120, s[76:79], s28 offen nt lds
  s_add_u32 m0, s38, 35840
  s_mov_b32 s28, 12800
  buffer_load_dwordx4 v120, s[76:79], s28 offen nt lds
  s_cmp_eq_u32 s4, 0
  s_cbranch_scc0 L_lw_99
  ds_read_b64_tr_b16 a[96:97], v124 offset:49152
  ds_read_b64_tr_b16 a[98:99], v124 offset:49408
  ds_read_b64_tr_b16 a[100:101], v124 offset:51200
  ds_read_b64_tr_b16 a[102:103], v124 offset:51456
  ds_read_b64_tr_b16 a[104:105], v125 offset:49152
  ds_read_b64_tr_b16 a[106:107], v125 offset:49408
  ds_read_b64_tr_b16 a[108:109], v125 offset:51200
  ds_read_b64_tr_b16 a[110:111], v125 offset:51456
  s_branch L_lw_98
L_lw_99:
  s_cmp_eq_u32 s4, 1
  s_cbranch_scc0 L_lw_100
  ds_read_b64_tr_b16 v[20:21], v124 offset:49152
  ds_read_b64_tr_b16 v[22:23], v124 offset:49408
  ds_read_b64_tr_b16 v[24:25], v124 offset:51200
  ds_read_b64_tr_b16 v[26:27], v124 offset:51456
  ds_read_b64_tr_b16 v[28:29], v125 offset:49152
  ds_read_b64_tr_b16 v[30:31], v125 offset:49408
  ds_read_b64_tr_b16 v[32:33], v125 offset:51200
  ds_read_b64_tr_b16 v[34:35], v125 offset:51456
  s_branch L_lw_98
L_lw_100:
  s_cmp_eq_u32 s4, 2
  s_cbranch_scc0 L_lw_101
  ds_read_b64_tr_b16 a[160:161], v124 offset:49152
  ds_read_b64_tr_b16 a[162:163], v124 offset:49408
  ds_read_b64_tr_b16 a[164:165], v124 offset:51200
  ds_read_b64_tr_b16 a[166:167], v124 offset:51456
  ds_read_b64_tr_b16 a[168:169], v125 offset:49152
  ds_read_b64_tr_b16 a[170:171], v125 offset:49408
  ds_read_b64_tr_b16 a[172:173], v125 offset:51200
  ds_read_b64_tr_b16 a[174:175], v125 offset:51456
  s_branch L_lw_98
L_lw_101:
  ds_read_b64_tr_b16 a[128:129], v124 offset:49152
  ds_read_b64_tr_b16 a[130:131], v124 offset:49408
  ds_read_b64_tr_b16 a[132:133], v124 offset:51200
  ds_read_b64_tr_b16 a[134:135], v124 offset:51456
  ds_read_b64_tr_b16 a[136:137], v125 offset:49152
  ds_read_b64_tr_b16 a[138:139], v125 offset:49408
  ds_read_b64_tr_b16 a[140:141], v125 offset:51200
  ds_read_b64_tr_b16 a[142:143], v125 offset:51456
L_lw_98:
  s_waitcnt lgkmcnt(0)
  s_waitcnt vmcnt(24)
  s_barrier
  s_add_u32 m0, s38, 49152
  s_mov_b32 s28, 768
  buffer_load_dwordx4 v120, s[76:79], s28 offen nt lds
  s_add_u32 m0, s38, 50176
  s_mov_b32 s28, 4864
  buffer_load_dwordx4 v120, s[76:79], s28 offen nt lds
  s_add_u32 m0, s38, 51200
  s_mov_b32 s28, 8960
  buffer_load_dwordx4 v120, s[76:79], s28 offen nt lds
  s_add_u32 m0, s38, 52224
  s_mov_b32 s28, 13056
  buffer_load_dwordx4 v120, s[76:79], s28 offen nt lds
  v_add_u32 v121, 65536, v121
  v_add_u32 v122, 65536, v122
  v_add_u32 v124, 65536, v124
  v_add_u32 v125, 65536, v125
  v_add_u32 v126, 65536, v126
  s_cmp_eq_u32 s4, 0
  s_cbranch_scc0 L_lw_104
  ds_read_b64_tr_b16 a[112:113], v124 offset:0
  ds_read_b64_tr_b16 a[114:115], v124 offset:256
  ds_read_b64_tr_b16 a[116:117], v124 offset:2048
  ds_read_b64_tr_b16 a[118:119], v124 offset:2304
  ds_read_b64_tr_b16 a[120:121], v125 offset:0
  ds_read_b64_tr_b16 a[122:123], v125 offset:256
  ds_read_b64_tr_b16 a[124:125], v125 offset:2048
  ds_read_b64_tr_b16 a[126:127], v125 offset:2304
  s_branch L_lw_103
L_lw_104:
  s_cmp_eq_u32 s4, 1
  s_cbranch_scc0 L_lw_105
  ds_read_b64_tr_b16 a[80:81], v124 offset:0
  ds_read_b64_tr_b16 a[82:83], v124 offset:256
  ds_read_b64_tr_b16 a[84:85], v124 offset:2048
  ds_read_b64_tr_b16 a[86:87], v124 offset:2304
  ds_read_b64_tr_b16 a[88:89], v125 offset:0
  ds_read_b64_tr_b16 a[90:91], v125 offset:256
  ds_read_b64_tr_b16 a[92:93], v125 offset:2048
  ds_read_b64_tr_b16 a[94:95], v125 offset:2304
  s_branch L_lw_103
L_lw_105:
  s_cmp_eq_u32 s4, 2
  s_cbranch_scc0 L_lw_106
  ds_read_b64_tr_b16 a[64:65], v124 offset:0
  ds_read_b64_tr_b16 a[66:67], v124 offset:256
  ds_read_b64_tr_b16 a[68:69], v124 offset:2048
  ds_read_b64_tr_b16 a[70:71], v124 offset:2304
  ds_read_b64_tr_b16 a[72:73], v125 offset:0
  ds_read_b64_tr_b16 a[74:75], v125 offset:256
  ds_read_b64_tr_b16 a[76:77], v125 offset:2048
  ds_read_b64_tr_b16 a[78:79], v125 offset:2304
  s_branch L_lw_103
L_lw_106:
  ds_read_b64_tr_b16 a[144:145], v124 offset:0
  ds_read_b64_tr_b16 a[146:147], v124 offset:256
  ds_read_b64_tr_b16 a[148:149], v124 offset:2048
  ds_read_b64_tr_b16 a[150:151], v124 offset:2304
  ds_read_b64_tr_b16 a[152:153], v125 offset:0
  ds_read_b64_tr_b16 a[154:155], v125 offset:256
  ds_read_b64_tr_b16 a[156:157], v125 offset:2048
  ds_read_b64_tr_b16 a[158:159], v125 offset:2304
L_lw_103:
  s_waitcnt lgkmcnt(0)
  s_waitcnt vmcnt(24)
  s_barrier
  s_add_u32 m0, s38, 65536
  s_mov_b32 s28, 65536
  buffer_load_dwordx4 v120, s[76:79], s28 offen nt lds
  s_add_u32 m0, s38, 66560
  s_mov_b32 s28, 69632
  buffer_load_dwordx4 v120, s[76:79], s28 offen nt lds
  s_add_u32 m0, s38, 67584
  s_mov_b32 s28, 73728
  buffer_load_dwordx4 v120, s[76:79], s28 offen nt lds
  s_add_u32 m0, s38, 68608
  s_mov_b32 s28, 77824
  buffer_load_dwordx4 v120, s[76:79], s28 offen nt lds
  s_cmp_eq_u32 s4, 0
  s_cbranch_scc0 L_lw_109
  ds_read_b64_tr_b16 a[128:129], v124 offset:16384
  ds_read_b64_tr_b16 a[130:131], v124 offset:16640
  ds_read_b64_tr_b16 a[132:133], v124 offset:18432
  ds_read_b64_tr_b16 a[134:135], v124 offset:18688
  ds_read_b64_tr_b16 a[136:137], v125 offset:16384
  ds_read_b64_tr_b16 a[138:139], v125 offset:16640
  ds_read_b64_tr_b16 a[140:141], v125 offset:18432
  ds_read_b64_tr_b16 a[142:143], v125 offset:18688
  s_branch L_lw_108
L_lw_109:
  s_cmp_eq_u32 s4, 1
  s_cbranch_scc0 L_lw_110
  ds_read_b64_tr_b16 a[96:97], v124 offset:16384
  ds_read_b64_tr_b16 a[98:99], v124 offset:16640
  ds_read_b64_tr_b16 a[100:101], v124 offset:18432
  ds_read_b64_tr_b16 a[102:103], v124 offset:18688
  ds_read_b64_tr_b16 a[104:105], v125 offset:16384
  ds_read_b64_tr_b16 a[106:107], v125 offset:16640
  ds_read_b64_tr_b16 a[108:109], v125 offset:18432
  ds_read_b64_tr_b16 a[110:111], v125 offset:18688
  s_branch L_lw_108
L_lw_110:
  s_cmp_eq_u32 s4, 2
  s_cbranch_scc0 L_lw_111
  ds_read_b64_tr_b16 v[20:21], v124 offset:16384
  ds_read_b64_tr_b16 v[22:23], v124 offset:16640
  ds_read_b64_tr_b16 v[24:25], v124 offset:18432
  ds_read_b64_tr_b16 v[26:27], v124 offset:18688
  ds_read_b64_tr_b16 v[28:29], v125 offset:16384
  ds_read_b64_tr_b16 v[30:31], v125 offset:16640
  ds_read_b64_tr_b16 v[32:33], v125 offset:18432
  ds_read_b64_tr_b16 v[34:35], v125 offset:18688
  s_branch L_lw_108
L_lw_111:
  ds_read_b64_tr_b16 a[160:161], v124 offset:16384
  ds_read_b64_tr_b16 a[162:163], v124 offset:16640
  ds_read_b64_tr_b16 a[164:165], v124 offset:18432
  ds_read_b64_tr_b16 a[166:167], v124 offset:18688
  ds_read_b64_tr_b16 a[168:169], v125 offset:16384
  ds_read_b64_tr_b16 a[170:171], v125 offset:16640
  ds_read_b64_tr_b16 a[172:173], v125 offset:18432
  ds_read_b64_tr_b16 a[174:175], v125 offset:18688
L_lw_108:
  s_waitcnt lgkmcnt(0)
  s_waitcnt vmcnt(24)
  s_barrier
  s_add_u32 m0, s38, 81920
  s_mov_b32 s28, 65792
  buffer_load_dwordx4 v120, s[76:79], s28 offen nt lds
  s_add_u32 m0, s38, 82944
  s_mov_b32 s28, 69888
  buffer_load_dwordx4 v120, s[76:79], s28 offen nt lds
  s_add_u32 m0, s38, 83968
  s_mov_b32 s28, 73984
  buffer_load_dwordx4 v120, s[76:79], s28 offen nt lds
  s_add_u32 m0, s38, 84992
  s_mov_b32 s28, 78080
  buffer_load_dwordx4 v120, s[76:79], s28 offen nt lds
  s_cmp_eq_u32 s4, 0
  s_cbranch_scc0 L_lw_114
  ds_read_b64_tr_b16 a[144:145], v124 offset:32768
  ds_read_b64_tr_b16 a[146:147], v124 offset:33024
  ds_read_b64_tr_b16 a[148:149], v124 offset:34816
  ds_read_b64_tr_b16 a[150:151], v124 offset:35072
  ds_read_b64_tr_b16 a[152:153], v125 offset:32768
  ds_read_b64_tr_b16 a[154:155], v125 offset:33024
  ds_read_b64_tr_b16 a[156:157], v125 offset:34816
  ds_read_b64_tr_b16 a[158:159], v125 offset:35072
  s_branch L_lw_113
L_lw_114:
  s_cmp_eq_u32 s4, 1
  s_cbranch_scc0 L_lw_115
  ds_read_b64_tr_b16 a[112:113], v124 offset:32768
  ds_read_b64_tr_b16 a[114:115], v124 offset:33024
  ds_read_b64_tr_b16 a[116:117], v124 offset:34816
  ds_read_b64_tr_b16 a[118:119], v124 offset:35072
  ds_read_b64_tr_b16 a[120:121], v125 offset:32768
  ds_read_b64_tr_b16 a[122:123], v125 offset:33024
  ds_read_b64_tr_b16 a[124:125], v125 offset:34816
  ds_read_b64_tr_b16 a[126:127], v125 offset:35072
  s_branch L_lw_113
L_lw_115:
  s_cmp_eq_u32 s4, 2
  s_cbranch_scc0 L_lw_116
  ds_read_b64_tr_b16 a[80:81], v124 offset:32768
  ds_read_b64_tr_b16 a[82:83], v124 offset:33024
  ds_read_b64_tr_b16 a[84:85], v124 offset:34816
  ds_read_b64_tr_b16 a[86:87], v124 offset:35072
  ds_read_b64_tr_b16 a[88:89], v125 offset:32768
  ds_read_b64_tr_b16 a[90:91], v125 offset:33024
  ds_read_b64_tr_b16 a[92:93], v125 offset:34816
  ds_read_b64_tr_b16 a[94:95], v125 offset:35072
  s_branch L_lw_113
L_lw_116:
  ds_read_b64_tr_b16 a[64:65], v124 offset:32768
  ds_read_b64_tr_b16 a[66:67], v124 offset:33024
  ds_read_b64_tr_b16 a[68:69], v124 offset:34816
  ds_read_b64_tr_b16 a[70:71], v124 offset:35072
  ds_read_b64_tr_b16 a[72:73], v125 offset:32768
  ds_read_b64_tr_b16 a[74:75], v125 offset:33024
  ds_read_b64_tr_b16 a[76:77], v125 offset:34816
  ds_read_b64_tr_b16 a[78:79], v125 offset:35072
L_lw_113:
  s_waitcnt lgkmcnt(0)
  s_waitcnt vmcnt(24)
  s_barrier
  s_add_u32 m0, s38, 98304
  s_mov_b32 s28, 66048
  buffer_load_dwordx4 v120, s[76:79], s28 offen nt lds
  s_add_u32 m0, s38, 99328
  s_mov_b32 s28, 70144
  buffer_load_dwordx4 v120, s[76:79], s28 offen nt lds
  s_add_u32 m0, s38, 100352
  s_mov_b32 s28, 74240
  buffer_load_dwordx4 v120, s[76:79], s28 offen nt lds
  s_add_u32 m0, s38, 101376
  s_mov_b32 s28, 78336
  buffer_load_dwordx4 v120, s[76:79], s28 offen nt lds
  s_cmp_eq_u32 s4, 0
  s_cbranch_scc0 L_lw_119
  ds_read_b64_tr_b16 a[160:161], v124 offset:49152
  ds_read_b64_tr_b16 a[162:163], v124 offset:49408
  ds_read_b64_tr_b16 a[164:165], v124 offset:51200
  ds_read_b64_tr_b16 a[166:167], v124 offset:51456
  ds_read_b64_tr_b16 a[168:169], v125 offset:49152
  ds_read_b64_tr_b16 a[170:171], v125 offset:49408
  ds_read_b64_tr_b16 a[172:173], v125 offset:51200
  ds_read_b64_tr_b16 a[174:175], v125 offset:51456
  s_branch L_lw_118
L_lw_119:
  s_cmp_eq_u32 s4, 1
  s_cbranch_scc0 L_lw_120
  ds_read_b64_tr_b16 a[128:129], v124 offset:49152
  ds_read_b64_tr_b16 a[130:131], v124 offset:49408
  ds_read_b64_tr_b16 a[132:133], v124 offset:51200
  ds_read_b64_tr_b16 a[134:135], v124 offset:51456
  ds_read_b64_tr_b16 a[136:137], v125 offset:49152
  ds_read_b64_tr_b16 a[138:139], v125 offset:49408
  ds_read_b64_tr_b16 a[140:141], v125 offset:51200
  ds_read_b64_tr_b16 a[142:143], v125 offset:51456
  s_branch L_lw_118
L_lw_120:
  s_cmp_eq_u32 s4, 2
  s_cbranch_scc0 L_lw_121
  ds_read_b64_tr_b16 a[96:97], v124 offset:49152
  ds_read_b64_tr_b16 a[98:99], v124 offset:49408
  ds_read_b64_tr_b16 a[100:101], v124 offset:51200
  ds_read_b64_tr_b16 a[102:103], v124 offset:51456
  ds_read_b64_tr_b16 a[104:105], v125 offset:49152
  ds_read_b64_tr_b16 a[106:107], v125 offset:49408
  ds_read_b64_tr_b16 a[108:109], v125 offset:51200
  ds_read_b64_tr_b16 a[110:111], v125 offset:51456
  s_branch L_lw_118
L_lw_121:
  ds_read_b64_tr_b16 v[20:21], v124 offset:49152
  ds_read_b64_tr_b16 v[22:23], v124 offset:49408
  ds_read_b64_tr_b16 v[24:25], v124 offset:51200
  ds_read_b64_tr_b16 v[26:27], v124 offset:51456
  ds_read_b64_tr_b16 v[28:29], v125 offset:49152
  ds_read_b64_tr_b16 v[30:31], v125 offset:49408
  ds_read_b64_tr_b16 v[32:33], v125 offset:51200
  ds_read_b64_tr_b16 v[34:35], v125 offset:51456
L_lw_118:
  s_waitcnt lgkmcnt(0)
  s_waitcnt vmcnt(24)
  s_barrier
  s_add_u32 m0, s38, 114688
  s_mov_b32 s28, 66304
  buffer_load_dwordx4 v120, s[76:79], s28 offen nt lds
  s_add_u32 m0, s38, 115712
  s_mov_b32 s28, 70400
  buffer_load_dwordx4 v120, s[76:79], s28 offen nt lds
  s_add_u32 m0, s38, 116736
  s_mov_b32 s28, 74496
  buffer_load_dwordx4 v120, s[76:79], s28 offen nt lds
  s_add_u32 m0, s38, 117760
  s_mov_b32 s28, 78592
  buffer_load_dwordx4 v120, s[76:79], s28 offen nt lds
  v_add_u32 v121, 4294901760, v121
  v_add_u32 v122, 4294901760, v122
  v_add_u32 v124, 4294901760, v124
  v_add_u32 v125, 4294901760, v125
  v_add_u32 v126, 4294901760, v126
  s_cmp_eq_u32 s4, 0
  s_cbranch_scc0 L_lo_123
  v_xor_b32 v127, 0, v126
  ds_read_b64_tr_b16 v[68:69], v127 offset:0
  ds_read_b64_tr_b16 v[70:71], v127 offset:512
  ds_read_b64_tr_b16 v[72:73], v127 offset:2048
  ds_read_b64_tr_b16 v[74:75], v127 offset:2560
  v_xor_b32 v127, 32, v126
  ds_read_b64_tr_b16 v[76:77], v127 offset:0
  ds_read_b64_tr_b16 v[78:79], v127 offset:512
  ds_read_b64_tr_b16 v[80:81], v127 offset:2048
  ds_read_b64_tr_b16 v[82:83], v127 offset:2560
  v_xor_b32 v127, 64, v126
  ds_read_b64_tr_b16 a[192:193], v127 offset:0
  ds_read_b64_tr_b16 a[194:195], v127 offset:512
  ds_read_b64_tr_b16 a[196:197], v127 offset:2048
  ds_read_b64_tr_b16 a[198:199], v127 offset:2560
  v_xor_b32 v127, 96, v126
  ds_read_b64_tr_b16 a[200:201], v127 offset:0
  ds_read_b64_tr_b16 a[202:203], v127 offset:512
  ds_read_b64_tr_b16 a[204:205], v127 offset:2048
  ds_read_b64_tr_b16 a[206:207], v127 offset:2560
  s_waitcnt lgkmcnt(0)
  v_xor_b32 v127, 128, v126
  ds_read_b64_tr_b16 a[224:225], v127 offset:0
  ds_read_b64_tr_b16 a[226:227], v127 offset:512
  ds_read_b64_tr_b16 a[228:229], v127 offset:2048
  ds_read_b64_tr_b16 a[230:231], v127 offset:2560
  v_xor_b32 v127, 160, v126
  ds_read_b64_tr_b16 a[232:233], v127 offset:0
  ds_read_b64_tr_b16 a[234:235], v127 offset:512
  ds_read_b64_tr_b16 a[236:237], v127 offset:2048
  ds_read_b64_tr_b16 a[238:239], v127 offset:2560
  v_xor_b32 v127, 192, v126
  ds_read_b64_tr_b16 v[84:85], v127 offset:0
  ds_read_b64_tr_b16 v[86:87], v127 offset:512
  ds_read_b64_tr_b16 v[88:89], v127 offset:2048
  ds_read_b64_tr_b16 v[90:91], v127 offset:2560
  v_xor_b32 v127, 224, v126
  ds_read_b64_tr_b16 v[92:93], v127 offset:0
  ds_read_b64_tr_b16 v[94:95], v127 offset:512
  ds_read_b64_tr_b16 v[96:97], v127 offset:2048
  ds_read_b64_tr_b16 v[98:99], v127 offset:2560
L_lo_123:
  s_waitcnt lgkmcnt(0)
  s_waitcnt vmcnt(24)
  s_barrier
  s_cmp_eq_u32 s4, 1
  s_cbranch_scc0 L_lo_124
  v_xor_b32 v127, 0, v126
  ds_read_b64_tr_b16 v[68:69], v127 offset:16384
  ds_read_b64_tr_b16 v[70:71], v127 offset:16896
  ds_read_b64_tr_b16 v[72:73], v127 offset:18432
  ds_read_b64_tr_b16 v[74:75], v127 offset:18944
  v_xor_b32 v127, 32, v126
  ds_read_b64_tr_b16 v[76:77], v127 offset:16384
  ds_read_b64_tr_b16 v[78:79], v127 offset:16896
  ds_read_b64_tr_b16 v[80:81], v127 offset:18432
  ds_read_b64_tr_b16 v[82:83], v127 offset:18944
  v_xor_b32 v127, 64, v126
  ds_read_b64_tr_b16 a[192:193], v127 offset:16384
  ds_read_b64_tr_b16 a[194:195], v127 offset:16896
  ds_read_b64_tr_b16 a[196:197], v127 offset:18432
  ds_read_b64_tr_b16 a[198:199], v127 offset:18944
  v_xor_b32 v127, 96, v126
  ds_read_b64_tr_b16 a[200:201], v127 offset:16384
  ds_read_b64_tr_b16 a[202:203], v127 offset:16896
  ds_read_b64_tr_b16 a[204:205], v127 offset:18432
  ds_read_b64_tr_b16 a[206:207], v127 offset:18944
  s_waitcnt lgkmcnt(0)
  v_xor_b32 v127, 128, v126
  ds_read_b64_tr_b16 a[224:225], v127 offset:16384
  ds_read_b64_tr_b16 a[226:227], v127 offset:16896
  ds_read_b64_tr_b16 a[228:229], v127 offset:18432
  ds_read_b64_tr_b16 a[230:231], v127 offset:18944
  v_xor_b32 v127, 160, v126
  ds_read_b64_tr_b16 a[232:233], v127 offset:16384
  ds_read_b64_tr_b16 a[234:235], v127 offset:16896
  ds_read_b64_tr_b16 a[236:237], v127 offset:18432
  ds_read_b64_tr_b16 a[238:239], v127 offset:18944
  v_xor_b32 v127, 192, v126
  ds_read_b64_tr_b16 v[84:85], v127 offset:16384
  ds_read_b64_tr_b16 v[86:87], v127 offset:16896
  ds_read_b64_tr_b16 v[88:89], v127 offset:18432
  ds_read_b64_tr_b16 v[90:91], v127 offset:18944
  v_xor_b32 v127, 224, v126
  ds_read_b64_tr_b16 v[92:93], v127 offset:16384
  ds_read_b64_tr_b16 v[94:95], v127 offset:16896
  ds_read_b64_tr_b16 v[96:97], v127 offset:18432
  ds_read_b64_tr_b16 v[98:99], v127 offset:18944
L_lo_124:
  s_waitcnt lgkmcnt(0)
  s_waitcnt vmcnt(20)
  s_barrier
  s_cmp_eq_u32 s4, 2
  s_cbranch_scc0 L_lo_125
  v_xor_b32 v127, 0, v126
  ds_read_b64_tr_b16 v[68:69], v127 offset:32768
  ds_read_b64_tr_b16 v[70:71], v127 offset:33280
  ds_read_b64_tr_b16 v[72:73], v127 offset:34816
  ds_read_b64_tr_b16 v[74:75], v127 offset:35328
  v_xor_b32 v127, 32, v126
  ds_read_b64_tr_b16 v[76:77], v127 offset:32768
  ds_read_b64_tr_b16 v[78:79], v127 offset:33280
  ds_read_b64_tr_b16 v[80:81], v127 offset:34816
  ds_read_b64_tr_b16 v[82:83], v127 offset:35328
  v_xor_b32 v127, 64, v126
  ds_read_b64_tr_b16 a[192:193], v127 offset:32768
  ds_read_b64_tr_b16 a[194:195], v127 offset:33280
  ds_read_b64_tr_b16 a[196:197], v127 offset:34816
  ds_read_b64_tr_b16 a[198:199], v127 offset:35328
  v_xor_b32 v127, 96, v126
  ds_read_b64_tr_b16 a[200:201], v127 offset:32768
  ds_read_b64_tr_b16 a[202:203], v127 offset:33280
  ds_read_b64_tr_b16 a[204:205], v127 offset:34816
  ds_read_b64_tr_b16 a[206:207], v127 offset:35328
  s_waitcnt lgkmcnt(0)
  v_xor_b32 v127, 128, v126
  ds_read_b64_tr_b16 a[224:225], v127 offset:32768
  ds_read_b64_tr_b16 a[226:227], v127 offset:33280
  ds_read_b64_tr_b16 a[228:229], v127 offset:34816
  ds_read_b64_tr_b16 a[230:231], v127 offset:35328
  v_xor_b32 v127, 160, v126
  ds_read_b64_tr_b16 a[232:233], v127 offset:32768
  ds_read_b64_tr_b16 a[234:235], v127 offset:33280
  ds_read_b64_tr_b16 a[236:237], v127 offset:34816
  ds_read_b64_tr_b16 a[238:239], v127 offset:35328
  v_xor_b32 v127, 192, v126
  ds_read_b64_tr_b16 v[84:85], v127 offset:32768
  ds_read_b64_tr_b16 v[86:87], v127 offset:33280
  ds_read_b64_tr_b16 v[88:89], v127 offset:34816
  ds_read_b64_tr_b16 v[90:91], v127 offset:35328
  v_xor_b32 v127, 224, v126
  ds_read_b64_tr_b16 v[92:93], v127 offset:32768
  ds_read_b64_tr_b16 v[94:95], v127 offset:33280
  ds_read_b64_tr_b16 v[96:97], v127 offset:34816
  ds_read_b64_tr_b16 v[98:99], v127 offset:35328
L_lo_125:
  s_waitcnt lgkmcnt(0)
  s_waitcnt vmcnt(16)
  s_barrier
  s_cmp_eq_u32 s4, 3
  s_cbranch_scc0 L_lo_126
  v_xor_b32 v127, 0, v126
  ds_read_b64_tr_b16 v[68:69], v127 offset:49152
  ds_read_b64_tr_b16 v[70:71], v127 offset:49664
  ds_read_b64_tr_b16 v[72:73], v127 offset:51200
  ds_read_b64_tr_b16 v[74:75], v127 offset:51712
  v_xor_b32 v127, 32, v126
  ds_read_b64_tr_b16 v[76:77], v127 offset:49152
  ds_read_b64_tr_b16 v[78:79], v127 offset:49664
  ds_read_b64_tr_b16 v[80:81], v127 offset:51200
  ds_read_b64_tr_b16 v[82:83], v127 offset:51712
  v_xor_b32 v127, 64, v126
  ds_read_b64_tr_b16 a[192:193], v127 offset:49152
  ds_read_b64_tr_b16 a[194:195], v127 offset:49664
  ds_read_b64_tr_b16 a[196:197], v127 offset:51200
  ds_read_b64_tr_b16 a[198:199], v127 offset:51712
  v_xor_b32 v127, 96, v126
  ds_read_b64_tr_b16 a[200:201], v127 offset:49152
  ds_read_b64_tr_b16 a[202:203], v127 offset:49664
  ds_read_b64_tr_b16 a[204:205], v127 offset:51200
  ds_read_b64_tr_b16 a[206:207], v127 offset:51712
  s_waitcnt lgkmcnt(0)
  v_xor_b32 v127, 128, v126
  ds_read_b64_tr_b16 a[224:225], v127 offset:49152
  ds_read_b64_tr_b16 a[226:227], v127 offset:49664
  ds_read_b64_tr_b16 a[228:229], v127 offset:51200
  ds_read_b64_tr_b16 a[230:231], v127 offset:51712
  v_xor_b32 v127, 160, v126
  ds_read_b64_tr_b16 a[232:233], v127 offset:49152
  ds_read_b64_tr_b16 a[234:235], v127 offset:49664
  ds_read_b64_tr_b16 a[236:237], v127 offset:51200
  ds_read_b64_tr_b16 a[238:239], v127 offset:51712
  v_xor_b32 v127, 192, v126
  ds_read_b64_tr_b16 v[84:85], v127 offset:49152
  ds_read_b64_tr_b16 v[86:87], v127 offset:49664
  ds_read_b64_tr_b16 v[88:89], v127 offset:51200
  ds_read_b64_tr_b16 v[90:91], v127 offset:51712
  v_xor_b32 v127, 224, v126
  ds_read_b64_tr_b16 v[92:93], v127 offset:49152
  ds_read_b64_tr_b16 v[94:95], v127 offset:49664
  ds_read_b64_tr_b16 v[96:97], v127 offset:51200
  ds_read_b64_tr_b16 v[98:99], v127 offset:51712
L_lo_126:
  s_waitcnt lgkmcnt(0)
  s_waitcnt vmcnt(12)
  s_barrier
  v_add_u32 v121, 65536, v121
  v_add_u32 v122, 65536, v122
  v_add_u32 v124, 65536, v124
  v_add_u32 v125, 65536, v125
  v_add_u32 v126, 65536, v126
  s_cmp_eq_u32 s4, 0
  s_cbranch_scc0 L_lo_127
  v_xor_b32 v127, 0, v126
  ds_read_b64_tr_b16 a[176:177], v127 offset:0
  ds_read_b64_tr_b16 a[178:179], v127 offset:512
  ds_read_b64_tr_b16 a[180:181], v127 offset:2048
  ds_read_b64_tr_b16 a[182:183], v127 offset:2560
  v_xor_b32 v127, 32, v126
  ds_read_b64_tr_b16 a[184:185], v127 offset:0
  ds_read_b64_tr_b16 a[186:187], v127 offset:512
  ds_read_b64_tr_b16 a[188:189], v127 offset:2048
  ds_read_b64_tr_b16 a[190:191], v127 offset:2560
  v_xor_b32 v127, 64, v126
  ds_read_b64_tr_b16 a[208:209], v127 offset:0
  ds_read_b64_tr_b16 a[210:211], v127 offset:512
  ds_read_b64_tr_b16 a[212:213], v127 offset:2048
  ds_read_b64_tr_b16 a[214:215], v127 offset:2560
  v_xor_b32 v127, 96, v126
  ds_read_b64_tr_b16 a[216:217], v127 offset:0
  ds_read_b64_tr_b16 a[218:219], v127 offset:512
  ds_read_b64_tr_b16 a[220:221], v127 offset:2048
  ds_read_b64_tr_b16 a[222:223], v127 offset:2560
  s_waitcnt lgkmcnt(0)
  v_xor_b32 v127, 128, v126
  ds_read_b64_tr_b16 a[240:241], v127 offset:0
  ds_read_b64_tr_b16 a[242:243], v127 offset:512
  ds_read_b64_tr_b16 a[244:245], v127 offset:2048
  ds_read_b64_tr_b16 a[246:247], v127 offset:2560
  v_xor_b32 v127, 160, v126
  ds_read_b64_tr_b16 a[248:249], v127 offset:0
  ds_read_b64_tr_b16 a[250:251], v127 offset:512
  ds_read_b64_tr_b16 a[252:253], v127 offset:2048
  ds_read_b64_tr_b16 a[254:255], v127 offset:2560
  v_xor_b32 v127, 192, v126
  ds_read_b64_tr_b16 v[100:101], v127 offset:0
  ds_read_b64_tr_b16 v[102:103], v127 offset:512
  ds_read_b64_tr_b16 v[104:105], v127 offset:2048
  ds_read_b64_tr_b16 v[106:107], v127 offset:2560
  v_xor_b32 v127, 224, v126
  ds_read_b64_tr_b16 v[108:109], v127 offset:0
  ds_read_b64_tr_b16 v[110:111], v127 offset:512
  ds_read_b64_tr_b16 v[112:113], v127 offset:2048
  ds_read_b64_tr_b16 v[114:115], v127 offset:2560
L_lo_127:
  s_waitcnt lgkmcnt(0)
  s_waitcnt vmcnt(8)
  s_barrier
  s_cmp_eq_u32 s4, 1
  s_cbranch_scc0 L_lo_128
  v_xor_b32 v127, 0, v126
  ds_read_b64_tr_b16 a[176:177], v127 offset:16384
  ds_read_b64_tr_b16 a[178:179], v127 offset:16896
  ds_read_b64_tr_b16 a[180:181], v127 offset:18432
  ds_read_b64_tr_b16 a[182:183], v127 offset:18944
  v_xor_b32 v127, 32, v126
  ds_read_b64_tr_b16 a[184:185], v127 offset:16384
  ds_read_b64_tr_b16 a[186:187], v127 offset:16896
  ds_read_b64_tr_b16 a[188:189], v127 offset:18432
  ds_read_b64_tr_b16 a[190:191], v127 offset:18944
  v_xor_b32 v127, 64, v126
  ds_read_b64_tr_b16 a[208:209], v127 offset:16384
  ds_read_b64_tr_b16 a[210:211], v127 offset:16896
  ds_read_b64_tr_b16 a[212:213], v127 offset:18432
  ds_read_b64_tr_b16 a[214:215], v127 offset:18944
  v_xor_b32 v127, 96, v126
  ds_read_b64_tr_b16 a[216:217], v127 offset:16384
  ds_read_b64_tr_b16 a[218:219], v127 offset:16896
  ds_read_b64_tr_b16 a[220:221], v127 offset:18432
  ds_read_b64_tr_b16 a[222:223], v127 offset:18944
  s_waitcnt lgkmcnt(0)
  v_xor_b32 v127, 128, v126
  ds_read_b64_tr_b16 a[240:241], v127 offset:16384
  ds_read_b64_tr_b16 a[242:243], v127 offset:16896
  ds_read_b64_tr_b16 a[244:245], v127 offset:18432
  ds_read_b64_tr_b16 a[246:247], v127 offset:18944
  v_xor_b32 v127, 160, v126
  ds_read_b64_tr_b16 a[248:249], v127 offset:16384
  ds_read_b64_tr_b16 a[250:251], v127 offset:16896
  ds_read_b64_tr_b16 a[252:253], v127 offset:18432
  ds_read_b64_tr_b16 a[254:255], v127 offset:18944
  v_xor_b32 v127, 192, v126
  ds_read_b64_tr_b16 v[100:101], v127 offset:16384
  ds_read_b64_tr_b16 v[102:103], v127 offset:16896
  ds_read_b64_tr_b16 v[104:105], v127 offset:18432
  ds_read_b64_tr_b16 v[106:107], v127 offset:18944
  v_xor_b32 v127, 224, v126
  ds_read_b64_tr_b16 v[108:109], v127 offset:16384
  ds_read_b64_tr_b16 v[110:111], v127 offset:16896
  ds_read_b64_tr_b16 v[112:113], v127 offset:18432
  ds_read_b64_tr_b16 v[114:115], v127 offset:18944
L_lo_128:
  s_waitcnt lgkmcnt(0)
  s_waitcnt vmcnt(4)
  s_barrier
  s_cmp_eq_u32 s4, 2
  s_cbranch_scc0 L_lo_129
  v_xor_b32 v127, 0, v126
  ds_read_b64_tr_b16 a[176:177], v127 offset:32768
  ds_read_b64_tr_b16 a[178:179], v127 offset:33280
  ds_read_b64_tr_b16 a[180:181], v127 offset:34816
  ds_read_b64_tr_b16 a[182:183], v127 offset:35328
  v_xor_b32 v127, 32, v126
  ds_read_b64_tr_b16 a[184:185], v127 offset:32768
  ds_read_b64_tr_b16 a[186:187], v127 offset:33280
  ds_read_b64_tr_b16 a[188:189], v127 offset:34816
  ds_read_b64_tr_b16 a[190:191], v127 offset:35328
  v_xor_b32 v127, 64, v126
  ds_read_b64_tr_b16 a[208:209], v127 offset:32768
  ds_read_b64_tr_b16 a[210:211], v127 offset:33280
  ds_read_b64_tr_b16 a[212:213], v127 offset:34816
  ds_read_b64_tr_b16 a[214:215], v127 offset:35328
  v_xor_b32 v127, 96, v126
  ds_read_b64_tr_b16 a[216:217], v127 offset:32768
  ds_read_b64_tr_b16 a[218:219], v127 offset:33280
  ds_read_b64_tr_b16 a[220:221], v127 offset:34816
  ds_read_b64_tr_b16 a[222:223], v127 offset:35328
  s_waitcnt lgkmcnt(0)
  v_xor_b32 v127, 128, v126
  ds_read_b64_tr_b16 a[240:241], v127 offset:32768
  ds_read_b64_tr_b16 a[242:243], v127 offset:33280
  ds_read_b64_tr_b16 a[244:245], v127 offset:34816
  ds_read_b64_tr_b16 a[246:247], v127 offset:35328
  v_xor_b32 v127, 160, v126
  ds_read_b64_tr_b16 a[248:249], v127 offset:32768
  ds_read_b64_tr_b16 a[250:251], v127 offset:33280
  ds_read_b64_tr_b16 a[252:253], v127 offset:34816
  ds_read_b64_tr_b16 a[254:255], v127 offset:35328
  v_xor_b32 v127, 192, v126
  ds_read_b64_tr_b16 v[100:101], v127 offset:32768
  ds_read_b64_tr_b16 v[102:103], v127 offset:33280
  ds_read_b64_tr_b16 v[104:105], v127 offset:34816
  ds_read_b64_tr_b16 v[106:107], v127 offset:35328
  v_xor_b32 v127, 224, v126
  ds_read_b64_tr_b16 v[108:109], v127 offset:32768
  ds_read_b64_tr_b16 v[110:111], v127 offset:33280
  ds_read_b64_tr_b16 v[112:113], v127 offset:34816
  ds_read_b64_tr_b16 v[114:115], v127 offset:35328
L_lo_129:
  s_waitcnt lgkmcnt(0)
  s_waitcnt vmcnt(0)
  s_barrier
  s_cmp_eq_u32 s4, 3
  s_cbranch_scc0 L_lo_130
  v_xor_b32 v127, 0, v126
  ds_read_b64_tr_b16 a[176:177], v127 offset:49152
  ds_read_b64_tr_b16 a[178:179], v127 offset:49664
  ds_read_b64_tr_b16 a[180:181], v127 offset:51200
  ds_read_b64_tr_b16 a[182:183], v127 offset:51712
  v_xor_b32 v127, 32, v126
  ds_read_b64_tr_b16 a[184:185], v127 offset:49152
  ds_read_b64_tr_b16 a[186:187], v127 offset:49664
  ds_read_b64_tr_b16 a[188:189], v127 offset:51200
  ds_read_b64_tr_b16 a[190:191], v127 offset:51712
  v_xor_b32 v127, 64, v126
  ds_read_b64_tr_b16 a[208:209], v127 offset:49152
  ds_read_b64_tr_b16 a[210:211], v127 offset:49664
  ds_read_b64_tr_b16 a[212:213], v127 offset:51200
  ds_read_b64_tr_b16 a[214:215], v127 offset:51712
  v_xor_b32 v127, 96, v126
  ds_read_b64_tr_b16 a[216:217], v127 offset:49152
  ds_read_b64_tr_b16 a[218:219], v127 offset:49664
  ds_read_b64_tr_b16 a[220:221], v127 offset:51200
  ds_read_b64_tr_b16 a[222:223], v127 offset:51712
  s_waitcnt lgkmcnt(0)
  v_xor_b32 v127, 128, v126
  ds_read_b64_tr_b16 a[240:241], v127 offset:49152
  ds_read_b64_tr_b16 a[242:243], v127 offset:49664
  ds_read_b64_tr_b16 a[244:245], v127 offset:51200
  ds_read_b64_tr_b16 a[246:247], v127 offset:51712
  v_xor_b32 v127, 160, v126
  ds_read_b64_tr_b16 a[248:249], v127 offset:49152
  ds_read_b64_tr_b16 a[250:251], v127 offset:49664
  ds_read_b64_tr_b16 a[252:253], v127 offset:51200
  ds_read_b64_tr_b16 a[254:255], v127 offset:51712
  v_xor_b32 v127, 192, v126
  ds_read_b64_tr_b16 v[100:101], v127 offset:49152
  ds_read_b64_tr_b16 v[102:103], v127 offset:49664
  ds_read_b64_tr_b16 v[104:105], v127 offset:51200
  ds_read_b64_tr_b16 v[106:107], v127 offset:51712
  v_xor_b32 v127, 224, v126
  ds_read_b64_tr_b16 v[108:109], v127 offset:49152
  ds_read_b64_tr_b16 v[110:111], v127 offset:49664
  ds_read_b64_tr_b16 v[112:113], v127 offset:51200
  ds_read_b64_tr_b16 v[114:115], v127 offset:51712
L_lo_130:
  s_waitcnt lgkmcnt(0)
  s_barrier
  ds_write_b128 v13, v[20:23] offset:8192
  ds_write_b128 v13, v[24:27] offset:9216
  ds_write_b128 v13, v[28:31] offset:10240
  ds_write_b128 v13, v[32:35] offset:11264
  ds_write_b128 v13, v[36:39] offset:12288
  ds_write_b128 v13, v[40:43] offset:13312
  ds_write_b128 v13, v[44:47] offset:14336
  ds_write_b128 v13, v[48:51] offset:15360
  ds_write_b128 v13, v[52:55] offset:16384
  ds_write_b128 v13, v[56:59] offset:17408
  ds_write_b128 v13, v[60:63] offset:18432
  ds_write_b128 v13, v[64:67] offset:19456
  ds_write_b128 v13, v[68:71] offset:20480
  ds_write_b128 v13, v[72:75] offset:21504
  ds_write_b128 v13, v[76:79] offset:22528
  ds_write_b128 v13, v[80:83] offset:23552
  ds_write_b128 v13, v[84:87] offset:24576
  ds_write_b128 v13, v[88:91] offset:25600
  ds_write_b128 v13, v[92:95] offset:26624
  ds_write_b128 v13, v[96:99] offset:27648
  ds_write_b128 v13, v[100:103] offset:28672
  ds_write_b128 v13, v[104:107] offset:29696
  ds_write_b128 v13, v[108:111] offset:30720
  ds_write_b128 v13, v[112:115] offset:31744
  ds_read_b128 v[20:23], v118 offset:0
  ds_read_b128 v[24:27], v118 offset:1024
  ds_read_b128 v[28:31], v118 offset:2048
  ds_read_b128 v[32:35], v118 offset:3072
  s_waitcnt lgkmcnt(0)
  ds_write_b128 v13, v[20:23] offset:0
  ds_write_b128 v13, v[24:27] offset:1024
  ds_write_b128 v13, v[28:31] offset:2048
  ds_write_b128 v13, v[32:35] offset:3072
  ds_read_b128 v[20:23], v118 offset:4096
  ds_read_b128 v[24:27], v118 offset:5120
  ds_read_b128 v[28:31], v118 offset:6144
  ds_read_b128 v[32:35], v118 offset:7168
  s_waitcnt lgkmcnt(0)
  ds_write_b128 v13, v[20:23] offset:4096
  ds_write_b128 v13, v[24:27] offset:5120
  ds_write_b128 v13, v[28:31] offset:6144
  ds_write_b128 v13, v[32:35] offset:7168
  s_waitcnt lgkmcnt(0)
  s_barrier
  v_mov_b32 v20, 0
  v_mov_b32 v21, 0
  v_mov_b32 v22, 0
  v_mov_b32 v23, 0
  v_mov_b32 v24, 0
  v_mov_b32 v25, 0
  v_mov_b32 v26, 0
  v_mov_b32 v27, 0
  v_mov_b32 v28, 0
  v_mov_b32 v29, 0
  v_mov_b32 v30, 0
  v_mov_b32 v31, 0
  v_mov_b32 v32, 0
  v_mov_b32 v33, 0
  v_mov_b32 v34, 0
  v_mov_b32 v35, 0
  v_bfe_u32 v94, v3, 4, 4
  v_and_b32 v95, 1, v94
  v_lshlrev_b32 v95, 4, v95
  v_mov_b32 v30, 0x3f80
  v_lshlrev_b32 v30, v95, v30
  s_mov_b32 s72, 0x30003
  s_mov_b32 s73, 0x30003
  s_mov_b32 s74, 0xc000c
  s_mov_b32 s75, 0xc000c
  s_mov_b32 s76, 0x300030
  s_mov_b32 s77, 0x300030
  s_mov_b32 s78, 0xc000c0
  s_mov_b32 s79, 0xc000c0
  s_cmp_eq_u32 s5, 7
  s_cselect_b32 s83, 61, 0xff
  s_mov_b32 s18, 1
  s_mov_b32 s17, 0
L_layer:
  s_mov_b32 s16, 0
  s_mov_b64 s[30:31], 0
  s_lshl_b32 s27, s17, 11
  s_add_u32 s27, s27, s5
  s_mul_i32 s28, s27, 16384
  s_add_u32 s28, s28, 17825792
  s_lshl_b32 s29, s4, 11
  s_add_u32 s23, s28, s29
  s_add_u32 s24, s23, 8192
  s_and_b32 s29, s4, 1
  s_lshl_b32 s29, s29, 13
  s_add_u32 s25, s28, s29
  s_add_u32 s25, s25, 1048576
  s_lshl_b32 s26, s27, 12
  s_lshl_b32 s29, s4, 10
  s_add_u32 s26, s26, s29
  s_add_u32 s26, s26, 917504
  s_lshl_b32 s27, s17, 5
  s_add_u32 s27, s27, s5
  s_lshl_b32 s40, s27, 8
  s_add_u32 s40, s40, 270336
  s_lshl_b32 s41, s27, 7
  s_add_u32 s41, s41, 286720
  s_add_u32 s84, s8, s41
  s_addc_u32 s85, s9, 0
  s_cmp_eq_u32 s4, 1
  s_cselect_b32 s86, 4, 0
  s_mov_b32 s87, 0x20000
  v_mov_b32 v28, 0
  s_load_dwordx2 s[12:13], s[0:1], 8
  s_waitcnt lgkmcnt(0)
  s_mov_b32 s14, 8192
  s_mov_b32 s15, 0x20000
  v_lshrrev_b32 v126, 4, v3
  v_bfe_u32 v124, v126, 2, 2
  v_lshlrev_b32 v124, 11, v124
  v_and_b32 v125, 1, v126
  v_lshl_add_u32 v124, v125, 10, v124
  v_bfe_u32 v125, v126, 1, 1
  v_lshl_add_u32 v124, v125, 6, v124
  v_bfe_u32 v125, v126, 4, 2
  v_lshl_add_u32 v124, v125, 3, v124
  s_lshl_b32 s27, s4, 8
  buffer_load_dwordx2 v[44:45], v124, s[12:15], s27 offen offset:0
  buffer_load_dwordx2 v[46:47], v124, s[12:15], s27 offen offset:32
  buffer_load_dwordx2 v[48:49], v124, s[12:15], s27 offen offset:128
  buffer_load_dwordx2 v[50:51], v124, s[12:15], s27 offen offset:160
  s_mov_b32 s28, 0x05040100
  s_mov_b32 s29, 0x07060302
  s_cmp_eq_u32 s17, 0
  s_cbranch_scc1 L_st0
  buffer_load_dword v18, v19, s[8:11], s40 offen sc1
  s_waitcnt vmcnt(0)
  s_branch L_st1
L_st0:
  v_lshrrev_b32 v120, 2, v3
L_ws_131:
  global_load_dword v121, v120, s[96:97] sc1
  buffer_load_dword v18, v19, s[8:11], s40 offen sc1
  s_waitcnt vmcnt(0)
  s_mov_b32 s3, 0
  v_readlane_b32 s2, v121, 2
  s_nop 3
  s_add_u32 s3, s3, s2
  v_readlane_b32 s2, v121, 3
  s_nop 3
  s_add_u32 s3, s3, s2
  v_readlane_b32 s2, v121, 18
  s_nop 3
  s_add_u32 s3, s3, s2
  v_readlane_b32 s2, v121, 19
  s_nop 3
  s_add_u32 s3, s3, s2
  v_readlane_b32 s2, v121, 34
  s_nop 3
  s_add_u32 s3, s3, s2
  v_readlane_b32 s2, v121, 35
  s_nop 3
  s_add_u32 s3, s3, s2
  v_readlane_b32 s2, v121, 50
  s_nop 3
  s_add_u32 s3, s3, s2
  v_readlane_b32 s2, v121, 51
  s_nop 3
  s_add_u32 s3, s3, s2
  s_add_u32 s39, s39, 1
  s_cmp_gt_u32 s39, 0x10000
  s_cbranch_scc1 L_abort
  s_cmp_lt_u32 s3, 256
  s_cbranch_scc1 L_ws_131
  v_readlane_b32 s3, v121, 5
  s_nop 3
  s_cmp_lt_u32 s3, 32
  s_cbranch_scc1 L_ws_131
  v_cmp_ne_u32 vcc, 32, v121
  s_nop 3
  s_or_b32 s3, vcc_lo, vcc_hi
  s_and_b32 s3, s3, 0x30003
  s_cselect_b32 s99, 1, 0
L_st1:
  v_cmp_ne_u32 s[30:31], 0, v18
  v_perm_b32 v36, v46, v44, s28
  v_perm_b32 v37, v46, v44, s29
  v_perm_b32 v38, v47, v45, s28
  v_perm_b32 v39, v47, v45, s29
  v_perm_b32 v40, v50, v48, s28
  v_perm_b32 v41, v50, v48, s29
  v_perm_b32 v42, v51, v49, s28
  v_perm_b32 v43, v51, v49, s29
  s_add_u32 s27, s16, 0
  s_min_u32 s27, s27, 63
  s_bitcmp1_b64 s[30:31], s27
  s_cbranch_scc1 L_kv0_ok
L_kv0_spin:
  buffer_load_dword v18, v19, s[8:11], s40 offen sc1
  s_waitcnt vmcnt(0)
  v_cmp_ne_u32 s[30:31], 0, v18
  s_add_u32 s39, s39, 1
  s_cmp_gt_u32 s39, 0x10000
  s_cbranch_scc1 L_abort
  s_nop 0
  s_bitcmp1_b64 s[30:31], s27
  s_cbranch_scc0 L_kv0_spin
L_kv0_ok:
  s_and_b32 s62, s62, 0x1fff
  v_mov_b32 v10, v3
  s_mov_b32 m0, s62
  s_nop 0
  buffer_load_dwordx4 v3, s[8:11], s23 offen sc1 lds
  buffer_load_dwordx4 v3, s[8:11], s23 offen offset:1024 sc1 lds
  s_xor_b32 s62, s62, 0x2000
  s_add_u32 s23, s23, 524288
  s_add_u32 s27, s16, 1
  s_min_u32 s27, s27, 63
  s_bitcmp1_b64 s[30:31], s27
  s_cbranch_scc1 L_kv1_ok
L_kv1_spin:
  buffer_load_dword v18, v19, s[8:11], s40 offen sc1
  s_waitcnt vmcnt(0)
  v_cmp_ne_u32 s[30:31], 0, v18
  s_add_u32 s39, s39, 1
  s_cmp_gt_u32 s39, 0x10000
  s_cbranch_scc1 L_abort
  s_nop 0
  s_bitcmp1_b64 s[30:31], s27
  s_cbranch_scc0 L_kv1_spin
L_kv1_ok:
  s_add_u32 s27, s16, 2
  s_min_u32 s27, s27, 63
  s_bitcmp1_b64 s[30:31], s27
  s_cbranch_scc1 L_kv2_ok
L_kv2_spin:
  buffer_load_dword v18, v19, s[8:11], s40 offen sc1
  s_waitcnt vmcnt(0)
  v_cmp_ne_u32 s[30:31], 0, v18
  s_add_u32 s39, s39, 1
  s_cmp_gt_u32 s39, 0x10000
  s_cbranch_scc1 L_abort
  s_nop 0
  s_bitcmp1_b64 s[30:31], s27
  s_cbranch_scc0 L_kv2_spin
L_kv2_ok:
  ds_read_b128 v[92:95], v13 offset:0
  ds_read_b128 v[96:99], v13 offset:1024
  ds_read_b128 v[100:103], v13 offset:2048
  ds_read_b128 v[104:107], v13 offset:3072
  ds_read_b128 v[108:111], v13 offset:4096
  ds_read_b128 v[112:115], v13 offset:5120
  ds_read_b128 v[116:119], v13 offset:6144
  ds_read_b128 v[120:123], v13 offset:7168
  v_mov_b64 v[68:69], 0
  v_mov_b64 v[70:71], 0
  v_mov_b64 v[72:73], 0
  v_mov_b64 v[74:75], 0
  v_mov_b64 v[76:77], 0
  v_mov_b64 v[78:79], 0
  v_mov_b64 v[80:81], 0
  v_mov_b64 v[82:83], 0
  v_mov_b64 v[84:85], 0
  v_mov_b64 v[86:87], 0
  v_mov_b64 v[88:89], 0
  v_mov_b64 v[90:91], 0
  ds_write_b128 v5, v[36:39]
  ds_write_b128 v5, v[40:43] offset:1024
  s_waitcnt vmcnt(0) lgkmcnt(0)
  s_cmp_eq_u32 s99, 0
  s_cbranch_scc0 L_go_s
  s_branch L_go_f
.p2align 8
  s_nop 0
  s_nop 0
  s_nop 0
L_step_f:
L_p2c_f:
  s_waitcnt vmcnt(2) lgkmcnt(0)
  v_bitop3_b32 v18, 1, v39, s18 bitop3:0x60
  v_bitop3_b32 v18, v18, v43, s18 bitop3:0x60
  v_cmp_ne_u32 vcc, 1, v18
  s_cbranch_vccnz L_p2f_f
L_go_f:
  v_smfmac_f32_16x16x64_bf16 v[68:71], v[36:39], v[92:99], v1
  ds_write_b128 v5, v[36:39]
  v_smfmac_f32_16x16x64_bf16 v[72:75], v[36:39], v[100:107], v1
  ds_write_b128 v5, v[40:43] offset:1024
  v_smfmac_f32_16x16x64_bf16 v[76:79], v[36:39], v[108:115], v1
  ds_read_b128 v[92:95], v13 offset:8192
  buffer_load_dwordx4 v[20:23], v3, s[8:11], s24 offen sc1
  v_smfmac_f32_16x16x64_bf16 v[80:83], v[36:39], v[116:123], v1
  ds_read_b128 v[96:99], v13 offset:9216
  buffer_load_dwordx4 v[24:27], v3, s[8:11], s24 offen offset:1024 sc1
  v_smfmac_f32_16x16x64_bf16 v[68:71], v[40:43], v[128:135], v1
  ds_read_b128 v[100:103], v13 offset:10240
  s_mov_b32 m0, s62
  v_smfmac_f32_16x16x64_bf16 v[72:75], v[40:43], v[136:143], v1
  ds_read_b128 v[104:107], v13 offset:11264
  buffer_load_dwordx4 v3, s[8:11], s23 offen sc1 lds
  v_smfmac_f32_16x16x64_bf16 v[76:79], v[40:43], v[240:247], v1
  s_waitcnt lgkmcnt(4)
  s_barrier
  ds_read_b128 v[44:47], v6 offset:0
  v_smfmac_f32_16x16x64_bf16 v[80:83], v[40:43], v[248:255], v1
  ds_read_b128 v[48:51], v6 offset:1024
  buffer_load_dwordx4 v3, s[8:11], s23 offen offset:1024 sc1 lds
  v_smfmac_f32_16x16x64_bf16 v[84:87], v[36:39], a[64:71], v1
  ds_read_b128 v[52:55], v7 offset:0
  v_smfmac_f32_16x16x64_bf16 v[88:91], v[36:39], a[72:79], v1
  ds_read_b128 v[56:59], v7 offset:1024
  s_waitcnt lgkmcnt(4)
  buffer_load_dword v18, v17, s[8:11], s25 offen sc1
  v_smfmac_f32_16x16x64_bf16 v[84:87], v[40:43], v[92:99], v1
  ds_read_b128 v[60:63], v8 offset:0
  buffer_load_dword v18, v19, s[8:11], s40 offen sc1
  v_smfmac_f32_16x16x64_bf16 v[88:91], v[40:43], v[100:107], v1
  ds_read_b128 v[64:67], v8 offset:1024
  s_waitcnt lgkmcnt(5)
  v_smfmac_f32_16x16x64_bf16 v[68:71], v[44:47], v[144:151], v1
  ds_read_b128 v[108:111], v13 offset:16384
  v_smfmac_f32_16x16x64_bf16 v[72:75], v[44:47], v[152:159], v1
  ds_read_b128 v[112:115], v13 offset:17408
  s_waitcnt lgkmcnt(6)
  v_smfmac_f32_16x16x64_bf16 v[68:71], v[48:51], v[160:167], v1
  ds_read_b128 v[116:119], v13 offset:18432
  v_smfmac_f32_16x16x64_bf16 v[72:75], v[48:51], v[168:175], v1
  ds_read_b128 v[120:123], v13 offset:19456
  s_waitcnt lgkmcnt(7)
  v_smfmac_f32_16x16x64_bf16 v[68:71], v[52:55], v[176:183], v1
  ds_read_b128 v[92:95], v13 offset:12288
  v_smfmac_f32_16x16x64_bf16 v[72:75], v[52:55], v[184:191], v1
  ds_read_b128 v[96:99], v13 offset:13312
  v_smfmac_f32_16x16x64_bf16 v[76:79], v[52:55], a[0:7], v1
  ds_read_b128 v[100:103], v13 offset:14336
  v_smfmac_f32_16x16x64_bf16 v[80:83], v[52:55], a[8:15], v1
  ds_read_b128 v[104:107], v13 offset:15360
  s_waitcnt lgkmcnt(10)
  v_smfmac_f32_16x16x64_bf16 v[68:71], v[56:59], v[192:199], v1
  v_smfmac_f32_16x16x64_bf16 v[72:75], v[56:59], v[200:207], v1
  s_waitcnt vmcnt(6)
  ds_read_b128 v[36:39], v10 offset:4096
  v_smfmac_f32_16x16x64_bf16 v[76:79], v[56:59], a[16:23], v1
  ds_read_b128 v[40:43], v10 offset:5120
  v_smfmac_f32_16x16x64_bf16 v[80:83], v[56:59], a[24:31], v1
  s_waitcnt lgkmcnt(10)
  v_smfmac_f32_16x16x64_bf16 v[68:71], v[60:63], v[208:215], v1
  v_smfmac_f32_16x16x64_bf16 v[72:75], v[60:63], v[216:223], v1
  v_smfmac_f32_16x16x64_bf16 v[68:71], v[64:67], v[224:231], v1
  v_smfmac_f32_16x16x64_bf16 v[72:75], v[64:67], v[232:239], v1
  s_waitcnt lgkmcnt(2)
  v_smfmac_f32_16x16x64_bf16 v[76:79], v[48:51], v[108:115], v1
  v_smfmac_f32_16x16x64_bf16 v[80:83], v[48:51], v[116:123], v1
  v_add_f32 v68, v68, v70
  v_smfmac_f32_16x16x64_bf16 v[76:79], v[44:47], v[92:99], v1
  ds_read_b128 v[108:111], v10 offset:0
  v_add_f32 v69, v69, v71
  v_smfmac_f32_16x16x64_bf16 v[80:83], v[44:47], v[100:107], v1
  ds_read_b128 v[112:115], v10 offset:1024
  v_add_f32 v72, v72, v74
  v_smfmac_f32_16x16x64_bf16 v[76:79], v[60:63], a[32:39], v1
  ds_read_b128 v[116:119], v10 offset:2048
  v_add_f32 v73, v73, v75
  v_smfmac_f32_16x16x64_bf16 v[80:83], v[60:63], a[40:47], v1
  ds_read_b128 v[120:123], v10 offset:3072
  v_cvt_pk_bf16_f32 v70, v68, v72
  v_smfmac_f32_16x16x64_bf16 v[76:79], v[64:67], a[48:55], v1
  buffer_store_dwordx4 v[124:127], v3, s[8:11], s26 offen sc1
  v_cvt_pk_bf16_f32 v71, v69, v73
  v_smfmac_f32_16x16x64_bf16 v[80:83], v[64:67], a[56:63], v1
  ds_write2_b32 v9, v70, v71 offset1:16
  v_smfmac_f32_16x16x64_bf16 v[84:87], v[44:47], a[80:87], v1
  buffer_store_dword v28, v3, s[84:87], 0 offen sc1
  v_smfmac_f32_16x16x64_bf16 v[88:91], v[44:47], a[88:95], v1
  v_add_f32 v76, v76, v78
  v_add_f32 v77, v77, v79
  v_smfmac_f32_16x16x64_bf16 v[84:87], v[48:51], a[96:103], v1
  ds_read_b128 v[44:47], v10 offset:6144
  v_add_f32 v80, v80, v82
  v_add_f32 v81, v81, v83
  v_smfmac_f32_16x16x64_bf16 v[88:91], v[48:51], a[104:111], v1
  v_cvt_pk_bf16_f32 v78, v76, v80
  v_cvt_pk_bf16_f32 v79, v77, v81
  v_smfmac_f32_16x16x64_bf16 v[84:87], v[52:55], a[112:119], v1
  ds_write2_b32 v12, v78, v79 offset1:16
  v_smfmac_f32_16x16x64_bf16 v[88:91], v[52:55], a[120:127], v1
  ds_read_b128 v[48:51], v10 offset:7168
  v_smfmac_f32_16x16x64_bf16 v[84:87], v[56:59], a[128:135], v1
  v_mov_b64 v[52:53], 0
  v_smfmac_f32_16x16x64_bf16 v[88:91], v[56:59], a[136:143], v1
  v_mov_b64 v[54:55], 0
  v_smfmac_f32_16x16x64_bf16 v[84:87], v[60:63], a[144:151], v1
  s_waitcnt lgkmcnt(1)
  s_barrier
  ds_read_b128 v[92:95], v11 offset:28672
  v_smfmac_f32_16x16x64_bf16 v[88:91], v[60:63], a[152:159], v1
  ds_read_b128 v[96:99], v11 offset:29184
  v_mov_b64 v[56:57], 0
  v_smfmac_f32_16x16x64_bf16 v[84:87], v[64:67], a[160:167], v1
  ds_read_b128 v[100:103], v11 offset:29696
  v_mov_b64 v[58:59], 0
  v_smfmac_f32_16x16x64_bf16 v[88:91], v[64:67], a[168:175], v1
  ds_read_b128 v[104:107], v11 offset:30208
  v_mov_b64 v[60:61], 0
  s_waitcnt lgkmcnt(3)
  v_mfma_f32_16x16x32_bf16 v[68:71], v[108:111], v[92:95], 0
  ds_read_b128 v[108:111], v11 offset:24576
  s_waitcnt lgkmcnt(3)
  v_mfma_f32_16x16x32_bf16 v[68:71], v[112:115], v[96:99], v[68:71]
  ds_read_b128 v[112:115], v11 offset:25088
  s_waitcnt lgkmcnt(3)
  v_mfma_f32_16x16x32_bf16 v[68:71], v[116:119], v[100:103], v[68:71]
  ds_read_b128 v[116:119], v11 offset:25600
  s_waitcnt lgkmcnt(3)
  v_mfma_f32_16x16x32_bf16 v[68:71], v[120:123], v[104:107], v[68:71]
  ds_read_b128 v[120:123], v11 offset:26112
  v_mov_b64 v[62:63], 0
  v_mfma_f32_16x16x32_bf16 v[72:75], v[36:39], v[92:95], 0
  v_add_f32 v84, v84, v86
  v_add_f32 v85, v85, v87
  v_mfma_f32_16x16x32_bf16 v[72:75], v[40:43], v[96:99], v[72:75]
  v_add_f32 v88, v88, v90
  v_add_f32 v89, v89, v91
  v_mfma_f32_16x16x32_bf16 v[72:75], v[44:47], v[100:103], v[72:75]
  v_cvt_pk_bf16_f32 v32, v84, v85
  v_cvt_pk_bf16_f32 v34, v88, v89
  v_mfma_f32_16x16x32_bf16 v[72:75], v[48:51], v[104:107], v[72:75]
  s_waitcnt lgkmcnt(3)
  v_max3_f32 v124, v68, v69, v70
  v_mfma_f32_16x16x32_bf16 v[76:79], v[108:111], v[92:95], 0
  ds_write_b32 v15, v32
  s_waitcnt lgkmcnt(3)
  v_mfma_f32_16x16x32_bf16 v[76:79], v[112:115], v[96:99], v[76:79]
  ds_write_b32 v15, v34 offset:256
  s_waitcnt lgkmcnt(3)
  v_mfma_f32_16x16x32_bf16 v[76:79], v[116:119], v[100:103], v[76:79]
  s_waitcnt lgkmcnt(2)
  v_mov_b64 v[64:65], 0
  v_mfma_f32_16x16x32_bf16 v[76:79], v[120:123], v[104:107], v[76:79]
  ds_read_b128 v[108:111], v13 offset:20480
  ds_read_b128 v[112:115], v13 offset:21504
  ds_read_b128 v[116:119], v13 offset:22528
  ds_read_b128 v[120:123], v13 offset:23552
  v_max3_f32 v125, v71, v72, v73
  v_max3_f32 v126, v74, v75, v124
  v_mov_b64 v[66:67], 0
  v_max_f32 v125, v125, v126
  v_max3_f32 v124, v125, v76, v77
  v_mov_b64 v[36:37], 0
  v_mov_b32 v125, v124
  v_mov_b64 v[38:39], 0
  v_mov_b64 v[40:41], 0
  v_permlane32_swap_b32 v124, v125
  v_max_f32 v124, v124, v125
  v_mov_b64 v[42:43], 0
  v_mov_b32 v125, v124
  v_mov_b64 v[44:45], 0
  v_mov_b64 v[46:47], 0
  v_permlane16_swap_b32 v124, v125
  v_max_f32 v124, v124, v125
  s_waitcnt vmcnt(6)
  v_mul_f32 v124, s6, v124
  v_pk_fma_f32 v[68:69], v[68:69], s[6:7], v[124:125] op_sel_hi:[1,1,0] neg_lo:[0,0,1] neg_hi:[0,0,1]
  v_pk_fma_f32 v[70:71], v[70:71], s[6:7], v[124:125] op_sel_hi:[1,1,0] neg_lo:[0,0,1] neg_hi:[0,0,1]
  v_pk_fma_f32 v[72:73], v[72:73], s[6:7], v[124:125] op_sel_hi:[1,1,0] neg_lo:[0,0,1] neg_hi:[0,0,1]
  v_pk_fma_f32 v[74:75], v[74:75], s[6:7], v[124:125] op_sel_hi:[1,1,0] neg_lo:[0,0,1] neg_hi:[0,0,1]
  v_pk_fma_f32 v[76:77], v[76:77], s[6:7], v[124:125] op_sel_hi:[1,1,0] neg_lo:[0,0,1] neg_hi:[0,0,1]
  v_exp_f32 v68, v68
  v_exp_f32 v69, v69
  v_exp_f32 v70, v70
  v_exp_f32 v71, v71
  v_exp_f32 v72, v72
  v_exp_f32 v73, v73
  v_exp_f32 v74, v74
  v_exp_f32 v75, v75
  v_exp_f32 v76, v76
  v_exp_f32 v77, v77
  v_cvt_pk_bf16_f32 v80, v68, v69
  v_cvt_pk_bf16_f32 v81, v70, v71
  v_cvt_pk_bf16_f32 v82, v72, v73
  v_cvt_pk_bf16_f32 v83, v74, v75
  v_cvt_pk_bf16_f32 v28, v76, v77
  v_add_f32 v76, v76, v77
  v_mfma_f32_16x16x32_bf16 v[92:95], v[20:23], v[80:83], 0
  v_add_f32 v68, v68, v69
  v_add_f32 v70, v70, v71
  v_mfma_f32_16x16x32_bf16 v[96:99], v[24:27], v[80:83], 0
  v_add_f32 v72, v72, v73
  v_add_f32 v74, v74, v75
  v_add_f32 v68, v68, v70
  v_mfma_f32_16x16x16_bf16 v[92:95], v[32:33], v[28:29], v[92:95]
  v_add_f32 v72, v72, v74
  v_add_f32 v68, v68, v76
  v_mfma_f32_16x16x16_bf16 v[96:99], v[34:35], v[28:29], v[96:99]
  v_add_f32 v124, v68, v72
  v_mov_b32 v125, v124
  v_mov_b64 v[48:49], 0
  v_mov_b64 v[50:51], 0
  v_permlane32_swap_b32 v124, v125
  v_add_f32 v124, v124, v125
  v_mov_b32 v125, v124
  s_mov_b64 exec, s[34:35]
  v_mov_b64 v[92:93], v[96:97]
  v_mov_b64 v[94:95], v[98:99]
  s_mov_b64 exec, -1
  v_permlane16_swap_b32 v124, v125
  v_add_f32 v124, v124, v125
  v_rcp_f32 v124, v124
  s_nop 0
  v_pk_mul_f32 v[92:93], v[92:93], v[124:125] op_sel_hi:[1,0]
  v_pk_mul_f32 v[94:95], v[94:95], v[124:125] op_sel_hi:[1,0]
  v_cvt_pk_bf16_f32 v92, v92, v93
  v_cvt_pk_bf16_f32 v93, v94, v95
  ds_write_b64 v14, v[92:93]
  s_waitcnt lgkmcnt(0)
  s_barrier
  ds_read_b128 v[100:103], v3 offset:30720
  ds_read_b128 v[104:107], v3 offset:31744
  ds_read_b128 v[68:71], v13 offset:24576
  ds_read_b128 v[72:75], v13 offset:25600
  ds_read_b128 v[76:79], v13 offset:26624
  ds_read_b128 v[80:83], v13 offset:27648
  s_waitcnt lgkmcnt(5)
  v_smfmac_f32_16x16x64_bf16 v[36:39], v[100:103], v[108:115], v1
  v_smfmac_f32_16x16x64_bf16 v[40:43], v[100:103], v[116:123], v1
  s_waitcnt lgkmcnt(4)
  v_smfmac_f32_16x16x64_bf16 v[36:39], v[104:107], a[176:183], v1
  ds_read_b128 v[108:111], v13 offset:28672
  v_smfmac_f32_16x16x64_bf16 v[40:43], v[104:107], a[184:191], v1
  ds_read_b128 v[112:115], v13 offset:29696
  v_smfmac_f32_16x16x64_bf16 v[44:47], v[100:103], a[192:199], v1
  ds_read_b128 v[116:119], v13 offset:30720
  v_smfmac_f32_16x16x64_bf16 v[48:51], v[100:103], a[200:207], v1
  ds_read_b128 v[120:123], v13 offset:31744
  v_add_f32 v36, v36, v38
  v_smfmac_f32_16x16x64_bf16 v[44:47], v[104:107], a[208:215], v1
  v_add_f32 v37, v37, v39
  v_cvt_pk_bf16_f32 v92, v36, v37
  v_smfmac_f32_16x16x64_bf16 v[48:51], v[104:107], a[216:223], v1
  v_add_f32 v40, v40, v42
  v_add_f32 v41, v41, v43
  v_smfmac_f32_16x16x64_bf16 v[52:55], v[100:103], a[224:231], v1
  v_cvt_pk_bf16_f32 v93, v40, v41
  v_bfi_b32 v92, 1, s18, v92
  v_smfmac_f32_16x16x64_bf16 v[56:59], v[100:103], a[232:239], v1
  v_add_f32 v44, v44, v46
  v_add_f32 v45, v45, v47
  v_smfmac_f32_16x16x64_bf16 v[52:55], v[104:107], a[240:247], v1
  v_cvt_pk_bf16_f32 v94, v44, v45
  v_add_f32 v48, v48, v50
  v_smfmac_f32_16x16x64_bf16 v[56:59], v[104:107], a[248:255], v1
  s_waitcnt lgkmcnt(0)
  v_add_f32 v49, v49, v51
  v_cvt_pk_bf16_f32 v95, v48, v49
  v_smfmac_f32_16x16x64_bf16 v[60:63], v[100:103], v[68:75], v1
  buffer_store_dwordx4 v[92:95], v2, s[8:11], 0 offen
  v_smfmac_f32_16x16x64_bf16 v[64:67], v[100:103], v[76:83], v1
  v_add_f32 v52, v52, v54
  v_add_f32 v53, v53, v55
  v_smfmac_f32_16x16x64_bf16 v[60:63], v[104:107], v[108:115], v1
  v_cvt_pk_bf16_f32 v96, v52, v53
  v_add_f32 v56, v56, v58
  v_smfmac_f32_16x16x64_bf16 v[64:67], v[104:107], v[116:123], v1
  v_add_f32 v57, v57, v59
  v_cvt_pk_bf16_f32 v97, v56, v57
  v_bfi_b32 v96, 1, s18, v96
  s_nop 1
  v_pk_add_f32 v[60:61], v[60:61], v[62:63]
  v_cvt_pk_bf16_f32 v98, v60, v61
  s_nop 0
  v_pk_add_f32 v[64:65], v[64:65], v[66:67]
  v_cvt_pk_bf16_f32 v99, v64, v65
  buffer_store_dwordx4 v[96:99], v2, s[8:11], s22 offen
  v_cndmask_b32 v84, 0, v30, s[72:73]
  v_cndmask_b32 v85, 0, v30, s[74:75]
  v_cndmask_b32 v86, 0, v30, s[76:77]
  v_cndmask_b32 v87, 0, v30, s[78:79]
  v_mov_b64 v[68:69], 0
  v_mov_b64 v[70:71], 0
  v_mov_b64 v[72:73], 0
  v_mov_b64 v[74:75], 0
  v_mov_b64 v[76:77], 0
  v_mov_b64 v[78:79], 0
  v_mov_b64 v[80:81], 0
  v_mov_b64 v[82:83], 0
  s_add_u32 s16, s16, 1
  s_add_u32 s24, s24, 524288
  s_add_u32 s26, s26, 131072
  s_cmp_lt_u32 s16, 62
  s_cselect_b32 s27, 524288, 0
  s_add_u32 s25, s25, s27
  s_cmp_lt_u32 s16, 63
  s_cselect_b32 s27, 524288, 0
  s_add_u32 s23, s23, s27
  s_xor_b32 s62, s62, 0x2000
  v_xor_b32 v10, 0x2000, v10
  v_mov_b32 v28, s16
  s_waitcnt vmcnt(4)
  v_cmp_ne_u32 s[30:31], 0, v18
  s_add_u32 s27, s16, 2
  s_min_u32 s27, s27, 63
  s_nop 1
  s_bitcmp1_b64 s[30:31], s27
  s_cbranch_scc1 L_kvs_f_ok
L_kvs_f_spin:
  buffer_load_dword v18, v19, s[8:11], s40 offen sc1
  s_waitcnt vmcnt(0)
  v_cmp_ne_u32 s[30:31], 0, v18
  s_add_u32 s39, s39, 1
  s_cmp_gt_u32 s39, 0x10000
  s_cbranch_scc1 L_abort
  s_nop 0
  s_bitcmp1_b64 s[30:31], s27
  s_cbranch_scc0 L_kvs_f_spin
L_kvs_f_ok:
  s_nop 14
  buffer_load_dwordx4 v[36:39], v3, s[8:11], s20 offen sc1
  buffer_load_dwordx4 v[40:43], v3, s[8:11], s20 offen offset:1024 sc1
  ds_read_b128 v[92:95], v13 offset:0
  ds_read_b128 v[96:99], v13 offset:1024
  ds_read_b128 v[100:103], v13 offset:2048
  ds_read_b128 v[104:107], v13 offset:3072
  ds_read_b128 v[108:111], v13 offset:4096
  ds_read_b128 v[112:115], v13 offset:5120
  ds_read_b128 v[116:119], v13 offset:6144
  ds_read_b128 v[120:123], v13 offset:7168
  s_nop 14
  buffer_load_dwordx4 v[44:47], v3, s[8:11], s20 offen sc1
  buffer_load_dwordx4 v[48:51], v3, s[8:11], s20 offen offset:1024 sc1
  s_waitcnt vmcnt(3)
  v_mfma_f32_16x16x32_bf16 v[88:91], v[84:87], v[36:39], 0
  s_waitcnt vmcnt(2)
  v_mfma_f32_16x16x32_bf16 v[88:91], v[84:87], v[40:43], v[88:91]
  v_bitop3_b32 v18, 1, v36, s18 bitop3:0x90
  v_bitop3_b32 v18, v18, v40, s18 bitop3:0x90
  v_cmp_ne_u32 vcc, 1, v18
  s_cbranch_vccnz L_p1f_f
L_p1k_f:
  s_nop 3
  v_add_f32_dpp v88, v88, v88 row_ror:8 row_mask:0xf bank_mask:0xf
  v_add_f32_dpp v89, v89, v89 row_ror:8 row_mask:0xf bank_mask:0xf
  v_add_f32_dpp v90, v90, v90 row_ror:8 row_mask:0xf bank_mask:0xf
  v_add_f32_dpp v91, v91, v91 row_ror:8 row_mask:0xf bank_mask:0xf
  v_add_f32_dpp v88, v88, v88 row_ror:4 row_mask:0xf bank_mask:0x5
  v_add_f32_dpp v90, v90, v90 row_ror:4 row_mask:0xf bank_mask:0x5
  s_nop 0
  v_add_f32_dpp v88, v89, v89 row_ror:4 row_mask:0xf bank_mask:0xa
  v_add_f32_dpp v90, v91, v91 row_ror:4 row_mask:0xf bank_mask:0xa
  s_mov_b64 exec, s[36:37]
  v_cvt_pk_bf16_f32 v124, v88, v90
  v_bfi_b32 v124, v0, s18, v124
  buffer_store_dword v124, v4, s[8:11], 0 offen
  s_mov_b64 exec, -1
  ds_read_b128 v[124:127], v16
  v_mov_b64 v[84:85], 0
  v_mov_b64 v[86:87], 0
  v_mov_b64 v[88:89], 0
  v_mov_b64 v[90:91], 0
  s_nop 15
  s_nop 15
  s_nop 7
  s_xor_b32 s18, s18, 1
  buffer_load_dwordx4 v[36:39], v3, s[8:11], s21 offen sc1
  buffer_load_dwordx4 v[40:43], v3, s[8:11], s21 offen offset:1024 sc1
  s_nop 15
  s_nop 13
  buffer_load_dwordx4 v[36:39], v3, s[8:11], s21 offen sc1
  buffer_load_dwordx4 v[40:43], v3, s[8:11], s21 offen offset:1024 sc1
  s_cmp_lt_u32 s16, 63
  s_cbranch_scc1 L_step_f
L_p2c_ft:
  s_waitcnt vmcnt(2) lgkmcnt(0)
  v_bitop3_b32 v18, 1, v39, s18 bitop3:0x60
  v_bitop3_b32 v18, v18, v43, s18 bitop3:0x60
  v_cmp_ne_u32 vcc, 1, v18
  s_cbranch_vccnz L_p2f_ft
  s_branch L_tail
L_step_s:
L_p2c_s:
  s_waitcnt vmcnt(0) lgkmcnt(0)
  v_bitop3_b32 v18, 1, v39, s18 bitop3:0x60
  v_bitop3_b32 v18, v18, v43, s18 bitop3:0x60
  v_cmp_ne_u32 vcc, 1, v18
  s_cbranch_vccnz L_p2f_s
L_go_s:
  v_smfmac_f32_16x16x64_bf16 v[68:71], v[36:39], v[92:99], v1
  ds_write_b128 v5, v[36:39]
  v_smfmac_f32_16x16x64_bf16 v[72:75], v[36:39], v[100:107], v1
  ds_write_b128 v5, v[40:43] offset:1024
  v_smfmac_f32_16x16x64_bf16 v[76:79], v[36:39], v[108:115], v1
  ds_read_b128 v[92:95], v13 offset:8192
  buffer_load_dwordx4 v[20:23], v3, s[8:11], s24 offen sc1
  v_smfmac_f32_16x16x64_bf16 v[80:83], v[36:39], v[116:123], v1
  ds_read_b128 v[96:99], v13 offset:9216
  buffer_load_dwordx4 v[24:27], v3, s[8:11], s24 offen offset:1024 sc1
  v_smfmac_f32_16x16x64_bf16 v[68:71], v[40:43], v[128:135], v1
  ds_read_b128 v[100:103], v13 offset:10240
  s_mov_b32 m0, s62
  v_smfmac_f32_16x16x64_bf16 v[72:75], v[40:43], v[136:143], v1
  ds_read_b128 v[104:107], v13 offset:11264
  buffer_load_dwordx4 v3, s[8:11], s23 offen sc1 lds
  v_smfmac_f32_16x16x64_bf16 v[76:79], v[40:43], v[240:247], v1
  s_waitcnt lgkmcnt(4)
  s_barrier
  ds_read_b128 v[44:47], v6 offset:0
  v_smfmac_f32_16x16x64_bf16 v[80:83], v[40:43], v[248:255], v1
  ds_read_b128 v[48:51], v6 offset:1024
  buffer_load_dwordx4 v3, s[8:11], s23 offen offset:1024 sc1 lds
  v_smfmac_f32_16x16x64_bf16 v[84:87], v[36:39], a[64:71], v1
  ds_read_b128 v[52:55], v7 offset:0
  v_smfmac_f32_16x16x64_bf16 v[88:91], v[36:39], a[72:79], v1
  ds_read_b128 v[56:59], v7 offset:1024
  s_waitcnt lgkmcnt(4)
  buffer_load_dword v18, v17, s[8:11], s25 offen sc1
  v_smfmac_f32_16x16x64_bf16 v[84:87], v[40:43], v[92:99], v1
  ds_read_b128 v[60:63], v8 offset:0
  buffer_load_dword v18, v19, s[8:11], s40 offen sc1
  v_smfmac_f32_16x16x64_bf16 v[88:91], v[40:43], v[100:107], v1
  ds_read_b128 v[64:67], v8 offset:1024
  s_waitcnt lgkmcnt(5)
  v_smfmac_f32_16x16x64_bf16 v[68:71], v[44:47], v[144:151], v1
  ds_read_b128 v[108:111], v13 offset:16384
  v_smfmac_f32_16x16x64_bf16 v[72:75], v[44:47], v[152:159], v1
  ds_read_b128 v[112:115], v13 offset:17408
  s_waitcnt lgkmcnt(6)
  v_smfmac_f32_16x16x64_bf16 v[68:71], v[48:51], v[160:167], v1
  ds_read_b128 v[116:119], v13 offset:18432
  v_smfmac_f32_16x16x64_bf16 v[72:75], v[48:51], v[168:175], v1
  ds_read_b128 v[120:123], v13 offset:19456
  s_waitcnt lgkmcnt(7)
  v_smfmac_f32_16x16x64_bf16 v[68:71], v[52:55], v[176:183], v1
  ds_read_b128 v[92:95], v13 offset:12288
  v_smfmac_f32_16x16x64_bf16 v[72:75], v[52:55], v[184:191], v1
  ds_read_b128 v[96:99], v13 offset:13312
  v_smfmac_f32_16x16x64_bf16 v[76:79], v[52:55], a[0:7], v1
  ds_read_b128 v[100:103], v13 offset:14336
  v_smfmac_f32_16x16x64_bf16 v[80:83], v[52:55], a[8:15], v1
  ds_read_b128 v[104:107], v13 offset:15360
  s_waitcnt lgkmcnt(10)
  v_smfmac_f32_16x16x64_bf16 v[68:71], v[56:59], v[192:199], v1
  v_smfmac_f32_16x16x64_bf16 v[72:75], v[56:59], v[200:207], v1
  s_waitcnt vmcnt(6)
  ds_read_b128 v[36:39], v10 offset:4096
  v_smfmac_f32_16x16x64_bf16 v[76:79], v[56:59], a[16:23], v1
  ds_read_b128 v[40:43], v10 offset:5120
  v_smfmac_f32_16x16x64_bf16 v[80:83], v[56:59], a[24:31], v1
  s_waitcnt lgkmcnt(10)
  v_smfmac_f32_16x16x64_bf16 v[68:71], v[60:63], v[208:215], v1
  v_smfmac_f32_16x16x64_bf16 v[72:75], v[60:63], v[216:223], v1
  v_smfmac_f32_16x16x64_bf16 v[68:71], v[64:67], v[224:231], v1
  v_smfmac_f32_16x16x64_bf16 v[72:75], v[64:67], v[232:239], v1
  s_waitcnt lgkmcnt(2)
  v_smfmac_f32_16x16x64_bf16 v[76:79], v[48:51], v[108:115], v1
  v_smfmac_f32_16x16x64_bf16 v[80:83], v[48:51], v[116:123], v1
  v_add_f32 v68, v68, v70
  v_smfmac_f32_16x16x64_bf16 v[76:79], v[44:47], v[92:99], v1
  ds_read_b128 v[108:111], v10 offset:0
  v_add_f32 v69, v69, v71
  v_smfmac_f32_16x16x64_bf16 v[80:83], v[44:47], v[100:107], v1
  ds_read_b128 v[112:115], v10 offset:1024
  v_add_f32 v72, v72, v74
  v_smfmac_f32_16x16x64_bf16 v[76:79], v[60:63], a[32:39], v1
  ds_read_b128 v[116:119], v10 offset:2048
  v_add_f32 v73, v73, v75
  v_smfmac_f32_16x16x64_bf16 v[80:83], v[60:63], a[40:47], v1
  ds_read_b128 v[120:123], v10 offset:3072
  v_cvt_pk_bf16_f32 v70, v68, v72
  v_smfmac_f32_16x16x64_bf16 v[76:79], v[64:67], a[48:55], v1
  buffer_store_dwordx4 v[124:127], v3, s[8:11], s26 offen sc1
  v_cvt_pk_bf16_f32 v71, v69, v73
  v_smfmac_f32_16x16x64_bf16 v[80:83], v[64:67], a[56:63], v1
  ds_write2_b32 v9, v70, v71 offset1:16
  v_smfmac_f32_16x16x64_bf16 v[84:87], v[44:47], a[80:87], v1
  buffer_store_dword v28, v3, s[84:87], 0 offen sc1
  v_smfmac_f32_16x16x64_bf16 v[88:91], v[44:47], a[88:95], v1
  v_add_f32 v76, v76, v78
  v_add_f32 v77, v77, v79
  v_smfmac_f32_16x16x64_bf16 v[84:87], v[48:51], a[96:103], v1
  ds_read_b128 v[44:47], v10 offset:6144
  v_add_f32 v80, v80, v82
  v_add_f32 v81, v81, v83
  v_smfmac_f32_16x16x64_bf16 v[88:91], v[48:51], a[104:111], v1
  v_cvt_pk_bf16_f32 v78, v76, v80
  v_cvt_pk_bf16_f32 v79, v77, v81
  v_smfmac_f32_16x16x64_bf16 v[84:87], v[52:55], a[112:119], v1
  ds_write2_b32 v12, v78, v79 offset1:16
  v_smfmac_f32_16x16x64_bf16 v[88:91], v[52:55], a[120:127], v1
  ds_read_b128 v[48:51], v10 offset:7168
  v_smfmac_f32_16x16x64_bf16 v[84:87], v[56:59], a[128:135], v1
  v_mov_b64 v[52:53], 0
  v_smfmac_f32_16x16x64_bf16 v[88:91], v[56:59], a[136:143], v1
  v_mov_b64 v[54:55], 0
  v_smfmac_f32_16x16x64_bf16 v[84:87], v[60:63], a[144:151], v1
  s_waitcnt lgkmcnt(1)
  s_barrier
  ds_read_b128 v[92:95], v11 offset:28672
  v_smfmac_f32_16x16x64_bf16 v[88:91], v[60:63], a[152:159], v1
  ds_read_b128 v[96:99], v11 offset:29184
  v_mov_b64 v[56:57], 0
  v_smfmac_f32_16x16x64_bf16 v[84:87], v[64:67], a[160:167], v1
  ds_read_b128 v[100:103], v11 offset:29696
  v_mov_b64 v[58:59], 0
  v_smfmac_f32_16x16x64_bf16 v[88:91], v[64:67], a[168:175], v1
  ds_read_b128 v[104:107], v11 offset:30208
  v_mov_b64 v[60:61], 0
  s_waitcnt lgkmcnt(3)
  v_mfma_f32_16x16x32_bf16 v[68:71], v[108:111], v[92:95], 0
  ds_read_b128 v[108:111], v11 offset:24576
  s_waitcnt lgkmcnt(3)
  v_mfma_f32_16x16x32_bf16 v[68:71], v[112:115], v[96:99], v[68:71]
  ds_read_b128 v[112:115], v11 offset:25088
  s_waitcnt lgkmcnt(3)
  v_mfma_f32_16x16x32_bf16 v[68:71], v[116:119], v[100:103], v[68:71]
  ds_read_b128 v[116:119], v11 offset:25600
  s_waitcnt lgkmcnt(3)
  v_mfma_f32_16x16x32_bf16 v[68:71], v[120:123], v[104:107], v[68:71]
  ds_read_b128 v[120:123], v11 offset:26112
  v_mov_b64 v[62:63], 0
  v_mfma_f32_16x16x32_bf16 v[72:75], v[36:39], v[92:95], 0
  v_add_f32 v84, v84, v86
  v_add_f32 v85, v85, v87
  v_mfma_f32_16x16x32_bf16 v[72:75], v[40:43], v[96:99], v[72:75]
  v_add_f32 v88, v88, v90
  v_add_f32 v89, v89, v91
  v_mfma_f32_16x16x32_bf16 v[72:75], v[44:47], v[100:103], v[72:75]
  v_cvt_pk_bf16_f32 v32, v84, v85
  v_cvt_pk_bf16_f32 v34, v88, v89
  v_mfma_f32_16x16x32_bf16 v[72:75], v[48:51], v[104:107], v[72:75]
  s_waitcnt lgkmcnt(3)
  v_max3_f32 v124, v68, v69, v70
  v_mfma_f32_16x16x32_bf16 v[76:79], v[108:111], v[92:95], 0
  ds_write_b32 v15, v32
  s_waitcnt lgkmcnt(3)
  v_mfma_f32_16x16x32_bf16 v[76:79], v[112:115], v[96:99], v[76:79]
  ds_write_b32 v15, v34 offset:256
  s_waitcnt lgkmcnt(3)
  v_mfma_f32_16x16x32_bf16 v[76:79], v[116:119], v[100:103], v[76:79]
  s_waitcnt lgkmcnt(2)
  v_mov_b64 v[64:65], 0
  v_mfma_f32_16x16x32_bf16 v[76:79], v[120:123], v[104:107], v[76:79]
  ds_read_b128 v[108:111], v13 offset:20480
  ds_read_b128 v[112:115], v13 offset:21504
  ds_read_b128 v[116:119], v13 offset:22528
  ds_read_b128 v[120:123], v13 offset:23552
  v_max3_f32 v125, v71, v72, v73
  v_max3_f32 v126, v74, v75, v124
  v_mov_b64 v[66:67], 0
  v_max_f32 v125, v125, v126
  v_max3_f32 v124, v125, v76, v77
  v_mov_b64 v[36:37], 0
  v_mov_b32 v125, v124
  v_mov_b64 v[38:39], 0
  v_mov_b64 v[40:41], 0
  v_permlane32_swap_b32 v124, v125
  v_max_f32 v124, v124, v125
  v_mov_b64 v[42:43], 0
  v_mov_b32 v125, v124
  v_mov_b64 v[44:45], 0
  v_mov_b64 v[46:47], 0
  v_permlane16_swap_b32 v124, v125
  v_max_f32 v124, v124, v125
  s_waitcnt vmcnt(6)
  v_mul_f32 v124, s6, v124
  v_pk_fma_f32 v[68:69], v[68:69], s[6:7], v[124:125] op_sel_hi:[1,1,0] neg_lo:[0,0,1] neg_hi:[0,0,1]
  v_pk_fma_f32 v[70:71], v[70:71], s[6:7], v[124:125] op_sel_hi:[1,1,0] neg_lo:[0,0,1] neg_hi:[0,0,1]
  v_pk_fma_f32 v[72:73], v[72:73], s[6:7], v[124:125] op_sel_hi:[1,1,0] neg_lo:[0,0,1] neg_hi:[0,0,1]
  v_pk_fma_f32 v[74:75], v[74:75], s[6:7], v[124:125] op_sel_hi:[1,1,0] neg_lo:[0,0,1] neg_hi:[0,0,1]
  v_pk_fma_f32 v[76:77], v[76:77], s[6:7], v[124:125] op_sel_hi:[1,1,0] neg_lo:[0,0,1] neg_hi:[0,0,1]
  v_exp_f32 v68, v68
  v_exp_f32 v69, v69
  v_exp_f32 v70, v70
  v_exp_f32 v71, v71
  v_exp_f32 v72, v72
  v_exp_f32 v73, v73
  v_exp_f32 v74, v74
  v_exp_f32 v75, v75
  v_exp_f32 v76, v76
  v_exp_f32 v77, v77
  v_cvt_pk_bf16_f32 v80, v68, v69
  v_cvt_pk_bf16_f32 v81, v70, v71
  v_cvt_pk_bf16_f32 v82, v72, v73
  v_cvt_pk_bf16_f32 v83, v74, v75
  v_cvt_pk_bf16_f32 v28, v76, v77
  v_add_f32 v76, v76, v77
  v_mfma_f32_16x16x32_bf16 v[92:95], v[20:23], v[80:83], 0
  v_add_f32 v68, v68, v69
  v_add_f32 v70, v70, v71
  v_mfma_f32_16x16x32_bf16 v[96:99], v[24:27], v[80:83], 0
  v_add_f32 v72, v72, v73
  v_add_f32 v74, v74, v75
  v_add_f32 v68, v68, v70
  v_mfma_f32_16x16x16_bf16 v[92:95], v[32:33], v[28:29], v[92:95]
  v_add_f32 v72, v72, v74
  v_add_f32 v68, v68, v76
  v_mfma_f32_16x16x16_bf16 v[96:99], v[34:35], v[28:29], v[96:99]
  v_add_f32 v124, v68, v72
  v_mov_b32 v125, v124
  v_mov_b64 v[48:49], 0
  v_mov_b64 v[50:51], 0
  v_permlane32_swap_b32 v124, v125
  v_add_f32 v124, v124, v125
  v_mov_b32 v125, v124
  s_mov_b64 exec, s[34:35]
  v_mov_b64 v[92:93], v[96:97]
  v_mov_b64 v[94:95], v[98:99]
  s_mov_b64 exec, -1
  v_permlane16_swap_b32 v124, v125
  v_add_f32 v124, v124, v125
  v_rcp_f32 v124, v124
  s_nop 0
  v_pk_mul_f32 v[92:93], v[92:93], v[124:125] op_sel_hi:[1,0]
  v_pk_mul_f32 v[94:95], v[94:95], v[124:125] op_sel_hi:[1,0]
  v_cvt_pk_bf16_f32 v92, v92, v93
  v_cvt_pk_bf16_f32 v93, v94, v95
  ds_write_b64 v14, v[92:93]
  s_waitcnt lgkmcnt(0)
  s_barrier
  ds_read_b128 v[100:103], v3 offset:30720
  ds_read_b128 v[104:107], v3 offset:31744
  ds_read_b128 v[68:71], v13 offset:24576
  ds_read_b128 v[72:75], v13 offset:25600
  ds_read_b128 v[76:79], v13 offset:26624
  ds_read_b128 v[80:83], v13 offset:27648
  s_waitcnt lgkmcnt(5)
  v_smfmac_f32_16x16x64_bf16 v[36:39], v[100:103], v[108:115], v1
  v_smfmac_f32_16x16x64_bf16 v[40:43], v[100:103], v[116:123], v1
  s_waitcnt lgkmcnt(4)
  v_smfmac_f32_16x16x64_bf16 v[36:39], v[104:107], a[176:183], v1
  ds_read_b128 v[108:111], v13 offset:28672
  v_smfmac_f32_16x16x64_bf16 v[40:43], v[104:107], a[184:191], v1
  ds_read_b128 v[112:115], v13 offset:29696
  v_smfmac_f32_16x16x64_bf16 v[44:47], v[100:103], a[192:199], v1
  ds_read_b128 v[116:119], v13 offset:30720
  v_smfmac_f32_16x16x64_bf16 v[48:51], v[100:103], a[200:207], v1
  ds_read_b128 v[120:123], v13 offset:31744
  v_add_f32 v36, v36, v38
  v_smfmac_f32_16x16x64_bf16 v[44:47], v[104:107], a[208:215], v1
  v_add_f32 v37, v37, v39
  v_cvt_pk_bf16_f32 v92, v36, v37
  v_smfmac_f32_16x16x64_bf16 v[48:51], v[104:107], a[216:223], v1
  v_add_f32 v40, v40, v42
  v_add_f32 v41, v41, v43
  v_smfmac_f32_16x16x64_bf16 v[52:55], v[100:103], a[224:231], v1
  v_cvt_pk_bf16_f32 v93, v40, v41
  v_bfi_b32 v92, 1, s18, v92
  v_smfmac_f32_16x16x64_bf16 v[56:59], v[100:103], a[232:239], v1
  v_add_f32 v44, v44, v46
  v_add_f32 v45, v45, v47
  v_smfmac_f32_16x16x64_bf16 v[52:55], v[104:107], a[240:247], v1
  v_cvt_pk_bf16_f32 v94, v44, v45
  v_add_f32 v48, v48, v50
  v_smfmac_f32_16x16x64_bf16 v[56:59], v[104:107], a[248:255], v1
  s_waitcnt lgkmcnt(0)
  v_add_f32 v49, v49, v51
  v_cvt_pk_bf16_f32 v95, v48, v49
  v_smfmac_f32_16x16x64_bf16 v[60:63], v[100:103], v[68:75], v1
  buffer_store_dwordx4 v[92:95], v2, s[8:11], 0 offen sc1
  v_smfmac_f32_16x16x64_bf16 v[64:67], v[100:103], v[76:83], v1
  v_add_f32 v52, v52, v54
  v_add_f32 v53, v53, v55
  v_smfmac_f32_16x16x64_bf16 v[60:63], v[104:107], v[108:115], v1
  v_cvt_pk_bf16_f32 v96, v52, v53
  v_add_f32 v56, v56, v58
  v_smfmac_f32_16x16x64_bf16 v[64:67], v[104:107], v[116:123], v1
  v_add_f32 v57, v57, v59
  v_cvt_pk_bf16_f32 v97, v56, v57
  v_bfi_b32 v96, 1, s18, v96
  s_nop 1
  v_pk_add_f32 v[60:61], v[60:61], v[62:63]
  v_cvt_pk_bf16_f32 v98, v60, v61
  s_nop 0
  v_pk_add_f32 v[64:65], v[64:65], v[66:67]
  v_cvt_pk_bf16_f32 v99, v64, v65
  buffer_store_dwordx4 v[96:99], v2, s[8:11], s22 offen sc1
  v_cndmask_b32 v84, 0, v30, s[72:73]
  v_cndmask_b32 v85, 0, v30, s[74:75]
  v_cndmask_b32 v86, 0, v30, s[76:77]
  v_cndmask_b32 v87, 0, v30, s[78:79]
  v_mov_b64 v[68:69], 0
  v_mov_b64 v[70:71], 0
  v_mov_b64 v[72:73], 0
  v_mov_b64 v[74:75], 0
  v_mov_b64 v[76:77], 0
  v_mov_b64 v[78:79], 0
  v_mov_b64 v[80:81], 0
  v_mov_b64 v[82:83], 0
  s_add_u32 s16, s16, 1
  s_add_u32 s24, s24, 524288
  s_add_u32 s26, s26, 131072
  s_cmp_lt_u32 s16, 62
  s_cselect_b32 s27, 524288, 0
  s_add_u32 s25, s25, s27
  s_cmp_lt_u32 s16, 63
  s_cselect_b32 s27, 524288, 0
  s_add_u32 s23, s23, s27
  s_xor_b32 s62, s62, 0x2000
  v_xor_b32 v10, 0x2000, v10
  v_mov_b32 v28, s16
  s_waitcnt vmcnt(4)
  v_cmp_ne_u32 s[30:31], 0, v18
  s_add_u32 s27, s16, 2
  s_min_u32 s27, s27, 63
  s_nop 1
  s_bitcmp1_b64 s[30:31], s27
  s_cbranch_scc1 L_kvs_s_ok
L_kvs_s_spin:
  buffer_load_dword v18, v19, s[8:11], s40 offen sc1
  s_waitcnt vmcnt(0)
  v_cmp_ne_u32 s[30:31], 0, v18
  s_add_u32 s39, s39, 1
  s_cmp_gt_u32 s39, 0x10000
  s_cbranch_scc1 L_abort
  s_nop 0
  s_bitcmp1_b64 s[30:31], s27
  s_cbranch_scc0 L_kvs_s_spin
L_kvs_s_ok:
  s_nop 15
  s_nop 15
  s_nop 15
  s_nop 15
  s_nop 15
  s_nop 15
  s_nop 3
  buffer_load_dwordx4 v[36:39], v3, s[8:11], s20 offen sc1
  buffer_load_dwordx4 v[40:43], v3, s[8:11], s20 offen offset:1024 sc1
  ds_read_b128 v[92:95], v13 offset:0
  ds_read_b128 v[96:99], v13 offset:1024
  ds_read_b128 v[100:103], v13 offset:2048
  ds_read_b128 v[104:107], v13 offset:3072
  ds_read_b128 v[108:111], v13 offset:4096
  ds_read_b128 v[112:115], v13 offset:5120
  ds_read_b128 v[116:119], v13 offset:6144
  ds_read_b128 v[120:123], v13 offset:7168
L_p1c_s:
  s_waitcnt vmcnt(1)
  v_mfma_f32_16x16x32_bf16 v[88:91], v[84:87], v[36:39], 0
  s_waitcnt vmcnt(0)
  v_mfma_f32_16x16x32_bf16 v[88:91], v[84:87], v[40:43], v[88:91]
  v_bitop3_b32 v18, 1, v36, s18 bitop3:0x90
  v_bitop3_b32 v18, v18, v40, s18 bitop3:0x90
  v_cmp_ne_u32 vcc, 1, v18
  s_cbranch_vccnz L_p1f_s
  s_nop 3
  v_add_f32_dpp v88, v88, v88 row_ror:8 row_mask:0xf bank_mask:0xf
  v_add_f32_dpp v89, v89, v89 row_ror:8 row_mask:0xf bank_mask:0xf
  v_add_f32_dpp v90, v90, v90 row_ror:8 row_mask:0xf bank_mask:0xf
  v_add_f32_dpp v91, v91, v91 row_ror:8 row_mask:0xf bank_mask:0xf
  v_add_f32_dpp v88, v88, v88 row_ror:4 row_mask:0xf bank_mask:0x5
  v_add_f32_dpp v90, v90, v90 row_ror:4 row_mask:0xf bank_mask:0x5
  s_nop 0
  v_add_f32_dpp v88, v89, v89 row_ror:4 row_mask:0xf bank_mask:0xa
  v_add_f32_dpp v90, v91, v91 row_ror:4 row_mask:0xf bank_mask:0xa
  s_mov_b64 exec, s[36:37]
  v_cvt_pk_bf16_f32 v124, v88, v90
  v_bfi_b32 v124, v0, s18, v124
  buffer_store_dword v124, v4, s[8:11], 0 offen sc1
  s_mov_b64 exec, -1
  ds_read_b128 v[124:127], v16
  v_mov_b64 v[84:85], 0
  v_mov_b64 v[86:87], 0
  v_mov_b64 v[88:89], 0
  v_mov_b64 v[90:91], 0
  s_nop 15
  s_nop 15
  s_nop 15
  s_nop 15
  s_nop 15
  s_nop 15
  s_nop 3
  s_xor_b32 s18, s18, 1
  buffer_load_dwordx4 v[36:39], v3, s[8:11], s21 offen sc1
  buffer_load_dwordx4 v[40:43], v3, s[8:11], s21 offen offset:1024 sc1
  s_cmp_lt_u32 s16, 63
  s_cbranch_scc1 L_step_s
L_p2c_st:
  s_waitcnt vmcnt(0) lgkmcnt(0)
  v_bitop3_b32 v18, 1, v39, s18 bitop3:0x60
  v_bitop3_b32 v18, v18, v43, s18 bitop3:0x60
  v_cmp_ne_u32 vcc, 1, v18
  s_cbranch_vccnz L_p2f_st
L_tail:
  ds_write_b128 v5, v[36:39]
  ds_write_b128 v5, v[40:43] offset:1024
  buffer_store_dwordx4 v[124:127], v3, s[8:11], s26 offen sc1
  s_waitcnt lgkmcnt(0)
  s_barrier
  s_cmp_eq_u32 s4, 1
  s_cbranch_scc0 L_te_132
  v_mov_b32 v20, 64
  s_mov_b64 exec, 1
  buffer_store_dword v20, v3, s[8:11], s41 offen sc1
  s_mov_b64 exec, -1
L_te_132:
  ds_read_b128 v[44:47], v6 offset:0
  ds_read_b128 v[48:51], v6 offset:1024
  ds_read_b128 v[52:55], v7 offset:0
  ds_read_b128 v[56:59], v7 offset:1024
  ds_read_b128 v[60:63], v8 offset:0
  ds_read_b128 v[64:67], v8 offset:1024
  ds_read_b128 v[92:95], v13 offset:12288
  ds_read_b128 v[96:99], v13 offset:13312
  ds_read_b128 v[100:103], v13 offset:14336
  ds_read_b128 v[104:107], v13 offset:15360
  v_smfmac_f32_16x16x64_bf16 v[76:79], v[36:39], v[108:115], v1
  v_smfmac_f32_16x16x64_bf16 v[80:83], v[36:39], v[116:123], v1
  v_smfmac_f32_16x16x64_bf16 v[76:79], v[40:43], v[240:247], v1
  v_smfmac_f32_16x16x64_bf16 v[80:83], v[40:43], v[248:255], v1
  ds_read_b128 v[108:111], v13 offset:16384
  ds_read_b128 v[112:115], v13 offset:17408
  ds_read_b128 v[116:119], v13 offset:18432
  ds_read_b128 v[120:123], v13 offset:19456
  v_smfmac_f32_16x16x64_bf16 v[84:87], v[36:39], a[64:71], v1
  v_smfmac_f32_16x16x64_bf16 v[88:91], v[36:39], a[72:79], v1
  s_waitcnt lgkmcnt(8)
  v_smfmac_f32_16x16x64_bf16 v[76:79], v[52:55], a[0:7], v1
  v_smfmac_f32_16x16x64_bf16 v[80:83], v[52:55], a[8:15], v1
  v_smfmac_f32_16x16x64_bf16 v[76:79], v[56:59], a[16:23], v1
  v_smfmac_f32_16x16x64_bf16 v[80:83], v[56:59], a[24:31], v1
  v_smfmac_f32_16x16x64_bf16 v[76:79], v[60:63], a[32:39], v1
  v_smfmac_f32_16x16x64_bf16 v[80:83], v[60:63], a[40:47], v1
  v_smfmac_f32_16x16x64_bf16 v[76:79], v[64:67], a[48:55], v1
  v_smfmac_f32_16x16x64_bf16 v[80:83], v[64:67], a[56:63], v1
  s_waitcnt lgkmcnt(0)
  v_smfmac_f32_16x16x64_bf16 v[76:79], v[44:47], v[92:99], v1
  v_smfmac_f32_16x16x64_bf16 v[80:83], v[44:47], v[100:107], v1
  v_smfmac_f32_16x16x64_bf16 v[76:79], v[48:51], v[108:115], v1
  v_smfmac_f32_16x16x64_bf16 v[80:83], v[48:51], v[116:123], v1
  ds_read_b128 v[92:95], v13 offset:8192
  ds_read_b128 v[96:99], v13 offset:9216
  ds_read_b128 v[100:103], v13 offset:10240
  ds_read_b128 v[104:107], v13 offset:11264
  v_smfmac_f32_16x16x64_bf16 v[84:87], v[44:47], a[80:87], v1
  v_smfmac_f32_16x16x64_bf16 v[88:91], v[44:47], a[88:95], v1
  v_smfmac_f32_16x16x64_bf16 v[84:87], v[48:51], a[96:103], v1
  v_smfmac_f32_16x16x64_bf16 v[88:91], v[48:51], a[104:111], v1
  v_smfmac_f32_16x16x64_bf16 v[84:87], v[52:55], a[112:119], v1
  v_smfmac_f32_16x16x64_bf16 v[88:91], v[52:55], a[120:127], v1
  v_smfmac_f32_16x16x64_bf16 v[84:87], v[56:59], a[128:135], v1
  v_smfmac_f32_16x16x64_bf16 v[88:91], v[56:59], a[136:143], v1
  v_smfmac_f32_16x16x64_bf16 v[84:87], v[60:63], a[144:151], v1
  v_smfmac_f32_16x16x64_bf16 v[88:91], v[60:63], a[152:159], v1
  v_smfmac_f32_16x16x64_bf16 v[84:87], v[64:67], a[160:167], v1
  v_smfmac_f32_16x16x64_bf16 v[88:91], v[64:67], a[168:175], v1
  s_waitcnt lgkmcnt(0)
  v_smfmac_f32_16x16x64_bf16 v[84:87], v[40:43], v[92:99], v1
  v_smfmac_f32_16x16x64_bf16 v[88:91], v[40:43], v[100:107], v1
  v_add_f32 v76, v76, v78
  v_add_f32 v77, v77, v79
  v_add_f32 v80, v80, v82
  v_add_f32 v81, v81, v83
  v_cvt_pk_bf16_f32 v68, v76, v80
  v_cvt_pk_bf16_f32 v69, v77, v81
  ds_write2_b32 v12, v68, v69 offset1:16
  v_add_f32 v84, v84, v86
  v_add_f32 v85, v85, v87
  v_cvt_pk_bf16_f32 v72, v84, v85
  v_add_f32 v88, v88, v90
  v_add_f32 v89, v89, v91
  v_cvt_pk_bf16_f32 v73, v88, v89
  ds_write_b32 v15, v72
  ds_write_b32 v15, v73 offset:256
  s_waitcnt lgkmcnt(0)
  s_barrier
  ds_read_b128 v[124:127], v16
  s_add_u32 s26, s26, 131072
  s_waitcnt lgkmcnt(0)
  buffer_store_dwordx4 v[124:127], v3, s[8:11], s26 offen sc1
  s_waitcnt vmcnt(0)
  s_barrier
  s_cmp_eq_u32 s4, 1
  s_cbranch_scc0 L_pf_133
  v_mov_b32 v18, 65
  s_mov_b64 exec, 1
  buffer_store_dword v18, v3, s[8:11], s41 offen sc1
  s_mov_b64 exec, -1
L_pf_133:
  s_add_u32 s72, s5, 96
  s_lshl_b32 s72, s72, 2
  s_add_u32 s72, s72, s4
  s_mul_i32 s72, s72, 36864
  s_add_u32 s72, s72, 118489088
  s_add_u32 s73, s5, 224
  s_mul_i32 s74, s4, 36864
  s_add_u32 s74, s74, 132644864
  v_lshlrev_b32 v92, 2, v3
  s_add_u32 s27, s72, 24576
  buffer_load_dword v93, v92, s[8:11], s27 offen sc1
  s_add_u32 s27, s74, 0
  buffer_load_dword v93, v92, s[8:11], s27 offen sc1
  s_add_u32 s27, s74, 4096
  buffer_load_dword v93, v92, s[8:11], s27 offen sc1
  s_add_u32 s27, s74, 8192
  buffer_load_dword v93, v92, s[8:11], s27 offen sc1
  s_add_u32 s27, s74, 12288
  buffer_load_dword v93, v92, s[8:11], s27 offen sc1
  s_add_u32 s27, s74, 16384
  buffer_load_dword v93, v92, s[8:11], s27 offen sc1
L_tt_134:
  s_add_u32 s27, s74, 12288
  buffer_load_dwordx4 v[112:115], v3, s[8:11], s27 offen offset:0 sc1
  s_add_u32 s27, s74, 12288
  buffer_load_dwordx4 v[116:119], v3, s[8:11], s27 offen offset:1024 sc1
  s_add_u32 s27, s74, 12288
  buffer_load_dwordx4 v[120:123], v3, s[8:11], s27 offen offset:2048 sc1
  s_add_u32 s27, s74, 12288
  buffer_load_dwordx4 v[124:127], v3, s[8:11], s27 offen offset:3072 sc1
  s_add_u32 s27, s74, 4096
  buffer_load_dwordx4 v[88:91], v3, s[8:11], s27 offen offset:2048 sc1
  s_add_u32 s27, s74, 4096
  buffer_load_dwordx4 v[92:95], v3, s[8:11], s27 offen offset:3072 sc1
  s_add_u32 s27, s74, 8192
  buffer_load_dwordx4 v[96:99], v3, s[8:11], s27 offen offset:0 sc1
  s_add_u32 s27, s74, 8192
  buffer_load_dwordx4 v[100:103], v3, s[8:11], s27 offen offset:1024 sc1
  s_add_u32 s27, s74, 8192
  buffer_load_dwordx4 v[104:107], v3, s[8:11], s27 offen offset:2048 sc1
  s_add_u32 s27, s74, 8192
  buffer_load_dwordx4 v[108:111], v3, s[8:11], s27 offen offset:3072 sc1
  v_lshrrev_b32 v32, 8, v3
  v_bfe_u32 v33, v3, 4, 4
  v_lshrrev_b32 v34, 2, v33
  v_and_b32 v35, 3, v33
  v_lshl_add_u32 v28, v32, 3, v34
  v_lshlrev_b32 v20, 7, v28
  v_lshl_add_u32 v20, v35, 3, v20
  s_lshl_b32 s28, s4, 5
  v_add_u32 v20, s28, v20
  v_mul_u32_u24 v25, 40, v28
  v_lshl_add_u32 v25, v35, 3, v25
  s_mul_i32 s29, s4, 2560
  v_add_u32 v25, s29, v25
  v_mul_u32_u24 v24, 40, v33
  v_lshl_add_u32 v24, v32, 3, v24
  v_add_u32 v24, s29, v24
  v_mul_u32_u24 v21, 72, v33
  v_lshl_add_u32 v21, v32, 3, v21
  s_mul_i32 s29, s4, 1152
  v_add_u32 v21, s29, v21
  v_lshl_add_u32 v28, v32, 2, v34
  v_mul_u32_u24 v22, 72, v28
  v_lshl_add_u32 v22, v35, 3, v22
  s_lshr_b32 s29, s4, 1
  s_lshl_b32 s29, s29, 10
  v_add_u32 v23, s29, v3
  s_and_b32 s29, s4, 1
  s_lshl_b32 s29, s29, 3
  v_add_u32 v23, s29, v23
  v_mul_u32_u24 v26, 0x90, v33
  v_lshl_add_u32 v26, v32, 3, v26
  v_add_u32 v26, s28, v26
  v_lshrrev_b32 v28, 7, v3
  v_mul_u32_u24 v27, 0x90, v28
  v_and_b32 v28, 0x70, v3
  v_add_u32 v27, v27, v28
  s_mul_i32 s29, s4, 2304
  v_add_u32 v27, s29, v27
  v_lshrrev_b32 v18, 6, v3
  v_lshlrev_b32 v18, 15, v18
  v_and_b32 v28, 0x30, v3
  v_add_u32 v18, v18, v28
  s_and_b32 s29, s4, 1
  s_lshl_b32 s29, s29, 20
  s_lshr_b32 s28, s4, 1
  s_lshl_b32 s28, s28, 6
  s_add_u32 s29, s29, s28
  s_lshl_b32 s28, s73, 7
  s_add_u32 s29, s29, s28
  s_lshl_b32 s28, s17, 21
  s_add_u32 s29, s29, s28
  v_add_u32 v18, s29, v18
  s_add_u32 s27, s74, 0
  buffer_load_dwordx4 v[64:67], v3, s[8:11], s27 offen offset:0 sc1
  s_add_u32 s27, s74, 0
  buffer_load_dwordx4 v[68:71], v3, s[8:11], s27 offen offset:1024 sc1
  s_add_u32 s27, s74, 0
  buffer_load_dwordx4 v[72:75], v3, s[8:11], s27 offen offset:2048 sc1
  s_add_u32 s27, s74, 0
  buffer_load_dwordx4 v[76:79], v3, s[8:11], s27 offen offset:3072 sc1
  s_add_u32 s27, s74, 4096
  buffer_load_dwordx4 v[80:83], v3, s[8:11], s27 offen offset:0 sc1
  s_add_u32 s27, s74, 4096
  buffer_load_dwordx4 v[84:87], v3, s[8:11], s27 offen offset:1024 sc1
  s_lshl_b32 s28, s17, 8
  s_add_u32 s73, s73, s28
  s_cmp_eq_u32 s4, 1
  s_cbranch_scc0 L_zf_135_ok
  s_lshr_b32 s27, s73, 3
  s_lshl_b32 s27, s27, 8
  s_add_u32 s27, s27, 354304
  v_lshrrev_b32 v28, 2, v3
L_zf_135:
  buffer_load_dword v29, v28, s[8:11], s27 offen sc1
  s_waitcnt vmcnt(0)
  v_cmp_eq_u32 vcc, 0, v29
  s_cbranch_vccz L_zf_135_ok
  s_add_u32 s39, s39, 1
  s_cmp_gt_u32 s39, 0x10000
  s_cbranch_scc1 L_abort
  s_sleep 1
  s_branch L_zf_135
L_zf_135_ok:
  s_lshl_b32 s29, s73, 13
  s_lshl_b32 s28, s4, 11
  s_add_u32 s29, s29, s28
  s_add_u32 s27, s29, 163577856
  s_add_u32 m0, s28, 0
  s_mov_b32 s75, 0
L_zf_135_z:
  s_barrier
  s_add_u32 s27, s29, 163577856
  buffer_load_dwordx4 v3, s[8:11], s27 offen sc1 lds
  buffer_load_dwordx4 v3, s[8:11], s27 offen offset:1024 sc1 lds
  s_waitcnt vmcnt(0)
  s_barrier
  ds_read_b64_tr_b16 v[48:49], v20 offset:0
  ds_read_b64_tr_b16 v[50:51], v20 offset:512
  ds_read_b64_tr_b16 v[52:53], v20 offset:4096
  ds_read_b64_tr_b16 v[54:55], v20 offset:4608
  s_waitcnt lgkmcnt(0)
  v_mfma_f32_16x16x32_bf16 v[32:35], v[64:67], v[48:51], 0
  v_mfma_f32_16x16x32_bf16 v[40:43], v[64:67], v[52:55], 0
  v_mfma_f32_16x16x32_bf16 v[36:39], v[68:71], v[48:51], 0
  v_mfma_f32_16x16x32_bf16 v[44:47], v[68:71], v[52:55], 0
  v_mfma_f32_16x16x32_bf16 v[32:35], v[72:75], v[52:55], v[32:35]
  v_mfma_f32_16x16x32_bf16 v[40:43], v[80:83], v[48:51], v[40:43]
  v_mfma_f32_16x16x32_bf16 v[36:39], v[76:79], v[52:55], v[36:39]
  v_mfma_f32_16x16x32_bf16 v[44:47], v[84:87], v[48:51], v[44:47]
  s_nop 3
  v_cmp_u_f32 vcc, v32, v40
  s_nop 1
  v_cndmask_b32 v56, 0, 1, vcc
  v_pk_mul_f32 v[28:29], v[32:33], v[112:113]
  v_pk_mul_f32 v[30:31], v[40:41], v[112:113]
  v_pk_fma_f32 v[28:29], v[40:41], v[120:121], v[28:29]
  v_pk_fma_f32 v[30:31], v[32:33], v[120:121], v[30:31] neg_lo:[1,0,0] neg_hi:[1,0,0]
  v_cvt_pk_bf16_f32 v32, v28, v29
  v_cvt_pk_bf16_f32 v40, v30, v31
  v_pk_mul_f32 v[28:29], v[34:35], v[114:115]
  v_pk_mul_f32 v[30:31], v[42:43], v[114:115]
  v_pk_fma_f32 v[28:29], v[42:43], v[122:123], v[28:29]
  v_pk_fma_f32 v[30:31], v[34:35], v[122:123], v[30:31] neg_lo:[1,0,0] neg_hi:[1,0,0]
  v_cvt_pk_bf16_f32 v33, v28, v29
  v_cvt_pk_bf16_f32 v41, v30, v31
  v_pk_mul_f32 v[28:29], v[36:37], v[116:117]
  v_pk_mul_f32 v[30:31], v[44:45], v[116:117]
  v_pk_fma_f32 v[28:29], v[44:45], v[124:125], v[28:29]
  v_pk_fma_f32 v[30:31], v[36:37], v[124:125], v[30:31] neg_lo:[1,0,0] neg_hi:[1,0,0]
  v_cvt_pk_bf16_f32 v34, v28, v29
  v_cvt_pk_bf16_f32 v42, v30, v31
  v_pk_mul_f32 v[28:29], v[38:39], v[118:119]
  v_pk_mul_f32 v[30:31], v[46:47], v[118:119]
  v_pk_fma_f32 v[28:29], v[46:47], v[126:127], v[28:29]
  v_pk_fma_f32 v[30:31], v[38:39], v[126:127], v[30:31] neg_lo:[1,0,0] neg_hi:[1,0,0]
  v_cvt_pk_bf16_f32 v35, v28, v29
  v_cvt_pk_bf16_f32 v43, v30, v31
  ds_write_b64 v21, v[32:33] offset:10240
  ds_write_b64 v21, v[34:35] offset:10272
  ds_write_b64 v21, v[40:41] offset:14848
  ds_write_b64 v21, v[42:43] offset:14880
  s_lshl_b32 s27, s4, 6
  v_lshrrev_b32 v57, 4, v3
  v_add_u32 v58, s27, v57
  ds_write_b8 v58, v56 offset:27648
  s_add_u32 s27, s72, 24576
  buffer_load_dwordx4 v[112:115], v3, s[8:11], s27 offen offset:0 sc1
  s_add_u32 s27, s72, 24576
  buffer_load_dwordx4 v[116:119], v3, s[8:11], s27 offen offset:1024 sc1
  s_add_u32 s27, s72, 24576
  buffer_load_dwordx4 v[120:123], v3, s[8:11], s27 offen offset:2048 sc1
  s_add_u32 s27, s72, 24576
  buffer_load_dwordx4 v[124:127], v3, s[8:11], s27 offen offset:3072 sc1
  v_lshlrev_b32 v57, 2, v57
  s_waitcnt lgkmcnt(0)
  s_barrier
  ds_read_b32 v28, v57 offset:27648
  ds_read_b64_tr_b16 v[48:49], v22 offset:10240
  ds_read_b64_tr_b16 v[50:51], v22 offset:11392
  ds_read_b64_tr_b16 v[56:57], v22 offset:14848
  ds_read_b64_tr_b16 v[58:59], v22 offset:16000
  ds_read_b64_tr_b16 v[52:53], v22 offset:12544
  ds_read_b64_tr_b16 v[54:55], v22 offset:13696
  ds_read_b64_tr_b16 v[60:61], v22 offset:17152
  ds_read_b64_tr_b16 v[62:63], v22 offset:18304
  s_waitcnt lgkmcnt(4)
  v_cmp_ne_u32 vcc, 0, v28
  s_cbranch_vccz L_zf_135_g
  s_add_u32 s75, s75, 1
  s_cmp_lt_u32 s75, 200
  s_cbranch_scc0 L_zf_135_g
  s_waitcnt vmcnt(0) lgkmcnt(0)
  s_add_u32 s27, s74, 12288
  buffer_load_dwordx4 v[112:115], v3, s[8:11], s27 offen offset:0 sc1
  s_add_u32 s27, s74, 12288
  buffer_load_dwordx4 v[116:119], v3, s[8:11], s27 offen offset:1024 sc1
  s_add_u32 s27, s74, 12288
  buffer_load_dwordx4 v[120:123], v3, s[8:11], s27 offen offset:2048 sc1
  s_add_u32 s27, s74, 12288
  buffer_load_dwordx4 v[124:127], v3, s[8:11], s27 offen offset:3072 sc1
  s_branch L_zf_135_z
L_zf_135_g:
  v_mfma_f32_16x16x32_bf16 v[32:35], v[88:91], v[48:51], 0
  v_mfma_f32_16x16x32_bf16 v[40:43], v[88:91], v[56:59], 0
  v_mfma_f32_16x16x32_bf16 v[32:35], v[96:99], v[56:59], v[32:35]
  v_mfma_f32_16x16x32_bf16 v[40:43], v[104:107], v[48:51], v[40:43]
  ds_read_b64_tr_b16 v[48:49], v22 offset:10272
  ds_read_b64_tr_b16 v[50:51], v22 offset:11424
  ds_read_b64_tr_b16 v[56:57], v22 offset:14880
  ds_read_b64_tr_b16 v[58:59], v22 offset:16032
  s_waitcnt lgkmcnt(4)
  v_mfma_f32_16x16x32_bf16 v[32:35], v[92:95], v[52:55], v[32:35]
  v_mfma_f32_16x16x32_bf16 v[40:43], v[92:95], v[60:63], v[40:43]
  v_mfma_f32_16x16x32_bf16 v[32:35], v[100:103], v[60:63], v[32:35]
  v_mfma_f32_16x16x32_bf16 v[40:43], v[108:111], v[52:55], v[40:43]
  ds_read_b64_tr_b16 v[52:53], v22 offset:12576
  ds_read_b64_tr_b16 v[54:55], v22 offset:13728
  ds_read_b64_tr_b16 v[60:61], v22 offset:17184
  ds_read_b64_tr_b16 v[62:63], v22 offset:18336
  s_waitcnt lgkmcnt(4)
  v_mfma_f32_16x16x32_bf16 v[36:39], v[88:91], v[48:51], 0
  v_mfma_f32_16x16x32_bf16 v[44:47], v[88:91], v[56:59], 0
  v_mfma_f32_16x16x32_bf16 v[36:39], v[96:99], v[56:59], v[36:39]
  v_mfma_f32_16x16x32_bf16 v[44:47], v[104:107], v[48:51], v[44:47]
  s_waitcnt lgkmcnt(0)
  v_mfma_f32_16x16x32_bf16 v[36:39], v[92:95], v[52:55], v[36:39]
  v_mfma_f32_16x16x32_bf16 v[44:47], v[92:95], v[60:63], v[44:47]
  v_mfma_f32_16x16x32_bf16 v[36:39], v[100:103], v[60:63], v[36:39]
  v_mfma_f32_16x16x32_bf16 v[44:47], v[108:111], v[52:55], v[44:47]
  s_waitcnt vmcnt(0)
  v_pk_mul_f32 v[28:29], v[32:33], v[112:113]
  v_pk_mul_f32 v[30:31], v[40:41], v[112:113]
  v_pk_fma_f32 v[28:29], v[40:41], v[120:121], v[28:29] neg_lo:[1,0,0] neg_hi:[1,0,0]
  v_pk_fma_f32 v[30:31], v[32:33], v[120:121], v[30:31]
  v_cvt_pk_bf16_f32 v32, v28, v29
  v_cvt_pk_bf16_f32 v40, -v30, -v31
  v_pk_mul_f32 v[28:29], v[34:35], v[114:115]
  v_pk_mul_f32 v[30:31], v[42:43], v[114:115]
  v_pk_fma_f32 v[28:29], v[42:43], v[122:123], v[28:29] neg_lo:[1,0,0] neg_hi:[1,0,0]
  v_pk_fma_f32 v[30:31], v[34:35], v[122:123], v[30:31]
  v_cvt_pk_bf16_f32 v33, v28, v29
  v_cvt_pk_bf16_f32 v41, -v30, -v31
  v_pk_mul_f32 v[28:29], v[36:37], v[116:117]
  v_pk_mul_f32 v[30:31], v[44:45], v[116:117]
  v_pk_fma_f32 v[28:29], v[44:45], v[124:125], v[28:29] neg_lo:[1,0,0] neg_hi:[1,0,0]
  v_pk_fma_f32 v[30:31], v[36:37], v[124:125], v[30:31]
  v_cvt_pk_bf16_f32 v34, v28, v29
  v_cvt_pk_bf16_f32 v42, -v30, -v31
  v_pk_mul_f32 v[28:29], v[38:39], v[118:119]
  v_pk_mul_f32 v[30:31], v[46:47], v[118:119]
  v_pk_fma_f32 v[28:29], v[46:47], v[126:127], v[28:29] neg_lo:[1,0,0] neg_hi:[1,0,0]
  v_pk_fma_f32 v[30:31], v[38:39], v[126:127], v[30:31]
  v_cvt_pk_bf16_f32 v35, v28, v29
  v_cvt_pk_bf16_f32 v43, -v30, -v31
  ds_write_b64 v23, v[32:33] offset:19456
  ds_write_b64 v23, v[34:35] offset:23552
  ds_write_b64 v23, v[40:41] offset:21504
  ds_write_b64 v23, v[42:43] offset:25600
  s_add_u32 s27, s74, 16384
  buffer_load_dwordx4 v[112:115], v3, s[8:11], s27 offen offset:0 sc1
  s_add_u32 s27, s74, 16384
  buffer_load_dwordx4 v[116:119], v3, s[8:11], s27 offen offset:1024 sc1
  s_add_u32 s27, s74, 16384
  buffer_load_dwordx4 v[120:123], v3, s[8:11], s27 offen offset:2048 sc1
  s_add_u32 s27, s74, 16384
  buffer_load_dwordx4 v[124:127], v3, s[8:11], s27 offen offset:3072 sc1
  s_waitcnt lgkmcnt(0)
  s_barrier
  ds_read_b128 v[48:51], v3 offset:19456
  ds_read_b128 v[56:59], v3 offset:21504
  ds_read_b128 v[52:55], v3 offset:20480
  ds_read_b128 v[60:63], v3 offset:22528
  s_waitcnt lgkmcnt(2)
  v_mfma_f32_16x16x32_bf16 v[32:35], v[88:91], v[48:51], 0
  v_mfma_f32_16x16x32_bf16 v[40:43], v[88:91], v[56:59], 0
  v_mfma_f32_16x16x32_bf16 v[32:35], v[96:99], v[56:59], v[32:35]
  v_mfma_f32_16x16x32_bf16 v[40:43], v[104:107], v[48:51], v[40:43]
  ds_read_b128 v[48:51], v3 offset:23552
  ds_read_b128 v[56:59], v3 offset:25600
  s_waitcnt lgkmcnt(2)
  v_mfma_f32_16x16x32_bf16 v[32:35], v[92:95], v[52:55], v[32:35]
  v_mfma_f32_16x16x32_bf16 v[40:43], v[92:95], v[60:63], v[40:43]
  v_mfma_f32_16x16x32_bf16 v[32:35], v[100:103], v[60:63], v[32:35]
  v_mfma_f32_16x16x32_bf16 v[40:43], v[108:111], v[52:55], v[40:43]
  ds_read_b128 v[52:55], v3 offset:24576
  ds_read_b128 v[60:63], v3 offset:26624
  s_waitcnt lgkmcnt(2)
  v_mfma_f32_16x16x32_bf16 v[36:39], v[88:91], v[48:51], 0
  v_mfma_f32_16x16x32_bf16 v[44:47], v[88:91], v[56:59], 0
  v_mfma_f32_16x16x32_bf16 v[36:39], v[96:99], v[56:59], v[36:39]
  v_mfma_f32_16x16x32_bf16 v[44:47], v[104:107], v[48:51], v[44:47]
  s_waitcnt lgkmcnt(0)
  v_mfma_f32_16x16x32_bf16 v[36:39], v[92:95], v[52:55], v[36:39]
  v_mfma_f32_16x16x32_bf16 v[44:47], v[92:95], v[60:63], v[44:47]
  v_mfma_f32_16x16x32_bf16 v[36:39], v[100:103], v[60:63], v[36:39]
  v_mfma_f32_16x16x32_bf16 v[44:47], v[108:111], v[52:55], v[44:47]
  s_waitcnt vmcnt(0)
  v_pk_mul_f32 v[28:29], v[32:33], v[112:113]
  v_pk_mul_f32 v[30:31], v[40:41], v[112:113]
  v_pk_fma_f32 v[28:29], v[40:41], v[120:121], v[28:29]
  v_pk_fma_f32 v[30:31], v[32:33], v[120:121], v[30:31] neg_lo:[1,0,0] neg_hi:[1,0,0]
  v_cvt_pk_bf16_f32 v32, v28, v29
  v_cvt_pk_bf16_f32 v40, v30, v31
  v_pk_mul_f32 v[28:29], v[34:35], v[114:115]
  v_pk_mul_f32 v[30:31], v[42:43], v[114:115]
  v_pk_fma_f32 v[28:29], v[42:43], v[122:123], v[28:29]
  v_pk_fma_f32 v[30:31], v[34:35], v[122:123], v[30:31] neg_lo:[1,0,0] neg_hi:[1,0,0]
  v_cvt_pk_bf16_f32 v33, v28, v29
  v_cvt_pk_bf16_f32 v41, v30, v31
  v_pk_mul_f32 v[28:29], v[36:37], v[116:117]
  v_pk_mul_f32 v[30:31], v[44:45], v[116:117]
  v_pk_fma_f32 v[28:29], v[44:45], v[124:125], v[28:29]
  v_pk_fma_f32 v[30:31], v[36:37], v[124:125], v[30:31] neg_lo:[1,0,0] neg_hi:[1,0,0]
  v_cvt_pk_bf16_f32 v34, v28, v29
  v_cvt_pk_bf16_f32 v42, v30, v31
  v_pk_mul_f32 v[28:29], v[38:39], v[118:119]
  v_pk_mul_f32 v[30:31], v[46:47], v[118:119]
  v_pk_fma_f32 v[28:29], v[46:47], v[126:127], v[28:29]
  v_pk_fma_f32 v[30:31], v[38:39], v[126:127], v[30:31] neg_lo:[1,0,0] neg_hi:[1,0,0]
  v_cvt_pk_bf16_f32 v35, v28, v29
  v_cvt_pk_bf16_f32 v43, v30, v31
  ds_write_b64 v24, v[32:33] offset:0
  ds_write_b64 v24, v[34:35] offset:640
  ds_write_b64 v24, v[40:41] offset:1280
  ds_write_b64 v24, v[42:43] offset:1920
  ds_read_b64_tr_b16 v[48:49], v25 offset:0
  ds_read_b64_tr_b16 v[50:51], v25 offset:160
  ds_read_b64_tr_b16 v[52:53], v25 offset:1280
  ds_read_b64_tr_b16 v[54:55], v25 offset:1440
  s_waitcnt lgkmcnt(0)
  v_mfma_f32_16x16x32_bf16 v[32:35], v[48:51], v[64:67], 0
  v_mfma_f32_16x16x32_bf16 v[40:43], v[52:55], v[64:67], 0
  v_mfma_f32_16x16x32_bf16 v[36:39], v[48:51], v[68:71], 0
  v_mfma_f32_16x16x32_bf16 v[44:47], v[52:55], v[68:71], 0
  v_mfma_f32_16x16x32_bf16 v[32:35], v[52:55], v[72:75], v[32:35]
  v_mfma_f32_16x16x32_bf16 v[40:43], v[48:51], v[80:83], v[40:43]
  v_mfma_f32_16x16x32_bf16 v[36:39], v[52:55], v[76:79], v[36:39]
  v_mfma_f32_16x16x32_bf16 v[44:47], v[48:51], v[84:87], v[44:47]
  v_cvt_pk_bf16_f32 v32, v32, v33
  v_cvt_pk_bf16_f32 v33, v34, v35
  ds_write_b64 v26, v[32:33] offset:10240
  s_nop 3
  v_cvt_pk_bf16_f32 v36, v36, v37
  v_cvt_pk_bf16_f32 v37, v38, v39
  ds_write_b64 v26, v[36:37] offset:12544
  v_cvt_pk_bf16_f32 v40, -v40, -v41
  v_cvt_pk_bf16_f32 v41, -v42, -v43
  ds_write_b64 v26, v[40:41] offset:14848
  v_cvt_pk_bf16_f32 v44, -v44, -v45
  v_cvt_pk_bf16_f32 v45, -v46, -v47
  ds_write_b64 v26, v[44:45] offset:17152
  s_mov_b32 s27, 99614720
  s_mov_b32 s28, 100139008
  s_waitcnt lgkmcnt(0)
  s_barrier
  ds_read_b128 v[48:51], v27 offset:10240
  ds_read_b128 v[52:55], v27 offset:11392
  s_waitcnt lgkmcnt(1)
  buffer_store_dwordx4 v[48:51], v18, s[8:11], s27 offen sc1
  s_waitcnt lgkmcnt(0)
  buffer_store_dwordx4 v[52:55], v18, s[8:11], s28 offen sc1
  s_lshl_b32 s27, s73, 2
  s_add_u32 s27, s27, 352256
  v_mov_b32 v28, 1
  s_barrier
  s_cmp_eq_u32 s4, 0
  s_cbranch_scc0 L_zf_135_nf
  s_mov_b64 exec, 1
  buffer_store_dword v28, v3, s[8:11], s27 offen sc1
  s_mov_b64 exec, -1
L_zf_135_nf:
  s_cmp_eq_u32 s17, 0
  s_cbranch_scc0 L_zf_135_n2
  s_cmp_eq_u32 s4, 1
  s_add_u32 s76, s27, 24576
L_zf_135_n2:
  s_waitcnt vmcnt(0)
  s_barrier
  s_cmp_eq_u32 s17, 0
  s_cbranch_scc0 L_y2_136
  s_cmp_eq_u32 s4, 0
  s_cbranch_scc0 L_y2_136
  s_mov_b64 exec, 1
  buffer_store_dword v28, v3, s[8:11], s76 offen sc1
  s_mov_b64 exec, -1
L_y2_136:
  v_mov_b32 v20, 0
  v_mov_b32 v21, 0
  v_mov_b32 v22, 0
  v_mov_b32 v23, 0
  v_mov_b32 v24, 0
  v_mov_b32 v25, 0
  v_mov_b32 v26, 0
  v_mov_b32 v27, 0
  v_mov_b32 v28, 0
  v_mov_b32 v29, 0
  v_mov_b32 v30, 0
  v_mov_b32 v31, 0
  v_mov_b32 v32, 0
  v_mov_b32 v33, 0
  v_mov_b32 v34, 0
  v_mov_b32 v35, 0
  v_bfe_u32 v94, v3, 4, 4
  v_and_b32 v95, 1, v94
  v_lshlrev_b32 v95, 4, v95
  v_mov_b32 v30, 0x3f80
  v_lshlrev_b32 v30, v95, v30
  s_mov_b32 s72, 0x30003
  s_mov_b32 s73, 0x30003
  s_mov_b32 s74, 0xc000c
  s_mov_b32 s75, 0xc000c
  s_mov_b32 s76, 0x300030
  s_mov_b32 s77, 0x300030
  s_mov_b32 s78, 0xc000c0
  s_mov_b32 s79, 0xc000c0
  s_add_u32 s17, s17, 1
  s_cmp_lt_u32 s17, 2
  s_cbranch_scc1 L_layer
  s_branch L_abort
L_p2f_f:
  buffer_load_dwordx4 v[36:39], v3, s[8:11], s21 offen sc1
  buffer_load_dwordx4 v[40:43], v3, s[8:11], s21 offen offset:1024 sc1
  s_add_u32 s39, s39, 1
  s_cmp_gt_u32 s39, 0x10000
  s_cbranch_scc1 L_abort
  s_branch L_p2c_f
L_p1f_f:
  s_add_u32 s39, s39, 1
  s_cmp_gt_u32 s39, 0x10000
  s_cbranch_scc1 L_abort
  s_waitcnt vmcnt(1)
  v_mfma_f32_16x16x32_bf16 v[88:91], v[84:87], v[44:47], 0
  s_waitcnt vmcnt(0)
  v_mfma_f32_16x16x32_bf16 v[88:91], v[84:87], v[48:51], v[88:91]
  v_bitop3_b32 v18, 1, v44, s18 bitop3:0x90
  v_bitop3_b32 v18, v18, v48, s18 bitop3:0x90
  v_cmp_ne_u32 vcc, 1, v18
  s_cbranch_vccnz L_p1g_f
  s_branch L_p1k_f
L_p1g_f:
  buffer_load_dwordx4 v[44:47], v3, s[8:11], s20 offen sc1
  buffer_load_dwordx4 v[48:51], v3, s[8:11], s20 offen offset:1024 sc1
  s_branch L_p1f_f
L_p2f_ft:
  buffer_load_dwordx4 v[36:39], v3, s[8:11], s21 offen sc1
  buffer_load_dwordx4 v[40:43], v3, s[8:11], s21 offen offset:1024 sc1
  s_add_u32 s39, s39, 1
  s_cmp_gt_u32 s39, 0x10000
  s_cbranch_scc1 L_abort
  s_branch L_p2c_ft
L_p2f_s:
  buffer_load_dwordx4 v[36:39], v3, s[8:11], s21 offen sc1
  buffer_load_dwordx4 v[40:43], v3, s[8:11], s21 offen offset:1024 sc1
  s_add_u32 s39, s39, 1
  s_cmp_gt_u32 s39, 0x10000
  s_cbranch_scc1 L_abort
  s_branch L_p2c_s
L_p1f_s:
  buffer_load_dwordx4 v[36:39], v3, s[8:11], s20 offen sc1
  buffer_load_dwordx4 v[40:43], v3, s[8:11], s20 offen offset:1024 sc1
  s_add_u32 s39, s39, 1
  s_cmp_gt_u32 s39, 0x10000
  s_cbranch_scc1 L_abort
  s_branch L_p1c_s
L_p2f_st:
  buffer_load_dwordx4 v[36:39], v3, s[8:11], s21 offen sc1
  buffer_load_dwordx4 v[40:43], v3, s[8:11], s21 offen offset:1024 sc1
  s_add_u32 s39, s39, 1
  s_cmp_gt_u32 s39, 0x10000
  s_cbranch_scc1 L_abort
  s_branch L_p2c_st
L_worker:
  s_sub_u32 s6, s98, 1
  s_cmp_eq_u32 s4, 0
  s_cbranch_scc0 L_ar_137
  s_add_u32 s3, s82, 8
  v_mov_b32 v120, s3
  v_mov_b32 v121, 1
  s_mov_b64 exec, 1
  global_atomic_add v120, v121, s[96:97]
  s_mov_b64 exec, -1
L_ar_137:
  s_load_dwordx2 s[12:13], s[0:1], 0
  s_load_dwordx2 s[16:17], s[0:1], 80
  s_load_dwordx2 s[72:73], s[0:1], 16
  s_load_dwordx2 s[76:77], s[0:1], 24
  s_load_dwordx2 s[80:81], s[0:1], 32
  s_load_dwordx2 s[84:85], s[0:1], 40
  v_and_b32 v20, 63, v0
  v_lshlrev_b32 v1, 4, v20
  v_lshrrev_b32 v24, 5, v20
  v_and_b32 v25, 31, v20
  v_bfe_u32 v21, v25, 3, 1
  v_lshlrev_b32 v2, 12, v21
  v_lshl_add_u32 v2, v24, 8, v2
  v_lshrrev_b32 v21, 4, v25
  v_lshl_add_u32 v2, v21, 7, v2
  v_and_b32 v22, 7, v25
  v_lshl_add_u32 v2, v22, 4, v2
  v_bfe_u32 v22, v25, 2, 1
  v_lshlrev_b32 v23, 3, v22
  v_bfe_u32 v22, v25, 3, 1
  v_lshl_add_u32 v23, v22, 2, v23
  v_and_b32 v22, 3, v25
  v_add_u32 v23, v23, v22
  v_lshlrev_b32 v3, 10, v21
  v_lshl_add_u32 v3, v24, 8, v3
  v_lshl_add_u32 v3, v23, 4, v3
  v_lshlrev_b32 v6, 8, v21
  v_lshl_add_u32 v6, v23, 4, v6
  v_lshl_add_u32 v6, v24, 3, v6
  s_lshl_b32 s27, s4, 9
  s_add_u32 s27, s27, 2048
  v_add_u32 v6, s27, v6
  v_and_b32 v22, 7, v25
  v_lshlrev_b32 v5, 6, v22
  v_lshl_add_u32 v5, v24, 4, v5
  v_mov_b32 v7, 0xf149f2ca
  s_lshl_b32 s27, s4, 11
  s_add_u32 s27, s27, 0
  v_lshlrev_b32 v8, 6, v25
  v_lshl_add_u32 v8, v24, 4, v8
  v_add_u32 v8, s27, v8
  v_lshrrev_b32 v21, 2, v20
  v_lshlrev_b32 v9, 15, v21
  v_and_b32 v22, 3, v20
  v_lshl_add_u32 v9, v22, 4, v9
  s_lshl_b32 s27, s5, 10
  s_lshl_b32 s28, s4, 8
  s_add_u32 s27, s27, s28
  v_add_u32 v9, s27, v9
  v_lshrrev_b32 v21, 4, v20
  v_and_b32 v22, 15, v20
  v_lshlrev_b32 v10, 10, v21
  v_lshl_add_u32 v10, v22, 4, v10
  s_lshl_b32 s27, s5, 15
  s_add_u32 s27, s27, s28
  v_add_u32 v10, s27, v10
  v_and_b32 v23, 1, v21
  v_lshlrev_b32 v11, 4, v22
  v_lshl_add_u32 v11, v23, 3, v11
  s_lshl_b32 s27, s5, 10
  s_add_u32 s27, s27, s28
  v_add_u32 v11, s27, v11
  v_lshrrev_b32 v12, 1, v22
  v_lshlrev_b32 v12, 10, v12
  v_and_b32 v22, 1, v22
  v_lshl_add_u32 v12, v22, 9, v12
  v_lshl_add_u32 v12, v23, 3, v12
  s_lshl_b32 s27, s4, 13
  s_lshl_b32 s29, s5, 4
  s_add_u32 s27, s27, s29
  v_add_u32 v12, s27, v12
  v_bfe_u32 v22, v20, 2, 2
  v_lshlrev_b32 v13, 11, v22
  v_and_b32 v22, 3, v20
  v_lshl_add_u32 v13, v22, 8, v13
  v_lshl_add_u32 v13, v23, 3, v13
  s_lshl_b32 s27, s4, 13
  s_lshr_b32 s29, s5, 4
  s_lshl_b32 s29, s29, 10
  s_add_u32 s27, s27, s29
  s_and_b32 s29, s5, 15
  s_lshl_b32 s29, s29, 4
  s_add_u32 s27, s27, s29
  v_add_u32 v13, s27, v13
  s_lshl_b32 s33, s4, 15
  s_add_u32 s33, s33, 32768
  v_lshlrev_b32 v4, 11, v24
  v_bfe_u32 v21, v20, 2, 2
  v_lshl_add_u32 v4, v21, 8, v4
  v_xor_b32 v21, s4, v21
  v_lshl_add_u32 v4, v21, 6, v4
  v_bfe_u32 v21, v20, 4, 1
  v_lshl_add_u32 v4, v21, 5, v4
  v_and_b32 v21, 1, v20
  v_lshl_add_u32 v4, v21, 4, v4
  v_bfe_u32 v21, v20, 1, 1
  v_lshl_add_u32 v4, v21, 3, v4
  v_add_u32 v4, 32768, v4
  v_and_b32 v21, 1, v20
  v_lshlrev_b32 v21, 4, v21
  v_mov_b32 v22, 0x3f80
  v_lshlrev_b32 v22, v21, v22
  v_bfe_u32 v21, v20, 1, 3
  v_cmp_eq_u32 vcc, 0, v21
  s_nop 1
  v_cndmask_b32 v16, 0, v22, vcc
  v_cmp_eq_u32 vcc, 1, v21
  s_nop 1
  v_cndmask_b32 v17, 0, v22, vcc
  v_cmp_eq_u32 vcc, 2, v21
  s_nop 1
  v_cndmask_b32 v18, 0, v22, vcc
  v_cmp_eq_u32 vcc, 3, v21
  s_nop 1
  v_cndmask_b32 v19, 0, v22, vcc
  v_lshlrev_b32 v21, 2, v24
  v_sub_u32 v21, v25, v21
  v_cmp_le_i32 s[40:41], 0, v21
  v_cmp_le_i32 s[42:43], 1, v21
  v_cmp_le_i32 s[44:45], 2, v21
  v_cmp_le_i32 s[46:47], 3, v21
  v_cmp_le_i32 s[48:49], 8, v21
  v_cmp_le_i32 s[50:51], 9, v21
  v_cmp_le_i32 s[52:53], 10, v21
  v_cmp_le_i32 s[54:55], 11, v21
  v_cmp_le_i32 s[56:57], 16, v21
  v_cmp_le_i32 s[58:59], 17, v21
  v_cmp_le_i32 s[60:61], 18, v21
  v_cmp_le_i32 s[62:63], 19, v21
  v_cmp_le_i32 s[64:65], 24, v21
  v_cmp_le_i32 s[66:67], 25, v21
  v_cmp_le_i32 s[68:69], 26, v21
  v_cmp_le_i32 s[70:71], 27, v21
  s_mov_b32 s90, 0x3e0293ee
  s_mov_b32 s94, -1
  s_mov_b32 s95, 0
  s_mov_b32 s32, 0
  s_lshl_b32 s34, s6, 5
  s_add_u32 s34, s34, s5
  s_add_u32 s35, s5, 224
  s_cmp_eq_u32 s6, 3
  s_cselect_b32 s25, 2, 1
  s_waitcnt lgkmcnt(0)
  s_mov_b32 s14, 0x200000
  s_mov_b32 s15, 0x20000
  s_mov_b32 s18, 0x200000
  s_mov_b32 s19, 0x20000
  s_mov_b32 s74, 0x400000
  s_mov_b32 s75, 0x20000
  s_mov_b32 s78, 0x400000
  s_mov_b32 s79, 0x20000
  s_mov_b32 s82, 0x400000
  s_mov_b32 s83, 0x20000
  s_mov_b32 s86, 0x400000
  s_mov_b32 s87, 0x20000
  s_mov_b32 s20, 0
  s_mov_b32 s89, 8192
  s_mov_b32 s21, s6
  s_mov_b32 s88, 64
  s_mov_b32 s22, 1
  v_lshrrev_b32 v60, 2, v1
L_ws_138:
  global_load_dword v61, v60, s[96:97] sc1
  s_waitcnt vmcnt(0)
  s_mov_b32 s3, 0
  v_readlane_b32 s2, v61, 2
  s_nop 3
  s_add_u32 s3, s3, s2
  v_readlane_b32 s2, v61, 3
  s_nop 3
  s_add_u32 s3, s3, s2
  v_readlane_b32 s2, v61, 18
  s_nop 3
  s_add_u32 s3, s3, s2
  v_readlane_b32 s2, v61, 19
  s_nop 3
  s_add_u32 s3, s3, s2
  v_readlane_b32 s2, v61, 34
  s_nop 3
  s_add_u32 s3, s3, s2
  v_readlane_b32 s2, v61, 35
  s_nop 3
  s_add_u32 s3, s3, s2
  v_readlane_b32 s2, v61, 50
  s_nop 3
  s_add_u32 s3, s3, s2
  v_readlane_b32 s2, v61, 51
  s_nop 3
  s_add_u32 s3, s3, s2
  s_add_u32 s39, s39, 1
  s_cmp_gt_u32 s39, 0x10000
  s_cbranch_scc1 L_abort
  s_cmp_lt_u32 s3, 256
  s_cbranch_scc1 L_ws_138
  v_cmp_ne_u32 vcc, 32, v61
  s_nop 3
  s_or_b32 s3, vcc_lo, vcc_hi
  s_and_b32 s3, s3, 0x30003
  s_cselect_b32 s99, 1, 0
  s_mov_b32 s7, s99
  s_mul_i32 s36, s4, 7
  s_add_u32 s36, s36, s21
  s_add_u32 s37, s36, 28
  s_add_u32 s91, s36, 56
  s_lshl_b32 s30, s5, 10
  v_add_u32 v42, s30, v1
  s_cmp_lt_u32 s36, s88
  s_cbranch_scc0 L_ln_139
  s_lshl_b32 s28, s36, 15
  s_cmp_eq_u32 s20, 0
  s_cbranch_scc0 L_ln_139_x2
  buffer_load_dwordx4 v[20:23], v42, s[12:15], s28 offen
  s_branch L_ln_139
L_ln_139_x2:
  s_lshl_b32 s27, s36, 7
  s_add_u32 s27, s27, 344064
  v_lshrrev_b32 v15, 2, v1
  v_and_b32 v15, 0x7c, v15
L_wf_140:
  buffer_load_dword v14, v15, s[8:11], s27 offen sc1
  s_waitcnt vmcnt(0)
  v_cmp_eq_u32 vcc, 0, v14
  s_cbranch_vccz L_wf_140_ok
  s_add_u32 s39, s39, 1
  s_cmp_gt_u32 s39, 0x10000
  s_cbranch_scc1 L_abort
  s_branch L_wf_140
L_wf_140_ok:
  s_add_u32 s28, s28, 97517568
  buffer_load_dwordx4 v[20:23], v42, s[8:11], s28 offen sc1
L_ln_139:
  s_cmp_lt_u32 s37, s88
  s_cbranch_scc0 L_ln_141
  s_lshl_b32 s28, s37, 15
  s_cmp_eq_u32 s20, 0
  s_cbranch_scc0 L_ln_141_x2
  buffer_load_dwordx4 v[24:27], v42, s[12:15], s28 offen
  s_branch L_ln_141
L_ln_141_x2:
  s_lshl_b32 s27, s37, 7
  s_add_u32 s27, s27, 344064
  v_lshrrev_b32 v15, 2, v1
  v_and_b32 v15, 0x7c, v15
L_wf_142:
  buffer_load_dword v14, v15, s[8:11], s27 offen sc1
  s_waitcnt vmcnt(0)
  v_cmp_eq_u32 vcc, 0, v14
  s_cbranch_vccz L_wf_142_ok
  s_add_u32 s39, s39, 1
  s_cmp_gt_u32 s39, 0x10000
  s_cbranch_scc1 L_abort
  s_branch L_wf_142
L_wf_142_ok:
  s_add_u32 s28, s28, 97517568
  buffer_load_dwordx4 v[24:27], v42, s[8:11], s28 offen sc1
L_ln_141:
  s_cmp_lt_u32 s91, s88
  s_cbranch_scc0 L_ln_143
  s_lshl_b32 s28, s91, 15
  s_cmp_eq_u32 s20, 0
  s_cbranch_scc0 L_ln_143_x2
  buffer_load_dwordx4 v[28:31], v42, s[12:15], s28 offen
  s_branch L_ln_143
L_ln_143_x2:
  s_lshl_b32 s27, s91, 7
  s_add_u32 s27, s27, 344064
  v_lshrrev_b32 v15, 2, v1
  v_and_b32 v15, 0x7c, v15
L_wf_144:
  buffer_load_dword v14, v15, s[8:11], s27 offen sc1
  s_waitcnt vmcnt(0)
  v_cmp_eq_u32 vcc, 0, v14
  s_cbranch_vccz L_wf_144_ok
  s_add_u32 s39, s39, 1
  s_cmp_gt_u32 s39, 0x10000
  s_cbranch_scc1 L_abort
  s_branch L_wf_144
L_wf_144_ok:
  s_add_u32 s28, s28, 97517568
  buffer_load_dwordx4 v[28:31], v42, s[8:11], s28 offen sc1
L_ln_143:
  v_lshrrev_b32 v43, 5, v1
  v_lshlrev_b32 v43, 10, v43
  v_bfe_u32 v42, v1, 4, 1
  v_lshl_add_u32 v43, v42, 9, v43
  s_lshl_b32 s30, s5, 4
  v_add_u32 v43, s30, v43
  s_waitcnt vmcnt(0)
  s_cmp_lt_u32 s36, s88
  s_cbranch_scc0 L_lne_145
  v_lshlrev_b32 v32, 16, v20
  v_and_b32 v33, 0xffff0000, v20
  v_lshlrev_b32 v34, 16, v21
  v_and_b32 v35, 0xffff0000, v21
  v_lshlrev_b32 v36, 16, v22
  v_and_b32 v37, 0xffff0000, v22
  v_lshlrev_b32 v38, 16, v23
  v_and_b32 v39, 0xffff0000, v23
  v_add_f32 v40, v32, v33
  v_mul_f32 v41, v32, v32
  v_fmac_f32 v41, v33, v33
  v_add_f32 v40, v40, v34
  v_fmac_f32 v41, v34, v34
  v_add_f32 v40, v40, v35
  v_fmac_f32 v41, v35, v35
  v_add_f32 v40, v40, v36
  v_fmac_f32 v41, v36, v36
  v_add_f32 v40, v40, v37
  v_fmac_f32 v41, v37, v37
  v_add_f32 v40, v40, v38
  v_fmac_f32 v41, v38, v38
  v_add_f32 v40, v40, v39
  v_fmac_f32 v41, v39, v39
  s_nop 0
  v_add_f32_dpp v40, v40, v40 row_ror:8 row_mask:0xf bank_mask:0xf
  v_add_f32_dpp v41, v41, v41 row_ror:8 row_mask:0xf bank_mask:0xf
  s_nop 0
  v_add_f32_dpp v40, v40, v40 row_ror:4 row_mask:0xf bank_mask:0xf
  v_add_f32_dpp v41, v41, v41 row_ror:4 row_mask:0xf bank_mask:0xf
  s_nop 0
  v_add_f32_dpp v40, v40, v40 row_ror:2 row_mask:0xf bank_mask:0xf
  v_add_f32_dpp v41, v41, v41 row_ror:2 row_mask:0xf bank_mask:0xf
  s_nop 0
  v_add_f32_dpp v40, v40, v40 row_ror:1 row_mask:0xf bank_mask:0xf
  v_add_f32_dpp v41, v41, v41 row_ror:1 row_mask:0xf bank_mask:0xf
  v_mov_b32 v42, v40
  v_mov_b32 v44, v41
  s_nop 0
  v_permlane32_swap_b32 v40, v42
  v_permlane32_swap_b32 v41, v44
  v_add_f32 v40, v40, v42
  v_add_f32 v41, v41, v44
  v_mov_b32 v42, v40
  v_mov_b32 v44, v41
  s_nop 0
  v_permlane16_swap_b32 v40, v42
  v_permlane16_swap_b32 v41, v44
  v_add_f32 v40, v40, v42
  v_add_f32 v41, v41, v44
  v_mul_f32 v40, 0x3b000000, v40
  v_mul_f32 v41, 0x3b000000, v41
  v_fma_f32 v41, -v40, v40, v41
  v_max_f32 v41, 0, v41
  v_add_f32 v41, 0x3727c5ac, v41
  v_rsq_f32 v41, v41
  v_sub_f32 v32, v32, v40
  v_sub_f32 v33, v33, v40
  v_sub_f32 v34, v34, v40
  v_sub_f32 v35, v35, v40
  v_sub_f32 v36, v36, v40
  v_sub_f32 v37, v37, v40
  v_sub_f32 v38, v38, v40
  v_sub_f32 v39, v39, v40
  v_mul_f32 v32, v32, v41
  v_mul_f32 v33, v33, v41
  v_mul_f32 v34, v34, v41
  v_mul_f32 v35, v35, v41
  v_mul_f32 v36, v36, v41
  v_mul_f32 v37, v37, v41
  v_mul_f32 v38, v38, v41
  v_mul_f32 v39, v39, v41
  v_cvt_pk_bf16_f32 v20, v32, v33
  v_cvt_pk_bf16_f32 v21, v34, v35
  v_cvt_pk_bf16_f32 v22, v36, v37
  v_cvt_pk_bf16_f32 v23, v38, v39
  s_lshl_b32 s29, s20, 6
  s_add_u32 s29, s29, s36
  s_lshl_b32 s29, s29, 15
  s_add_u32 s29, s29, 84934656
  s_cmp_eq_u32 s7, 0
  s_cbranch_scc0 L_xs_146
  buffer_store_dwordx4 v[20:23], v43, s[8:11], s29 offen
  s_branch L_xe_147
L_xs_146:
  buffer_store_dwordx4 v[20:23], v43, s[8:11], s29 offen sc1
L_xe_147:
  s_cmp_lt_u32 s37, s88
  s_cbranch_scc0 L_lne_145
  v_lshlrev_b32 v32, 16, v24
  v_and_b32 v33, 0xffff0000, v24
  v_lshlrev_b32 v34, 16, v25
  v_and_b32 v35, 0xffff0000, v25
  v_lshlrev_b32 v36, 16, v26
  v_and_b32 v37, 0xffff0000, v26
  v_lshlrev_b32 v38, 16, v27
  v_and_b32 v39, 0xffff0000, v27
  v_add_f32 v40, v32, v33
  v_mul_f32 v41, v32, v32
  v_fmac_f32 v41, v33, v33
  v_add_f32 v40, v40, v34
  v_fmac_f32 v41, v34, v34
  v_add_f32 v40, v40, v35
  v_fmac_f32 v41, v35, v35
  v_add_f32 v40, v40, v36
  v_fmac_f32 v41, v36, v36
  v_add_f32 v40, v40, v37
  v_fmac_f32 v41, v37, v37
  v_add_f32 v40, v40, v38
  v_fmac_f32 v41, v38, v38
  v_add_f32 v40, v40, v39
  v_fmac_f32 v41, v39, v39
  s_nop 0
  v_add_f32_dpp v40, v40, v40 row_ror:8 row_mask:0xf bank_mask:0xf
  v_add_f32_dpp v41, v41, v41 row_ror:8 row_mask:0xf bank_mask:0xf
  s_nop 0
  v_add_f32_dpp v40, v40, v40 row_ror:4 row_mask:0xf bank_mask:0xf
  v_add_f32_dpp v41, v41, v41 row_ror:4 row_mask:0xf bank_mask:0xf
  s_nop 0
  v_add_f32_dpp v40, v40, v40 row_ror:2 row_mask:0xf bank_mask:0xf
  v_add_f32_dpp v41, v41, v41 row_ror:2 row_mask:0xf bank_mask:0xf
  s_nop 0
  v_add_f32_dpp v40, v40, v40 row_ror:1 row_mask:0xf bank_mask:0xf
  v_add_f32_dpp v41, v41, v41 row_ror:1 row_mask:0xf bank_mask:0xf
  v_mov_b32 v42, v40
  v_mov_b32 v44, v41
  s_nop 0
  v_permlane32_swap_b32 v40, v42
  v_permlane32_swap_b32 v41, v44
  v_add_f32 v40, v40, v42
  v_add_f32 v41, v41, v44
  v_mov_b32 v42, v40
  v_mov_b32 v44, v41
  s_nop 0
  v_permlane16_swap_b32 v40, v42
  v_permlane16_swap_b32 v41, v44
  v_add_f32 v40, v40, v42
  v_add_f32 v41, v41, v44
  v_mul_f32 v40, 0x3b000000, v40
  v_mul_f32 v41, 0x3b000000, v41
  v_fma_f32 v41, -v40, v40, v41
  v_max_f32 v41, 0, v41
  v_add_f32 v41, 0x3727c5ac, v41
  v_rsq_f32 v41, v41
  v_sub_f32 v32, v32, v40
  v_sub_f32 v33, v33, v40
  v_sub_f32 v34, v34, v40
  v_sub_f32 v35, v35, v40
  v_sub_f32 v36, v36, v40
  v_sub_f32 v37, v37, v40
  v_sub_f32 v38, v38, v40
  v_sub_f32 v39, v39, v40
  v_mul_f32 v32, v32, v41
  v_mul_f32 v33, v33, v41
  v_mul_f32 v34, v34, v41
  v_mul_f32 v35, v35, v41
  v_mul_f32 v36, v36, v41
  v_mul_f32 v37, v37, v41
  v_mul_f32 v38, v38, v41
  v_mul_f32 v39, v39, v41
  v_cvt_pk_bf16_f32 v24, v32, v33
  v_cvt_pk_bf16_f32 v25, v34, v35
  v_cvt_pk_bf16_f32 v26, v36, v37
  v_cvt_pk_bf16_f32 v27, v38, v39
  s_lshl_b32 s29, s20, 6
  s_add_u32 s29, s29, s37
  s_lshl_b32 s29, s29, 15
  s_add_u32 s29, s29, 84934656
  s_cmp_eq_u32 s7, 0
  s_cbranch_scc0 L_xs_148
  buffer_store_dwordx4 v[24:27], v43, s[8:11], s29 offen
  s_branch L_xe_149
L_xs_148:
  buffer_store_dwordx4 v[24:27], v43, s[8:11], s29 offen sc1
L_xe_149:
  s_cmp_lt_u32 s91, s88
  s_cbranch_scc0 L_lne_145
  v_lshlrev_b32 v32, 16, v28
  v_and_b32 v33, 0xffff0000, v28
  v_lshlrev_b32 v34, 16, v29
  v_and_b32 v35, 0xffff0000, v29
  v_lshlrev_b32 v36, 16, v30
  v_and_b32 v37, 0xffff0000, v30
  v_lshlrev_b32 v38, 16, v31
  v_and_b32 v39, 0xffff0000, v31
  v_add_f32 v40, v32, v33
  v_mul_f32 v41, v32, v32
  v_fmac_f32 v41, v33, v33
  v_add_f32 v40, v40, v34
  v_fmac_f32 v41, v34, v34
  v_add_f32 v40, v40, v35
  v_fmac_f32 v41, v35, v35
  v_add_f32 v40, v40, v36
  v_fmac_f32 v41, v36, v36
  v_add_f32 v40, v40, v37
  v_fmac_f32 v41, v37, v37
  v_add_f32 v40, v40, v38
  v_fmac_f32 v41, v38, v38
  v_add_f32 v40, v40, v39
  v_fmac_f32 v41, v39, v39
  s_nop 0
  v_add_f32_dpp v40, v40, v40 row_ror:8 row_mask:0xf bank_mask:0xf
  v_add_f32_dpp v41, v41, v41 row_ror:8 row_mask:0xf bank_mask:0xf
  s_nop 0
  v_add_f32_dpp v40, v40, v40 row_ror:4 row_mask:0xf bank_mask:0xf
  v_add_f32_dpp v41, v41, v41 row_ror:4 row_mask:0xf bank_mask:0xf
  s_nop 0
  v_add_f32_dpp v40, v40, v40 row_ror:2 row_mask:0xf bank_mask:0xf
  v_add_f32_dpp v41, v41, v41 row_ror:2 row_mask:0xf bank_mask:0xf
  s_nop 0
  v_add_f32_dpp v40, v40, v40 row_ror:1 row_mask:0xf bank_mask:0xf
  v_add_f32_dpp v41, v41, v41 row_ror:1 row_mask:0xf bank_mask:0xf
  v_mov_b32 v42, v40
  v_mov_b32 v44, v41
  s_nop 0
  v_permlane32_swap_b32 v40, v42
  v_permlane32_swap_b32 v41, v44
  v_add_f32 v40, v40, v42
  v_add_f32 v41, v41, v44
  v_mov_b32 v42, v40
  v_mov_b32 v44, v41
  s_nop 0
  v_permlane16_swap_b32 v40, v42
  v_permlane16_swap_b32 v41, v44
  v_add_f32 v40, v40, v42
  v_add_f32 v41, v41, v44
  v_mul_f32 v40, 0x3b000000, v40
  v_mul_f32 v41, 0x3b000000, v41
  v_fma_f32 v41, -v40, v40, v41
  v_max_f32 v41, 0, v41
  v_add_f32 v41, 0x3727c5ac, v41
  v_rsq_f32 v41, v41
  v_sub_f32 v32, v32, v40
  v_sub_f32 v33, v33, v40
  v_sub_f32 v34, v34, v40
  v_sub_f32 v35, v35, v40
  v_sub_f32 v36, v36, v40
  v_sub_f32 v37, v37, v40
  v_sub_f32 v38, v38, v40
  v_sub_f32 v39, v39, v40
  v_mul_f32 v32, v32, v41
  v_mul_f32 v33, v33, v41
  v_mul_f32 v34, v34, v41
  v_mul_f32 v35, v35, v41
  v_mul_f32 v36, v36, v41
  v_mul_f32 v37, v37, v41
  v_mul_f32 v38, v38, v41
  v_mul_f32 v39, v39, v41
  v_cvt_pk_bf16_f32 v28, v32, v33
  v_cvt_pk_bf16_f32 v29, v34, v35
  v_cvt_pk_bf16_f32 v30, v36, v37
  v_cvt_pk_bf16_f32 v31, v38, v39
  s_lshl_b32 s29, s20, 6
  s_add_u32 s29, s29, s91
  s_lshl_b32 s29, s29, 15
  s_add_u32 s29, s29, 84934656
  s_cmp_eq_u32 s7, 0
  s_cbranch_scc0 L_xs_150
  buffer_store_dwordx4 v[28:31], v43, s[8:11], s29 offen
  s_branch L_xe_151
L_xs_150:
  buffer_store_dwordx4 v[28:31], v43, s[8:11], s29 offen sc1
L_xe_151:
L_lne_145:
  s_waitcnt vmcnt(0)
  v_mov_b32 v14, 1
  s_mov_b64 exec, 1
  s_cmp_lt_u32 s36, s88
  s_cbranch_scc0 L_lnf_152
  s_lshl_b32 s27, s20, 6
  s_add_u32 s27, s27, s36
  s_lshl_b32 s27, s27, 7
  s_add_u32 s27, s27, 294912
  s_lshl_b32 s31, s5, 2
  s_add_u32 s27, s27, s31
  s_cmp_eq_u32 s7, 0
  s_cbranch_scc0 L_xs_153
  buffer_store_dword v14, v1, s[8:11], s27 offen
  s_branch L_xe_154
L_xs_153:
  buffer_store_dword v14, v1, s[8:11], s27 offen sc1
L_xe_154:
  s_cmp_lt_u32 s37, s88
  s_cbranch_scc0 L_lnf_152
  s_lshl_b32 s27, s20, 6
  s_add_u32 s27, s27, s37
  s_lshl_b32 s27, s27, 7
  s_add_u32 s27, s27, 294912
  s_lshl_b32 s31, s5, 2
  s_add_u32 s27, s27, s31
  s_cmp_eq_u32 s7, 0
  s_cbranch_scc0 L_xs_155
  buffer_store_dword v14, v1, s[8:11], s27 offen
  s_branch L_xe_156
L_xs_155:
  buffer_store_dword v14, v1, s[8:11], s27 offen sc1
L_xe_156:
  s_cmp_lt_u32 s91, s88
  s_cbranch_scc0 L_lnf_152
  s_lshl_b32 s27, s20, 6
  s_add_u32 s27, s27, s91
  s_lshl_b32 s27, s27, 7
  s_add_u32 s27, s27, 294912
  s_lshl_b32 s31, s5, 2
  s_add_u32 s27, s27, s31
  s_cmp_eq_u32 s7, 0
  s_cbranch_scc0 L_xs_157
  buffer_store_dword v14, v1, s[8:11], s27 offen
  s_branch L_xe_158
L_xs_157:
  buffer_store_dword v14, v1, s[8:11], s27 offen sc1
L_xe_158:
L_lnf_152:
  s_mov_b64 exec, -1
  v_lshrrev_b32 v116, 4, v1
  v_lshrrev_b32 v117, 4, v116
  v_and_b32 v118, 15, v116
  v_lshlrev_b32 v120, 2, v117
  v_xor_b32 v118, v118, v120
  v_lshlrev_b32 v119, 13, v117
  v_lshl_add_u32 v119, v118, 4, v119
  s_lshl_b32 s27, s5, 8
  s_lshl_b32 s28, s4, 17
  s_add_u32 s27, s27, s28
  v_add_u32 v119, s27, v119
  v_lshlrev_b32 v120, 10, v117
  v_lshrrev_b32 v117, 2, v118
  v_lshl_add_u32 v120, v117, 8, v120
  v_and_b32 v117, 3, v118
  v_lshl_add_u32 v120, v117, 4, v120
  s_lshl_b32 s27, s5, 17
  s_lshl_b32 s28, s4, 14
  s_add_u32 s27, s27, s28
  v_add_u32 v120, s27, v120
  v_bfe_u32 v117, v116, 5, 1
  v_lshlrev_b32 v121, 11, v117
  v_bfe_u32 v117, v116, 2, 2
  v_lshl_add_u32 v121, v117, 8, v121
  v_xor_b32 v117, s4, v117
  v_lshl_add_u32 v121, v117, 6, v121
  v_bfe_u32 v117, v116, 4, 1
  v_lshl_add_u32 v121, v117, 5, v121
  v_and_b32 v117, 1, v116
  v_lshl_add_u32 v121, v117, 4, v121
  v_bfe_u32 v117, v116, 1, 1
  v_lshl_add_u32 v121, v117, 3, v121
  v_add_u32 v121, 32768, v121
  v_add_u32 v122, 0x10000, v121
  s_lshl_b32 s29, s4, 12
  s_add_u32 s23, s29, 32768
  s_barrier
  s_add_u32 m0, s23, 0
  s_mov_b32 s28, 0
  buffer_load_dwordx4 v119, s[76:79], s28 offen lds
  s_add_u32 m0, s23, 1024
  s_mov_b32 s28, 32768
  buffer_load_dwordx4 v119, s[76:79], s28 offen lds
  s_add_u32 m0, s23, 2048
  s_mov_b32 s28, 65536
  buffer_load_dwordx4 v119, s[76:79], s28 offen lds
  s_add_u32 m0, s23, 3072
  s_mov_b32 s28, 98304
  buffer_load_dwordx4 v119, s[76:79], s28 offen lds
  s_add_u32 m0, s23, 16384
  s_mov_b32 s28, 524288
  buffer_load_dwordx4 v119, s[76:79], s28 offen lds
  s_add_u32 m0, s23, 17408
  s_mov_b32 s28, 557056
  buffer_load_dwordx4 v119, s[76:79], s28 offen lds
  s_add_u32 m0, s23, 18432
  s_mov_b32 s28, 589824
  buffer_load_dwordx4 v119, s[76:79], s28 offen lds
  s_add_u32 m0, s23, 19456
  s_mov_b32 s28, 622592
  buffer_load_dwordx4 v119, s[76:79], s28 offen lds
  s_add_u32 m0, s23, 32768
  s_mov_b32 s28, 1048576
  buffer_load_dwordx4 v119, s[76:79], s28 offen lds
  s_add_u32 m0, s23, 33792
  s_mov_b32 s28, 1081344
  buffer_load_dwordx4 v119, s[76:79], s28 offen lds
  s_add_u32 m0, s23, 34816
  s_mov_b32 s28, 1114112
  buffer_load_dwordx4 v119, s[76:79], s28 offen lds
  s_add_u32 m0, s23, 35840
  s_mov_b32 s28, 1146880
  buffer_load_dwordx4 v119, s[76:79], s28 offen lds
  s_add_u32 m0, s23, 49152
  s_mov_b32 s28, 1572864
  buffer_load_dwordx4 v119, s[76:79], s28 offen lds
  s_add_u32 m0, s23, 50176
  s_mov_b32 s28, 1605632
  buffer_load_dwordx4 v119, s[76:79], s28 offen lds
  s_add_u32 m0, s23, 51200
  s_mov_b32 s28, 1638400
  buffer_load_dwordx4 v119, s[76:79], s28 offen lds
  s_add_u32 m0, s23, 52224
  s_mov_b32 s28, 1671168
  buffer_load_dwordx4 v119, s[76:79], s28 offen lds
  s_add_u32 m0, s23, 65536
  s_mov_b32 s28, 2097152
  buffer_load_dwordx4 v119, s[76:79], s28 offen lds
  s_add_u32 m0, s23, 66560
  s_mov_b32 s28, 2129920
  buffer_load_dwordx4 v119, s[76:79], s28 offen lds
  s_add_u32 m0, s23, 67584
  s_mov_b32 s28, 2162688
  buffer_load_dwordx4 v119, s[76:79], s28 offen lds
  s_add_u32 m0, s23, 68608
  s_mov_b32 s28, 2195456
  buffer_load_dwordx4 v119, s[76:79], s28 offen lds
  s_add_u32 m0, s23, 81920
  s_mov_b32 s28, 2621440
  buffer_load_dwordx4 v119, s[76:79], s28 offen lds
  s_add_u32 m0, s23, 82944
  s_mov_b32 s28, 2654208
  buffer_load_dwordx4 v119, s[76:79], s28 offen lds
  s_add_u32 m0, s23, 83968
  s_mov_b32 s28, 2686976
  buffer_load_dwordx4 v119, s[76:79], s28 offen lds
  s_add_u32 m0, s23, 84992
  s_mov_b32 s28, 2719744
  buffer_load_dwordx4 v119, s[76:79], s28 offen lds
  s_add_u32 m0, s23, 98304
  s_mov_b32 s28, 3145728
  buffer_load_dwordx4 v119, s[76:79], s28 offen lds
  s_add_u32 m0, s23, 99328
  s_mov_b32 s28, 3178496
  buffer_load_dwordx4 v119, s[76:79], s28 offen lds
  s_add_u32 m0, s23, 100352
  s_mov_b32 s28, 3211264
  buffer_load_dwordx4 v119, s[76:79], s28 offen lds
  s_add_u32 m0, s23, 101376
  s_mov_b32 s28, 3244032
  buffer_load_dwordx4 v119, s[76:79], s28 offen lds
  s_waitcnt vmcnt(24)
  s_barrier
  s_add_u32 m0, s23, 114688
  s_mov_b32 s28, 3670016
  buffer_load_dwordx4 v119, s[76:79], s28 offen lds
  s_add_u32 m0, s23, 115712
  s_mov_b32 s28, 3702784
  buffer_load_dwordx4 v119, s[76:79], s28 offen lds
  s_add_u32 m0, s23, 116736
  s_mov_b32 s28, 3735552
  buffer_load_dwordx4 v119, s[76:79], s28 offen lds
  s_add_u32 m0, s23, 117760
  s_mov_b32 s28, 3768320
  buffer_load_dwordx4 v119, s[76:79], s28 offen lds
  ds_read_b64_tr_b16 a[0:1], v121 offset:0
  ds_read_b64_tr_b16 a[2:3], v121 offset:1024
  ds_read_b64_tr_b16 a[4:5], v121 offset:4096
  ds_read_b64_tr_b16 a[6:7], v121 offset:5120
  ds_read_b64_tr_b16 a[8:9], v121 offset:8192
  ds_read_b64_tr_b16 a[10:11], v121 offset:9216
  ds_read_b64_tr_b16 a[12:13], v121 offset:12288
  ds_read_b64_tr_b16 a[14:15], v121 offset:13312
  s_waitcnt lgkmcnt(0)
  s_waitcnt vmcnt(24)
  s_barrier
  s_add_u32 m0, s23, 0
  s_mov_b32 s28, 0
  buffer_load_dwordx4 v119, s[80:83], s28 offen lds
  s_add_u32 m0, s23, 1024
  s_mov_b32 s28, 32768
  buffer_load_dwordx4 v119, s[80:83], s28 offen lds
  s_add_u32 m0, s23, 2048
  s_mov_b32 s28, 65536
  buffer_load_dwordx4 v119, s[80:83], s28 offen lds
  s_add_u32 m0, s23, 3072
  s_mov_b32 s28, 98304
  buffer_load_dwordx4 v119, s[80:83], s28 offen lds
  ds_read_b64_tr_b16 a[16:17], v121 offset:16384
  ds_read_b64_tr_b16 a[18:19], v121 offset:17408
  ds_read_b64_tr_b16 a[20:21], v121 offset:20480
  ds_read_b64_tr_b16 a[22:23], v121 offset:21504
  ds_read_b64_tr_b16 a[24:25], v121 offset:24576
  ds_read_b64_tr_b16 a[26:27], v121 offset:25600
  ds_read_b64_tr_b16 a[28:29], v121 offset:28672
  ds_read_b64_tr_b16 a[30:31], v121 offset:29696
  s_waitcnt lgkmcnt(0)
  s_waitcnt vmcnt(24)
  s_barrier
  s_add_u32 m0, s23, 16384
  s_mov_b32 s28, 524288
  buffer_load_dwordx4 v119, s[80:83], s28 offen lds
  s_add_u32 m0, s23, 17408
  s_mov_b32 s28, 557056
  buffer_load_dwordx4 v119, s[80:83], s28 offen lds
  s_add_u32 m0, s23, 18432
  s_mov_b32 s28, 589824
  buffer_load_dwordx4 v119, s[80:83], s28 offen lds
  s_add_u32 m0, s23, 19456
  s_mov_b32 s28, 622592
  buffer_load_dwordx4 v119, s[80:83], s28 offen lds
  ds_read_b64_tr_b16 a[32:33], v121 offset:32768
  ds_read_b64_tr_b16 a[34:35], v121 offset:33792
  ds_read_b64_tr_b16 a[36:37], v121 offset:36864
  ds_read_b64_tr_b16 a[38:39], v121 offset:37888
  ds_read_b64_tr_b16 a[40:41], v121 offset:40960
  ds_read_b64_tr_b16 a[42:43], v121 offset:41984
  ds_read_b64_tr_b16 a[44:45], v121 offset:45056
  ds_read_b64_tr_b16 a[46:47], v121 offset:46080
  s_waitcnt lgkmcnt(0)
  s_waitcnt vmcnt(24)
  s_barrier
  s_add_u32 m0, s23, 32768
  s_mov_b32 s28, 1048576
  buffer_load_dwordx4 v119, s[80:83], s28 offen lds
  s_add_u32 m0, s23, 33792
  s_mov_b32 s28, 1081344
  buffer_load_dwordx4 v119, s[80:83], s28 offen lds
  s_add_u32 m0, s23, 34816
  s_mov_b32 s28, 1114112
  buffer_load_dwordx4 v119, s[80:83], s28 offen lds
  s_add_u32 m0, s23, 35840
  s_mov_b32 s28, 1146880
  buffer_load_dwordx4 v119, s[80:83], s28 offen lds
  ds_read_b64_tr_b16 a[48:49], v121 offset:49152
  ds_read_b64_tr_b16 a[50:51], v121 offset:50176
  ds_read_b64_tr_b16 a[52:53], v121 offset:53248
  ds_read_b64_tr_b16 a[54:55], v121 offset:54272
  ds_read_b64_tr_b16 a[56:57], v121 offset:57344
  ds_read_b64_tr_b16 a[58:59], v121 offset:58368
  ds_read_b64_tr_b16 a[60:61], v121 offset:61440
  ds_read_b64_tr_b16 a[62:63], v121 offset:62464
  s_waitcnt lgkmcnt(0)
  s_waitcnt vmcnt(24)
  s_barrier
  s_add_u32 m0, s23, 49152
  s_mov_b32 s28, 1572864
  buffer_load_dwordx4 v119, s[80:83], s28 offen lds
  s_add_u32 m0, s23, 50176
  s_mov_b32 s28, 1605632
  buffer_load_dwordx4 v119, s[80:83], s28 offen lds
  s_add_u32 m0, s23, 51200
  s_mov_b32 s28, 1638400
  buffer_load_dwordx4 v119, s[80:83], s28 offen lds
  s_add_u32 m0, s23, 52224
  s_mov_b32 s28, 1671168
  buffer_load_dwordx4 v119, s[80:83], s28 offen lds
  ds_read_b64_tr_b16 a[64:65], v122 offset:0
  ds_read_b64_tr_b16 a[66:67], v122 offset:1024
  ds_read_b64_tr_b16 a[68:69], v122 offset:4096
  ds_read_b64_tr_b16 a[70:71], v122 offset:5120
  ds_read_b64_tr_b16 a[72:73], v122 offset:8192
  ds_read_b64_tr_b16 a[74:75], v122 offset:9216
  ds_read_b64_tr_b16 a[76:77], v122 offset:12288
  ds_read_b64_tr_b16 a[78:79], v122 offset:13312
  s_waitcnt lgkmcnt(0)
  s_waitcnt vmcnt(24)
  s_barrier
  s_add_u32 m0, s23, 65536
  s_mov_b32 s28, 2097152
  buffer_load_dwordx4 v119, s[80:83], s28 offen lds
  s_add_u32 m0, s23, 66560
  s_mov_b32 s28, 2129920
  buffer_load_dwordx4 v119, s[80:83], s28 offen lds
  s_add_u32 m0, s23, 67584
  s_mov_b32 s28, 2162688
  buffer_load_dwordx4 v119, s[80:83], s28 offen lds
  s_add_u32 m0, s23, 68608
  s_mov_b32 s28, 2195456
  buffer_load_dwordx4 v119, s[80:83], s28 offen lds
  ds_read_b64_tr_b16 a[80:81], v122 offset:16384
  ds_read_b64_tr_b16 a[82:83], v122 offset:17408
  ds_read_b64_tr_b16 a[84:85], v122 offset:20480
  ds_read_b64_tr_b16 a[86:87], v122 offset:21504
  ds_read_b64_tr_b16 a[88:89], v122 offset:24576
  ds_read_b64_tr_b16 a[90:91], v122 offset:25600
  ds_read_b64_tr_b16 a[92:93], v122 offset:28672
  ds_read_b64_tr_b16 a[94:95], v122 offset:29696
  s_waitcnt lgkmcnt(0)
  s_waitcnt vmcnt(24)
  s_barrier
  s_add_u32 m0, s23, 81920
  s_mov_b32 s28, 2621440
  buffer_load_dwordx4 v119, s[80:83], s28 offen lds
  s_add_u32 m0, s23, 82944
  s_mov_b32 s28, 2654208
  buffer_load_dwordx4 v119, s[80:83], s28 offen lds
  s_add_u32 m0, s23, 83968
  s_mov_b32 s28, 2686976
  buffer_load_dwordx4 v119, s[80:83], s28 offen lds
  s_add_u32 m0, s23, 84992
  s_mov_b32 s28, 2719744
  buffer_load_dwordx4 v119, s[80:83], s28 offen lds
  ds_read_b64_tr_b16 a[96:97], v122 offset:32768
  ds_read_b64_tr_b16 a[98:99], v122 offset:33792
  ds_read_b64_tr_b16 a[100:101], v122 offset:36864
  ds_read_b64_tr_b16 a[102:103], v122 offset:37888
  ds_read_b64_tr_b16 a[104:105], v122 offset:40960
  ds_read_b64_tr_b16 a[106:107], v122 offset:41984
  ds_read_b64_tr_b16 a[108:109], v122 offset:45056
  ds_read_b64_tr_b16 a[110:111], v122 offset:46080
  s_waitcnt lgkmcnt(0)
  s_waitcnt vmcnt(24)
  s_barrier
  s_add_u32 m0, s23, 98304
  s_mov_b32 s28, 3145728
  buffer_load_dwordx4 v119, s[80:83], s28 offen lds
  s_add_u32 m0, s23, 99328
  s_mov_b32 s28, 3178496
  buffer_load_dwordx4 v119, s[80:83], s28 offen lds
  s_add_u32 m0, s23, 100352
  s_mov_b32 s28, 3211264
  buffer_load_dwordx4 v119, s[80:83], s28 offen lds
  s_add_u32 m0, s23, 101376
  s_mov_b32 s28, 3244032
  buffer_load_dwordx4 v119, s[80:83], s28 offen lds
  ds_read_b64_tr_b16 a[112:113], v122 offset:49152
  ds_read_b64_tr_b16 a[114:115], v122 offset:50176
  ds_read_b64_tr_b16 a[116:117], v122 offset:53248
  ds_read_b64_tr_b16 a[118:119], v122 offset:54272
  ds_read_b64_tr_b16 a[120:121], v122 offset:57344
  ds_read_b64_tr_b16 a[122:123], v122 offset:58368
  ds_read_b64_tr_b16 a[124:125], v122 offset:61440
  ds_read_b64_tr_b16 a[126:127], v122 offset:62464
  s_waitcnt lgkmcnt(0)
  s_waitcnt vmcnt(24)
  s_barrier
  s_add_u32 m0, s23, 114688
  s_mov_b32 s28, 3670016
  buffer_load_dwordx4 v119, s[80:83], s28 offen lds
  s_add_u32 m0, s23, 115712
  s_mov_b32 s28, 3702784
  buffer_load_dwordx4 v119, s[80:83], s28 offen lds
  s_add_u32 m0, s23, 116736
  s_mov_b32 s28, 3735552
  buffer_load_dwordx4 v119, s[80:83], s28 offen lds
  s_add_u32 m0, s23, 117760
  s_mov_b32 s28, 3768320
  buffer_load_dwordx4 v119, s[80:83], s28 offen lds
  ds_read_b64_tr_b16 a[128:129], v121 offset:0
  ds_read_b64_tr_b16 a[130:131], v121 offset:1024
  ds_read_b64_tr_b16 a[132:133], v121 offset:4096
  ds_read_b64_tr_b16 a[134:135], v121 offset:5120
  ds_read_b64_tr_b16 a[136:137], v121 offset:8192
  ds_read_b64_tr_b16 a[138:139], v121 offset:9216
  ds_read_b64_tr_b16 a[140:141], v121 offset:12288
  ds_read_b64_tr_b16 a[142:143], v121 offset:13312
  s_waitcnt lgkmcnt(0)
  s_waitcnt vmcnt(24)
  s_barrier
  ds_read_b64_tr_b16 a[144:145], v121 offset:16384
  ds_read_b64_tr_b16 a[146:147], v121 offset:17408
  ds_read_b64_tr_b16 a[148:149], v121 offset:20480
  ds_read_b64_tr_b16 a[150:151], v121 offset:21504
  ds_read_b64_tr_b16 a[152:153], v121 offset:24576
  ds_read_b64_tr_b16 a[154:155], v121 offset:25600
  ds_read_b64_tr_b16 a[156:157], v121 offset:28672
  ds_read_b64_tr_b16 a[158:159], v121 offset:29696
  s_waitcnt lgkmcnt(0)
  s_waitcnt vmcnt(20)
  s_barrier
  ds_read_b64_tr_b16 a[160:161], v121 offset:32768
  ds_read_b64_tr_b16 a[162:163], v121 offset:33792
  ds_read_b64_tr_b16 a[164:165], v121 offset:36864
  ds_read_b64_tr_b16 a[166:167], v121 offset:37888
  ds_read_b64_tr_b16 a[168:169], v121 offset:40960
  ds_read_b64_tr_b16 a[170:171], v121 offset:41984
  ds_read_b64_tr_b16 a[172:173], v121 offset:45056
  ds_read_b64_tr_b16 a[174:175], v121 offset:46080
  s_waitcnt lgkmcnt(0)
  s_waitcnt vmcnt(16)
  s_barrier
  ds_read_b64_tr_b16 a[176:177], v121 offset:49152
  ds_read_b64_tr_b16 a[178:179], v121 offset:50176
  ds_read_b64_tr_b16 a[180:181], v121 offset:53248
  ds_read_b64_tr_b16 a[182:183], v121 offset:54272
  ds_read_b64_tr_b16 a[184:185], v121 offset:57344
  ds_read_b64_tr_b16 a[186:187], v121 offset:58368
  ds_read_b64_tr_b16 a[188:189], v121 offset:61440
  ds_read_b64_tr_b16 a[190:191], v121 offset:62464
  s_waitcnt lgkmcnt(0)
  s_waitcnt vmcnt(12)
  s_barrier
  ds_read_b64_tr_b16 a[192:193], v122 offset:0
  ds_read_b64_tr_b16 a[194:195], v122 offset:1024
  ds_read_b64_tr_b16 a[196:197], v122 offset:4096
  ds_read_b64_tr_b16 a[198:199], v122 offset:5120
  ds_read_b64_tr_b16 a[200:201], v122 offset:8192
  ds_read_b64_tr_b16 a[202:203], v122 offset:9216
  ds_read_b64_tr_b16 a[204:205], v122 offset:12288
  ds_read_b64_tr_b16 a[206:207], v122 offset:13312
  s_waitcnt lgkmcnt(0)
  s_waitcnt vmcnt(8)
  s_barrier
  ds_read_b64_tr_b16 a[208:209], v122 offset:16384
  ds_read_b64_tr_b16 a[210:211], v122 offset:17408
  ds_read_b64_tr_b16 a[212:213], v122 offset:20480
  ds_read_b64_tr_b16 a[214:215], v122 offset:21504
  ds_read_b64_tr_b16 a[216:217], v122 offset:24576
  ds_read_b64_tr_b16 a[218:219], v122 offset:25600
  ds_read_b64_tr_b16 a[220:221], v122 offset:28672
  ds_read_b64_tr_b16 a[222:223], v122 offset:29696
  s_waitcnt lgkmcnt(0)
  s_waitcnt vmcnt(4)
  s_barrier
  ds_read_b64_tr_b16 a[224:225], v122 offset:32768
  ds_read_b64_tr_b16 a[226:227], v122 offset:33792
  ds_read_b64_tr_b16 a[228:229], v122 offset:36864
  ds_read_b64_tr_b16 a[230:231], v122 offset:37888
  ds_read_b64_tr_b16 a[232:233], v122 offset:40960
  ds_read_b64_tr_b16 a[234:235], v122 offset:41984
  ds_read_b64_tr_b16 a[236:237], v122 offset:45056
  ds_read_b64_tr_b16 a[238:239], v122 offset:46080
  s_waitcnt lgkmcnt(0)
  s_waitcnt vmcnt(0)
  s_barrier
  ds_read_b64_tr_b16 a[240:241], v122 offset:49152
  ds_read_b64_tr_b16 a[242:243], v122 offset:50176
  ds_read_b64_tr_b16 a[244:245], v122 offset:53248
  ds_read_b64_tr_b16 a[246:247], v122 offset:54272
  ds_read_b64_tr_b16 a[248:249], v122 offset:57344
  ds_read_b64_tr_b16 a[250:251], v122 offset:58368
  ds_read_b64_tr_b16 a[252:253], v122 offset:61440
  ds_read_b64_tr_b16 a[254:255], v122 offset:62464
  s_waitcnt lgkmcnt(0)
  s_barrier
  s_mov_b32 s88, 7
  s_branch W_kv
W_layer:
  s_mov_b32 s21, s6
  s_mov_b32 s38, s6
  s_mov_b32 s92, 0
  s_mov_b32 s22, 0
  s_mov_b32 s88, 7
W_idft:
  s_mov_b32 s83, s38
  v_lshrrev_b32 v20, 4, v1
  v_and_b32 v24, 15, v20
  v_lshlrev_b32 v24, 10, v24
  v_lshrrev_b32 v21, 4, v20
  v_lshl_add_u32 v24, v21, 3, v24
  s_and_b32 s27, s4, 1
  s_lshl_b32 s28, s27, 14
  s_lshl_b32 s29, s5, 5
  s_add_u32 s28, s28, s29
  v_add_u32 v24, s28, v24
  v_lshlrev_b32 v22, 9, v21
  v_bfe_u32 v21, v20, 2, 2
  v_lshl_add_u32 v22, v21, 6, v22
  v_and_b32 v21, 3, v20
  v_lshl_add_u32 v22, v21, 3, v22
  s_lshl_b32 s27, s27, 5
  s_lshr_b32 s82, s4, 1
  s_lshl_b32 s28, s82, 15
  s_add_u32 s27, s27, s28
  s_add_u32 s27, s27, 32768
  v_add_u32 v22, s27, v22
  v_add_u32 v23, 0x10000, v22
  s_mul_i32 s82, s82, 7
  s_lshl_b32 s29, s34, 2
  s_mul_i32 s29, s29, 36864
  s_add_u32 s29, s29, 118517760
  buffer_load_dwordx4 v[64:67], v1, s[8:11], s29 offen offset:0 sc1
  buffer_load_dwordx4 v[68:71], v1, s[8:11], s29 offen offset:1024 sc1
  buffer_load_dwordx4 v[72:75], v1, s[8:11], s29 offen offset:2048 sc1
  buffer_load_dwordx4 v[76:79], v1, s[8:11], s29 offen offset:3072 sc1
  s_add_u32 s29, s29, 36864
  buffer_load_dwordx4 v[80:83], v1, s[8:11], s29 offen offset:0 sc1
  buffer_load_dwordx4 v[84:87], v1, s[8:11], s29 offen offset:1024 sc1
  buffer_load_dwordx4 v[88:91], v1, s[8:11], s29 offen offset:2048 sc1
  buffer_load_dwordx4 v[92:95], v1, s[8:11], s29 offen offset:3072 sc1
  s_add_u32 s29, s29, 36864
  buffer_load_dwordx4 v[96:99], v1, s[8:11], s29 offen offset:0 sc1
  buffer_load_dwordx4 v[100:103], v1, s[8:11], s29 offen offset:1024 sc1
  buffer_load_dwordx4 v[104:107], v1, s[8:11], s29 offen offset:2048 sc1
  buffer_load_dwordx4 v[108:111], v1, s[8:11], s29 offen offset:3072 sc1
  s_add_u32 s29, s29, 36864
  buffer_load_dwordx4 v[112:115], v1, s[8:11], s29 offen offset:0 sc1
  buffer_load_dwordx4 v[116:119], v1, s[8:11], s29 offen offset:1024 sc1
  buffer_load_dwordx4 v[120:123], v1, s[8:11], s29 offen offset:2048 sc1
  buffer_load_dwordx4 v[124:127], v1, s[8:11], s29 offen offset:3072 sc1
  s_lshl_b32 s80, s92, 21
  s_and_b32 s27, s4, 1
  s_lshl_b32 s27, s27, 14
  s_add_u32 s80, s80, s27
  s_add_u32 s80, s80, 99614720
  s_lshl_b32 s81, s92, 21
  s_add_u32 s81, s81, 93323264
  s_lshl_b32 s91, s4, 14
  s_add_u32 s91, s91, 32768
  s_cmp_eq_u32 s22, 1
  s_cbranch_scc1 W_y2
  s_cmp_eq_u32 s4, 1
  s_cbranch_scc0 L_wy_159_ok
  s_lshl_b32 s28, s92, 3
  s_add_u32 s28, s28, s6
  s_lshl_b32 s28, s28, 7
  s_add_u32 s28, s28, 372736
  s_cmp_eq_u32 s5, 0
  s_cbranch_scc0 L_wy_159_l
  s_lshl_b32 s27, s92, 10
  s_add_u32 s27, s27, 352256
L_wy_159:
  buffer_load_dwordx4 v[32:35], v1, s[8:11], s27 offen sc1
  s_waitcnt vmcnt(0)
  v_min_u32 v32, v32, v33
  v_min3_u32 v32, v32, v34, v35
  v_cmp_eq_u32 vcc, 0, v32
  s_cbranch_vccz L_wy_159_g
  s_add_u32 s39, s39, 1
  s_cmp_gt_u32 s39, 0x10000
  s_cbranch_scc1 L_abort
  s_branch L_wy_159
L_wy_159_g:
  s_mov_b64 exec, 1
  s_cmp_eq_u32 s7, 0
  s_cbranch_scc0 L_xs_160
  buffer_store_dword v32, v1, s[8:11], s28 offen
  s_branch L_xe_161
L_xs_160:
  buffer_store_dword v32, v1, s[8:11], s28 offen sc1
L_xe_161:
  s_mov_b64 exec, -1
  s_branch L_wy_159_ok
L_wy_159_l:
  v_mov_b32 v33, 0
L_wy_159_l2:
  buffer_load_dword v32, v33, s[8:11], s28 offen sc1
  s_waitcnt vmcnt(0)
  v_cmp_eq_u32 vcc, 0, v32
  s_cbranch_vccz L_wy_159_ok
  s_add_u32 s39, s39, 1
  s_cmp_gt_u32 s39, 0x10000
  s_cbranch_scc1 L_abort
  s_branch L_wy_159_l2
L_wy_159_ok:
  s_barrier
  s_branch W_noy
W_y2:
  s_cmp_eq_u32 s4, 1
  s_cbranch_scc0 L_wy_162_ok
  s_lshl_b32 s28, s92, 3
  s_add_u32 s28, s28, s6
  s_lshl_b32 s28, s28, 7
  s_add_u32 s28, s28, 372800
  s_cmp_eq_u32 s5, 0
  s_cbranch_scc0 L_wy_162_l
  s_lshl_b32 s27, s92, 10
  s_add_u32 s27, s27, 376832
L_wy_162:
  buffer_load_dwordx4 v[32:35], v1, s[8:11], s27 offen sc1
  s_waitcnt vmcnt(0)
  v_min_u32 v32, v32, v33
  v_min3_u32 v32, v32, v34, v35
  v_cmp_eq_u32 vcc, 0, v32
  s_cbranch_vccz L_wy_162_g
  s_add_u32 s39, s39, 1
  s_cmp_gt_u32 s39, 0x10000
  s_cbranch_scc1 L_abort
  s_branch L_wy_162
L_wy_162_g:
  s_mov_b64 exec, 1
  s_cmp_eq_u32 s7, 0
  s_cbranch_scc0 L_xs_163
  buffer_store_dword v32, v1, s[8:11], s28 offen
  s_branch L_xe_164
L_xs_163:
  buffer_store_dword v32, v1, s[8:11], s28 offen sc1
L_xe_164:
  s_mov_b64 exec, -1
  s_branch L_wy_162_ok
L_wy_162_l:
  v_mov_b32 v33, 0
L_wy_162_l2:
  buffer_load_dword v32, v33, s[8:11], s28 offen sc1
  s_waitcnt vmcnt(0)
  v_cmp_eq_u32 vcc, 0, v32
  s_cbranch_vccz L_wy_162_ok
  s_add_u32 s39, s39, 1
  s_cmp_gt_u32 s39, 0x10000
  s_cbranch_scc1 L_abort
  s_branch L_wy_162_l2
L_wy_162_ok:
  s_barrier
W_noy:
  s_mov_b32 s36, 0
W_idr:
  s_add_u32 s30, s38, s82
  s_cmp_lt_u32 s30, s88
  s_cbranch_scc0 L_if_165
  s_lshl_b32 s30, s30, 15
  s_add_u32 s27, s30, s80
  s_add_u32 m0, s91, 0
  s_nop 0
  buffer_load_dwordx4 v1, s[8:11], s27 offen offset:0 sc1 lds
  buffer_load_dwordx4 v1, s[8:11], s27 offen offset:1024 sc1 lds
  buffer_load_dwordx4 v1, s[8:11], s27 offen offset:2048 sc1 lds
  buffer_load_dwordx4 v1, s[8:11], s27 offen offset:3072 sc1 lds
  s_add_u32 m0, s91, 4096
  s_add_u32 s27, s27, 4096
  buffer_load_dwordx4 v1, s[8:11], s27 offen offset:0 sc1 lds
  buffer_load_dwordx4 v1, s[8:11], s27 offen offset:1024 sc1 lds
  buffer_load_dwordx4 v1, s[8:11], s27 offen offset:2048 sc1 lds
  buffer_load_dwordx4 v1, s[8:11], s27 offen offset:3072 sc1 lds
  s_add_u32 m0, s91, 8192
  s_add_u32 s27, s27, 4096
  buffer_load_dwordx4 v1, s[8:11], s27 offen offset:0 sc1 lds
  buffer_load_dwordx4 v1, s[8:11], s27 offen offset:1024 sc1 lds
  buffer_load_dwordx4 v1, s[8:11], s27 offen offset:2048 sc1 lds
  buffer_load_dwordx4 v1, s[8:11], s27 offen offset:3072 sc1 lds
  s_add_u32 m0, s91, 12288
  s_add_u32 s27, s27, 4096
  buffer_load_dwordx4 v1, s[8:11], s27 offen offset:0 sc1 lds
  buffer_load_dwordx4 v1, s[8:11], s27 offen offset:1024 sc1 lds
  buffer_load_dwordx4 v1, s[8:11], s27 offen offset:2048 sc1 lds
  buffer_load_dwordx4 v1, s[8:11], s27 offen offset:3072 sc1 lds
  s_add_u32 s27, s30, s81
  buffer_load_dwordx2 v[26:27], v24, s[8:11], s27 offen sc1
L_if_165:
W_id0a:
  s_waitcnt vmcnt(0)
  s_barrier
  s_cmp_eq_u32 s32, 0
  s_cbranch_scc1 L_fp_166
  s_cmp_eq_u32 s4, 0
  s_cbranch_scc0 L_fp_166_z
  v_mov_b32 v14, 1
  s_mov_b64 exec, 1
  buffer_store_dword v14, v1, s[8:11], s32 offen sc1
  s_mov_b64 exec, -1
L_fp_166_z:
  s_mov_b32 s32, 0
L_fp_166:
  s_add_u32 s30, s38, s82
  s_add_u32 s30, s30, 14
  s_cmp_lt_u32 s30, s88
  s_cbranch_scc0 L_if_167
  s_lshl_b32 s30, s30, 15
  s_add_u32 s27, s30, s80
  s_add_u32 m0, s91, 65536
  s_nop 0
  buffer_load_dwordx4 v1, s[8:11], s27 offen offset:0 sc1 lds
  buffer_load_dwordx4 v1, s[8:11], s27 offen offset:1024 sc1 lds
  buffer_load_dwordx4 v1, s[8:11], s27 offen offset:2048 sc1 lds
  buffer_load_dwordx4 v1, s[8:11], s27 offen offset:3072 sc1 lds
  s_add_u32 m0, s91, 69632
  s_add_u32 s27, s27, 4096
  buffer_load_dwordx4 v1, s[8:11], s27 offen offset:0 sc1 lds
  buffer_load_dwordx4 v1, s[8:11], s27 offen offset:1024 sc1 lds
  buffer_load_dwordx4 v1, s[8:11], s27 offen offset:2048 sc1 lds
  buffer_load_dwordx4 v1, s[8:11], s27 offen offset:3072 sc1 lds
  s_add_u32 m0, s91, 73728
  s_add_u32 s27, s27, 4096
  buffer_load_dwordx4 v1, s[8:11], s27 offen offset:0 sc1 lds
  buffer_load_dwordx4 v1, s[8:11], s27 offen offset:1024 sc1 lds
  buffer_load_dwordx4 v1, s[8:11], s27 offen offset:2048 sc1 lds
  buffer_load_dwordx4 v1, s[8:11], s27 offen offset:3072 sc1 lds
  s_add_u32 m0, s91, 77824
  s_add_u32 s27, s27, 4096
  buffer_load_dwordx4 v1, s[8:11], s27 offen offset:0 sc1 lds
  buffer_load_dwordx4 v1, s[8:11], s27 offen offset:1024 sc1 lds
  buffer_load_dwordx4 v1, s[8:11], s27 offen offset:2048 sc1 lds
  buffer_load_dwordx4 v1, s[8:11], s27 offen offset:3072 sc1 lds
  s_add_u32 s27, s30, s81
  buffer_load_dwordx2 v[28:29], v24, s[8:11], s27 offen sc1
L_if_167:
  s_add_u32 s30, s38, s82
  s_cmp_lt_u32 s30, s88
  s_cbranch_scc0 L_is_168_v
  ds_read_b64_tr_b16 v[36:37], v22 offset:0
  ds_read_b64_tr_b16 v[38:39], v22 offset:256
  ds_read_b64_tr_b16 v[40:41], v22 offset:2048
  ds_read_b64_tr_b16 v[42:43], v22 offset:2304
  ds_read_b64_tr_b16 v[44:45], v22 offset:4096
  ds_read_b64_tr_b16 v[46:47], v22 offset:4352
  ds_read_b64_tr_b16 v[48:49], v22 offset:6144
  ds_read_b64_tr_b16 v[50:51], v22 offset:6400
  ds_read_b64_tr_b16 v[52:53], v22 offset:8192
  ds_read_b64_tr_b16 v[54:55], v22 offset:8448
  ds_read_b64_tr_b16 v[56:57], v22 offset:10240
  ds_read_b64_tr_b16 v[58:59], v22 offset:10496
  s_waitcnt lgkmcnt(10)
  v_mfma_f32_16x16x32_bf16 v[30:33], v[64:67], v[36:39], 0
  ds_read_b64_tr_b16 v[36:37], v22 offset:12288
  ds_read_b64_tr_b16 v[38:39], v22 offset:12544
  s_waitcnt lgkmcnt(10)
  v_mfma_f32_16x16x32_bf16 v[30:33], v[68:71], v[40:43], v[30:33]
  ds_read_b64_tr_b16 v[40:41], v22 offset:14336
  ds_read_b64_tr_b16 v[42:43], v22 offset:14592
  s_waitcnt lgkmcnt(10)
  v_mfma_f32_16x16x32_bf16 v[30:33], v[72:75], v[44:47], v[30:33]
  ds_read_b64_tr_b16 v[44:45], v22 offset:16384
  ds_read_b64_tr_b16 v[46:47], v22 offset:16640
  s_waitcnt lgkmcnt(10)
  v_mfma_f32_16x16x32_bf16 v[30:33], v[76:79], v[48:51], v[30:33]
  ds_read_b64_tr_b16 v[48:49], v22 offset:18432
  ds_read_b64_tr_b16 v[50:51], v22 offset:18688
  s_waitcnt lgkmcnt(10)
  v_mfma_f32_16x16x32_bf16 v[30:33], v[80:83], v[52:55], v[30:33]
  ds_read_b64_tr_b16 v[52:53], v22 offset:20480
  ds_read_b64_tr_b16 v[54:55], v22 offset:20736
  s_waitcnt lgkmcnt(10)
  v_mfma_f32_16x16x32_bf16 v[30:33], v[84:87], v[56:59], v[30:33]
  ds_read_b64_tr_b16 v[56:57], v22 offset:22528
  ds_read_b64_tr_b16 v[58:59], v22 offset:22784
  s_waitcnt lgkmcnt(10)
  v_mfma_f32_16x16x32_bf16 v[30:33], v[88:91], v[36:39], v[30:33]
  ds_read_b64_tr_b16 v[36:37], v22 offset:24576
  ds_read_b64_tr_b16 v[38:39], v22 offset:24832
  s_waitcnt lgkmcnt(10)
  v_mfma_f32_16x16x32_bf16 v[30:33], v[92:95], v[40:43], v[30:33]
  ds_read_b64_tr_b16 v[40:41], v22 offset:26624
  ds_read_b64_tr_b16 v[42:43], v22 offset:26880
  s_waitcnt lgkmcnt(10)
  v_mfma_f32_16x16x32_bf16 v[30:33], v[96:99], v[44:47], v[30:33]
  ds_read_b64_tr_b16 v[44:45], v22 offset:28672
  ds_read_b64_tr_b16 v[46:47], v22 offset:28928
  s_waitcnt lgkmcnt(10)
  v_mfma_f32_16x16x32_bf16 v[30:33], v[100:103], v[48:51], v[30:33]
  ds_read_b64_tr_b16 v[48:49], v22 offset:30720
  ds_read_b64_tr_b16 v[50:51], v22 offset:30976
  s_waitcnt lgkmcnt(10)
  v_mfma_f32_16x16x32_bf16 v[30:33], v[104:107], v[52:55], v[30:33]
  s_waitcnt lgkmcnt(8)
  v_mfma_f32_16x16x32_bf16 v[30:33], v[108:111], v[56:59], v[30:33]
  s_waitcnt lgkmcnt(6)
  v_mfma_f32_16x16x32_bf16 v[30:33], v[112:115], v[36:39], v[30:33]
  s_waitcnt lgkmcnt(4)
  v_mfma_f32_16x16x32_bf16 v[30:33], v[116:119], v[40:43], v[30:33]
  s_waitcnt lgkmcnt(2)
  v_mfma_f32_16x16x32_bf16 v[30:33], v[120:123], v[44:47], v[30:33]
  s_waitcnt lgkmcnt(0)
  v_mfma_f32_16x16x32_bf16 v[30:33], v[124:127], v[48:51], v[30:33]
  s_nop 7
  v_cmp_u_f32 vcc, v30, v31
  s_nop 3
  s_cmp_lg_u64 vcc, 0
  s_cselect_b32 s37, 1, 0
L_is_168_v:
  s_cmp_eq_u32 s22, 0
  s_cbranch_scc0 L_is_168_w
  s_lshl_b32 s27, s4, 2
  v_mov_b32 v21, s27
  v_mov_b32 v36, s37
  ds_write_b32 v21, v36
  v_mov_b32 v21, 0
  s_waitcnt lgkmcnt(0)
  s_barrier
  ds_read_b64 v[36:37], v21
  s_waitcnt lgkmcnt(0)
  v_or_b32 v36, v36, v37
  s_nop 0
  v_readfirstlane_b32 s37, v36
  s_nop 3
  s_cmp_eq_u32 s37, 0
  s_cbranch_scc1 L_is_168_w
  s_add_u32 s36, s36, 1
  s_cmp_lt_u32 s36, 200
  s_cbranch_scc1 W_idr
L_is_168_w:
  s_cmp_lt_u32 s30, s88
  s_cbranch_scc0 L_is_168
  v_lshlrev_b32 v36, 16, v26
  v_and_b32 v37, 0xffff0000, v26
  v_lshlrev_b32 v38, 16, v27
  v_and_b32 v39, 0xffff0000, v27
  s_lshl_b32 s28, s30, 15
  v_cvt_pk_bf16_f32 v30, v30, v31
  v_cvt_pk_bf16_f32 v31, v32, v33
  v_and_b32 v33, 0xffff0000, v31
  v_lshlrev_b32 v32, 16, v31
  v_and_b32 v31, 0xffff0000, v30
  v_lshlrev_b32 v30, 16, v30
  v_add_f32 v30, v30, v36
  v_add_f32 v31, v31, v37
  v_add_f32 v32, v32, v38
  v_add_f32 v33, v33, v39
  v_cvt_pk_bf16_f32 v30, v30, v31
  v_cvt_pk_bf16_f32 v31, v32, v33
  s_cmp_eq_u32 s92, 0
  s_cbranch_scc1 L_id_169_x2
  buffer_store_dwordx2 v[30:31], v24, s[16:19], s28 offen
  s_branch L_is_168
L_id_169_x2:
  s_add_u32 s28, s28, 97517568
  s_cmp_eq_u32 s7, 0
  s_cbranch_scc0 L_xs_170
  buffer_store_dwordx2 v[30:31], v24, s[8:11], s28 offen
  s_branch L_xe_171
L_xs_170:
  buffer_store_dwordx2 v[30:31], v24, s[8:11], s28 offen sc1
L_xe_171:
L_is_168:
  s_add_u32 s38, s38, 14
  s_cmp_lt_u32 s38, s88
  s_cbranch_scc0 W_ide
W_id1a:
  s_waitcnt vmcnt(0)
  s_barrier
  s_add_u32 s30, s38, s82
  s_add_u32 s30, s30, 14
  s_cmp_lt_u32 s30, s88
  s_cbranch_scc0 L_if_172
  s_lshl_b32 s30, s30, 15
  s_add_u32 s27, s30, s80
  s_add_u32 m0, s91, 0
  s_nop 0
  buffer_load_dwordx4 v1, s[8:11], s27 offen offset:0 sc1 lds
  buffer_load_dwordx4 v1, s[8:11], s27 offen offset:1024 sc1 lds
  buffer_load_dwordx4 v1, s[8:11], s27 offen offset:2048 sc1 lds
  buffer_load_dwordx4 v1, s[8:11], s27 offen offset:3072 sc1 lds
  s_add_u32 m0, s91, 4096
  s_add_u32 s27, s27, 4096
  buffer_load_dwordx4 v1, s[8:11], s27 offen offset:0 sc1 lds
  buffer_load_dwordx4 v1, s[8:11], s27 offen offset:1024 sc1 lds
  buffer_load_dwordx4 v1, s[8:11], s27 offen offset:2048 sc1 lds
  buffer_load_dwordx4 v1, s[8:11], s27 offen offset:3072 sc1 lds
  s_add_u32 m0, s91, 8192
  s_add_u32 s27, s27, 4096
  buffer_load_dwordx4 v1, s[8:11], s27 offen offset:0 sc1 lds
  buffer_load_dwordx4 v1, s[8:11], s27 offen offset:1024 sc1 lds
  buffer_load_dwordx4 v1, s[8:11], s27 offen offset:2048 sc1 lds
  buffer_load_dwordx4 v1, s[8:11], s27 offen offset:3072 sc1 lds
  s_add_u32 m0, s91, 12288
  s_add_u32 s27, s27, 4096
  buffer_load_dwordx4 v1, s[8:11], s27 offen offset:0 sc1 lds
  buffer_load_dwordx4 v1, s[8:11], s27 offen offset:1024 sc1 lds
  buffer_load_dwordx4 v1, s[8:11], s27 offen offset:2048 sc1 lds
  buffer_load_dwordx4 v1, s[8:11], s27 offen offset:3072 sc1 lds
  s_add_u32 s27, s30, s81
  buffer_load_dwordx2 v[26:27], v24, s[8:11], s27 offen sc1
L_if_172:
  s_add_u32 s30, s38, s82
  s_cmp_lt_u32 s30, s88
  s_cbranch_scc0 L_is_173
  ds_read_b64_tr_b16 v[36:37], v23 offset:0
  ds_read_b64_tr_b16 v[38:39], v23 offset:256
  ds_read_b64_tr_b16 v[40:41], v23 offset:2048
  ds_read_b64_tr_b16 v[42:43], v23 offset:2304
  ds_read_b64_tr_b16 v[44:45], v23 offset:4096
  ds_read_b64_tr_b16 v[46:47], v23 offset:4352
  ds_read_b64_tr_b16 v[48:49], v23 offset:6144
  ds_read_b64_tr_b16 v[50:51], v23 offset:6400
  ds_read_b64_tr_b16 v[52:53], v23 offset:8192
  ds_read_b64_tr_b16 v[54:55], v23 offset:8448
  ds_read_b64_tr_b16 v[56:57], v23 offset:10240
  ds_read_b64_tr_b16 v[58:59], v23 offset:10496
  s_waitcnt lgkmcnt(10)
  v_mfma_f32_16x16x32_bf16 v[30:33], v[64:67], v[36:39], 0
  ds_read_b64_tr_b16 v[36:37], v23 offset:12288
  ds_read_b64_tr_b16 v[38:39], v23 offset:12544
  s_waitcnt lgkmcnt(10)
  v_mfma_f32_16x16x32_bf16 v[30:33], v[68:71], v[40:43], v[30:33]
  ds_read_b64_tr_b16 v[40:41], v23 offset:14336
  ds_read_b64_tr_b16 v[42:43], v23 offset:14592
  s_waitcnt lgkmcnt(10)
  v_mfma_f32_16x16x32_bf16 v[30:33], v[72:75], v[44:47], v[30:33]
  ds_read_b64_tr_b16 v[44:45], v23 offset:16384
  ds_read_b64_tr_b16 v[46:47], v23 offset:16640
  s_waitcnt lgkmcnt(10)
  v_mfma_f32_16x16x32_bf16 v[30:33], v[76:79], v[48:51], v[30:33]
  ds_read_b64_tr_b16 v[48:49], v23 offset:18432
  ds_read_b64_tr_b16 v[50:51], v23 offset:18688
  s_waitcnt lgkmcnt(10)
  v_mfma_f32_16x16x32_bf16 v[30:33], v[80:83], v[52:55], v[30:33]
  ds_read_b64_tr_b16 v[52:53], v23 offset:20480
  ds_read_b64_tr_b16 v[54:55], v23 offset:20736
  s_waitcnt lgkmcnt(10)
  v_mfma_f32_16x16x32_bf16 v[30:33], v[84:87], v[56:59], v[30:33]
  ds_read_b64_tr_b16 v[56:57], v23 offset:22528
  ds_read_b64_tr_b16 v[58:59], v23 offset:22784
  s_waitcnt lgkmcnt(10)
  v_mfma_f32_16x16x32_bf16 v[30:33], v[88:91], v[36:39], v[30:33]
  ds_read_b64_tr_b16 v[36:37], v23 offset:24576
  ds_read_b64_tr_b16 v[38:39], v23 offset:24832
  s_waitcnt lgkmcnt(10)
  v_mfma_f32_16x16x32_bf16 v[30:33], v[92:95], v[40:43], v[30:33]
  ds_read_b64_tr_b16 v[40:41], v23 offset:26624
  ds_read_b64_tr_b16 v[42:43], v23 offset:26880
  s_waitcnt lgkmcnt(10)
  v_mfma_f32_16x16x32_bf16 v[30:33], v[96:99], v[44:47], v[30:33]
  ds_read_b64_tr_b16 v[44:45], v23 offset:28672
  ds_read_b64_tr_b16 v[46:47], v23 offset:28928
  s_waitcnt lgkmcnt(10)
  v_mfma_f32_16x16x32_bf16 v[30:33], v[100:103], v[48:51], v[30:33]
  ds_read_b64_tr_b16 v[48:49], v23 offset:30720
  ds_read_b64_tr_b16 v[50:51], v23 offset:30976
  s_waitcnt lgkmcnt(10)
  v_mfma_f32_16x16x32_bf16 v[30:33], v[104:107], v[52:55], v[30:33]
  s_waitcnt lgkmcnt(8)
  v_mfma_f32_16x16x32_bf16 v[30:33], v[108:111], v[56:59], v[30:33]
  s_waitcnt lgkmcnt(6)
  v_mfma_f32_16x16x32_bf16 v[30:33], v[112:115], v[36:39], v[30:33]
  s_waitcnt lgkmcnt(4)
  v_mfma_f32_16x16x32_bf16 v[30:33], v[116:119], v[40:43], v[30:33]
  s_waitcnt lgkmcnt(2)
  v_mfma_f32_16x16x32_bf16 v[30:33], v[120:123], v[44:47], v[30:33]
  s_waitcnt lgkmcnt(0)
  v_mfma_f32_16x16x32_bf16 v[30:33], v[124:127], v[48:51], v[30:33]
  v_lshlrev_b32 v36, 16, v28
  v_and_b32 v37, 0xffff0000, v28
  v_lshlrev_b32 v38, 16, v29
  v_and_b32 v39, 0xffff0000, v29
  s_lshl_b32 s28, s30, 15
  s_nop 2
  v_cvt_pk_bf16_f32 v30, v30, v31
  v_cvt_pk_bf16_f32 v31, v32, v33
  v_and_b32 v33, 0xffff0000, v31
  v_lshlrev_b32 v32, 16, v31
  v_and_b32 v31, 0xffff0000, v30
  v_lshlrev_b32 v30, 16, v30
  v_add_f32 v30, v30, v36
  v_add_f32 v31, v31, v37
  v_add_f32 v32, v32, v38
  v_add_f32 v33, v33, v39
  v_cvt_pk_bf16_f32 v30, v30, v31
  v_cvt_pk_bf16_f32 v31, v32, v33
  s_cmp_eq_u32 s92, 0
  s_cbranch_scc1 L_id_174_x2
  buffer_store_dwordx2 v[30:31], v24, s[16:19], s28 offen
  s_branch L_is_173
L_id_174_x2:
  s_add_u32 s28, s28, 97517568
  s_cmp_eq_u32 s7, 0
  s_cbranch_scc0 L_xs_175
  buffer_store_dwordx2 v[30:31], v24, s[8:11], s28 offen
  s_branch L_xe_176
L_xs_175:
  buffer_store_dwordx2 v[30:31], v24, s[8:11], s28 offen sc1
L_xe_176:
L_is_173:
  s_add_u32 s38, s38, 14
  s_cmp_lt_u32 s38, s88
  s_cbranch_scc1 W_id0a
W_ide:
  s_cmp_eq_u32 s92, 1
  s_cbranch_scc1 L_abort
  s_add_u32 s38, s88, s6
  s_waitcnt vmcnt(0)
  s_barrier
  s_cmp_eq_u32 s4, 0
  s_cbranch_scc0 L_idf_177
  v_mul_u32_u24 v21, 7, v20
  v_add_u32 v21, s83, v21
  v_cmp_gt_u32 vcc, s88, v21
  v_lshlrev_b32 v21, 7, v21
  s_lshl_b32 s27, s5, 2
  s_add_u32 s27, s27, 344064
  v_mov_b32 v14, 1
  s_mov_b64 exec, vcc
  s_cmp_eq_u32 s7, 0
  s_cbranch_scc0 L_xs_178
  buffer_store_dword v14, v21, s[8:11], s27 offen
  s_branch L_xe_179
L_xs_178:
  buffer_store_dword v14, v21, s[8:11], s27 offen sc1
L_xe_179:
  s_mov_b64 exec, -1
L_idf_177:
  s_mul_i32 s36, s4, 7
  s_add_u32 s36, s36, s21
  s_add_u32 s37, s36, 28
  s_add_u32 s91, s36, 56
  s_lshl_b32 s30, s5, 10
  v_add_u32 v42, s30, v1
  s_cmp_lt_u32 s36, s88
  s_cbranch_scc0 L_ln_180
  s_lshl_b32 s28, s36, 15
  s_cmp_eq_u32 s20, 0
  s_cbranch_scc0 L_ln_180_x2
  buffer_load_dwordx4 v[20:23], v42, s[12:15], s28 offen
  s_branch L_ln_180
L_ln_180_x2:
  s_lshl_b32 s27, s36, 7
  s_add_u32 s27, s27, 344064
  v_lshrrev_b32 v15, 2, v1
  v_and_b32 v15, 0x7c, v15
L_wf_181:
  buffer_load_dword v14, v15, s[8:11], s27 offen sc1
  s_waitcnt vmcnt(0)
  v_cmp_eq_u32 vcc, 0, v14
  s_cbranch_vccz L_wf_181_ok
  s_add_u32 s39, s39, 1
  s_cmp_gt_u32 s39, 0x10000
  s_cbranch_scc1 L_abort
  s_branch L_wf_181
L_wf_181_ok:
  s_add_u32 s28, s28, 97517568
  buffer_load_dwordx4 v[20:23], v42, s[8:11], s28 offen sc1
L_ln_180:
  s_cmp_lt_u32 s37, s88
  s_cbranch_scc0 L_ln_182
  s_lshl_b32 s28, s37, 15
  s_cmp_eq_u32 s20, 0
  s_cbranch_scc0 L_ln_182_x2
  buffer_load_dwordx4 v[24:27], v42, s[12:15], s28 offen
  s_branch L_ln_182
L_ln_182_x2:
  s_lshl_b32 s27, s37, 7
  s_add_u32 s27, s27, 344064
  v_lshrrev_b32 v15, 2, v1
  v_and_b32 v15, 0x7c, v15
L_wf_183:
  buffer_load_dword v14, v15, s[8:11], s27 offen sc1
  s_waitcnt vmcnt(0)
  v_cmp_eq_u32 vcc, 0, v14
  s_cbranch_vccz L_wf_183_ok
  s_add_u32 s39, s39, 1
  s_cmp_gt_u32 s39, 0x10000
  s_cbranch_scc1 L_abort
  s_branch L_wf_183
L_wf_183_ok:
  s_add_u32 s28, s28, 97517568
  buffer_load_dwordx4 v[24:27], v42, s[8:11], s28 offen sc1
L_ln_182:
  s_cmp_lt_u32 s91, s88
  s_cbranch_scc0 L_ln_184
  s_lshl_b32 s28, s91, 15
  s_cmp_eq_u32 s20, 0
  s_cbranch_scc0 L_ln_184_x2
  buffer_load_dwordx4 v[28:31], v42, s[12:15], s28 offen
  s_branch L_ln_184
L_ln_184_x2:
  s_lshl_b32 s27, s91, 7
  s_add_u32 s27, s27, 344064
  v_lshrrev_b32 v15, 2, v1
  v_and_b32 v15, 0x7c, v15
L_wf_185:
  buffer_load_dword v14, v15, s[8:11], s27 offen sc1
  s_waitcnt vmcnt(0)
  v_cmp_eq_u32 vcc, 0, v14
  s_cbranch_vccz L_wf_185_ok
  s_add_u32 s39, s39, 1
  s_cmp_gt_u32 s39, 0x10000
  s_cbranch_scc1 L_abort
  s_branch L_wf_185
L_wf_185_ok:
  s_add_u32 s28, s28, 97517568
  buffer_load_dwordx4 v[28:31], v42, s[8:11], s28 offen sc1
L_ln_184:
  v_lshrrev_b32 v43, 5, v1
  v_lshlrev_b32 v43, 10, v43
  v_bfe_u32 v42, v1, 4, 1
  v_lshl_add_u32 v43, v42, 9, v43
  s_lshl_b32 s30, s5, 4
  v_add_u32 v43, s30, v43
  s_waitcnt vmcnt(0)
  s_cmp_lt_u32 s36, s88
  s_cbranch_scc0 L_lne_186
  v_lshlrev_b32 v32, 16, v20
  v_and_b32 v33, 0xffff0000, v20
  v_lshlrev_b32 v34, 16, v21
  v_and_b32 v35, 0xffff0000, v21
  v_lshlrev_b32 v36, 16, v22
  v_and_b32 v37, 0xffff0000, v22
  v_lshlrev_b32 v38, 16, v23
  v_and_b32 v39, 0xffff0000, v23
  v_add_f32 v40, v32, v33
  v_mul_f32 v41, v32, v32
  v_fmac_f32 v41, v33, v33
  v_add_f32 v40, v40, v34
  v_fmac_f32 v41, v34, v34
  v_add_f32 v40, v40, v35
  v_fmac_f32 v41, v35, v35
  v_add_f32 v40, v40, v36
  v_fmac_f32 v41, v36, v36
  v_add_f32 v40, v40, v37
  v_fmac_f32 v41, v37, v37
  v_add_f32 v40, v40, v38
  v_fmac_f32 v41, v38, v38
  v_add_f32 v40, v40, v39
  v_fmac_f32 v41, v39, v39
  s_nop 0
  v_add_f32_dpp v40, v40, v40 row_ror:8 row_mask:0xf bank_mask:0xf
  v_add_f32_dpp v41, v41, v41 row_ror:8 row_mask:0xf bank_mask:0xf
  s_nop 0
  v_add_f32_dpp v40, v40, v40 row_ror:4 row_mask:0xf bank_mask:0xf
  v_add_f32_dpp v41, v41, v41 row_ror:4 row_mask:0xf bank_mask:0xf
  s_nop 0
  v_add_f32_dpp v40, v40, v40 row_ror:2 row_mask:0xf bank_mask:0xf
  v_add_f32_dpp v41, v41, v41 row_ror:2 row_mask:0xf bank_mask:0xf
  s_nop 0
  v_add_f32_dpp v40, v40, v40 row_ror:1 row_mask:0xf bank_mask:0xf
  v_add_f32_dpp v41, v41, v41 row_ror:1 row_mask:0xf bank_mask:0xf
  v_mov_b32 v42, v40
  v_mov_b32 v44, v41
  s_nop 0
  v_permlane32_swap_b32 v40, v42
  v_permlane32_swap_b32 v41, v44
  v_add_f32 v40, v40, v42
  v_add_f32 v41, v41, v44
  v_mov_b32 v42, v40
  v_mov_b32 v44, v41
  s_nop 0
  v_permlane16_swap_b32 v40, v42
  v_permlane16_swap_b32 v41, v44
  v_add_f32 v40, v40, v42
  v_add_f32 v41, v41, v44
  v_mul_f32 v40, 0x3b000000, v40
  v_mul_f32 v41, 0x3b000000, v41
  v_fma_f32 v41, -v40, v40, v41
  v_max_f32 v41, 0, v41
  v_add_f32 v41, 0x3727c5ac, v41
  v_rsq_f32 v41, v41
  v_sub_f32 v32, v32, v40
  v_sub_f32 v33, v33, v40
  v_sub_f32 v34, v34, v40
  v_sub_f32 v35, v35, v40
  v_sub_f32 v36, v36, v40
  v_sub_f32 v37, v37, v40
  v_sub_f32 v38, v38, v40
  v_sub_f32 v39, v39, v40
  v_mul_f32 v32, v32, v41
  v_mul_f32 v33, v33, v41
  v_mul_f32 v34, v34, v41
  v_mul_f32 v35, v35, v41
  v_mul_f32 v36, v36, v41
  v_mul_f32 v37, v37, v41
  v_mul_f32 v38, v38, v41
  v_mul_f32 v39, v39, v41
  v_cvt_pk_bf16_f32 v20, v32, v33
  v_cvt_pk_bf16_f32 v21, v34, v35
  v_cvt_pk_bf16_f32 v22, v36, v37
  v_cvt_pk_bf16_f32 v23, v38, v39
  s_lshl_b32 s29, s20, 6
  s_add_u32 s29, s29, s36
  s_lshl_b32 s29, s29, 15
  s_add_u32 s29, s29, 84934656
  s_cmp_eq_u32 s7, 0
  s_cbranch_scc0 L_xs_187
  buffer_store_dwordx4 v[20:23], v43, s[8:11], s29 offen
  s_branch L_xe_188
L_xs_187:
  buffer_store_dwordx4 v[20:23], v43, s[8:11], s29 offen sc1
L_xe_188:
  s_cmp_lt_u32 s37, s88
  s_cbranch_scc0 L_lne_186
  v_lshlrev_b32 v32, 16, v24
  v_and_b32 v33, 0xffff0000, v24
  v_lshlrev_b32 v34, 16, v25
  v_and_b32 v35, 0xffff0000, v25
  v_lshlrev_b32 v36, 16, v26
  v_and_b32 v37, 0xffff0000, v26
  v_lshlrev_b32 v38, 16, v27
  v_and_b32 v39, 0xffff0000, v27
  v_add_f32 v40, v32, v33
  v_mul_f32 v41, v32, v32
  v_fmac_f32 v41, v33, v33
  v_add_f32 v40, v40, v34
  v_fmac_f32 v41, v34, v34
  v_add_f32 v40, v40, v35
  v_fmac_f32 v41, v35, v35
  v_add_f32 v40, v40, v36
  v_fmac_f32 v41, v36, v36
  v_add_f32 v40, v40, v37
  v_fmac_f32 v41, v37, v37
  v_add_f32 v40, v40, v38
  v_fmac_f32 v41, v38, v38
  v_add_f32 v40, v40, v39
  v_fmac_f32 v41, v39, v39
  s_nop 0
  v_add_f32_dpp v40, v40, v40 row_ror:8 row_mask:0xf bank_mask:0xf
  v_add_f32_dpp v41, v41, v41 row_ror:8 row_mask:0xf bank_mask:0xf
  s_nop 0
  v_add_f32_dpp v40, v40, v40 row_ror:4 row_mask:0xf bank_mask:0xf
  v_add_f32_dpp v41, v41, v41 row_ror:4 row_mask:0xf bank_mask:0xf
  s_nop 0
  v_add_f32_dpp v40, v40, v40 row_ror:2 row_mask:0xf bank_mask:0xf
  v_add_f32_dpp v41, v41, v41 row_ror:2 row_mask:0xf bank_mask:0xf
  s_nop 0
  v_add_f32_dpp v40, v40, v40 row_ror:1 row_mask:0xf bank_mask:0xf
  v_add_f32_dpp v41, v41, v41 row_ror:1 row_mask:0xf bank_mask:0xf
  v_mov_b32 v42, v40
  v_mov_b32 v44, v41
  s_nop 0
  v_permlane32_swap_b32 v40, v42
  v_permlane32_swap_b32 v41, v44
  v_add_f32 v40, v40, v42
  v_add_f32 v41, v41, v44
  v_mov_b32 v42, v40
  v_mov_b32 v44, v41
  s_nop 0
  v_permlane16_swap_b32 v40, v42
  v_permlane16_swap_b32 v41, v44
  v_add_f32 v40, v40, v42
  v_add_f32 v41, v41, v44
  v_mul_f32 v40, 0x3b000000, v40
  v_mul_f32 v41, 0x3b000000, v41
  v_fma_f32 v41, -v40, v40, v41
  v_max_f32 v41, 0, v41
  v_add_f32 v41, 0x3727c5ac, v41
  v_rsq_f32 v41, v41
  v_sub_f32 v32, v32, v40
  v_sub_f32 v33, v33, v40
  v_sub_f32 v34, v34, v40
  v_sub_f32 v35, v35, v40
  v_sub_f32 v36, v36, v40
  v_sub_f32 v37, v37, v40
  v_sub_f32 v38, v38, v40
  v_sub_f32 v39, v39, v40
  v_mul_f32 v32, v32, v41
  v_mul_f32 v33, v33, v41
  v_mul_f32 v34, v34, v41
  v_mul_f32 v35, v35, v41
  v_mul_f32 v36, v36, v41
  v_mul_f32 v37, v37, v41
  v_mul_f32 v38, v38, v41
  v_mul_f32 v39, v39, v41
  v_cvt_pk_bf16_f32 v24, v32, v33
  v_cvt_pk_bf16_f32 v25, v34, v35
  v_cvt_pk_bf16_f32 v26, v36, v37
  v_cvt_pk_bf16_f32 v27, v38, v39
  s_lshl_b32 s29, s20, 6
  s_add_u32 s29, s29, s37
  s_lshl_b32 s29, s29, 15
  s_add_u32 s29, s29, 84934656
  s_cmp_eq_u32 s7, 0
  s_cbranch_scc0 L_xs_189
  buffer_store_dwordx4 v[24:27], v43, s[8:11], s29 offen
  s_branch L_xe_190
L_xs_189:
  buffer_store_dwordx4 v[24:27], v43, s[8:11], s29 offen sc1
L_xe_190:
  s_cmp_lt_u32 s91, s88
  s_cbranch_scc0 L_lne_186
  v_lshlrev_b32 v32, 16, v28
  v_and_b32 v33, 0xffff0000, v28
  v_lshlrev_b32 v34, 16, v29
  v_and_b32 v35, 0xffff0000, v29
  v_lshlrev_b32 v36, 16, v30
  v_and_b32 v37, 0xffff0000, v30
  v_lshlrev_b32 v38, 16, v31
  v_and_b32 v39, 0xffff0000, v31
  v_add_f32 v40, v32, v33
  v_mul_f32 v41, v32, v32
  v_fmac_f32 v41, v33, v33
  v_add_f32 v40, v40, v34
  v_fmac_f32 v41, v34, v34
  v_add_f32 v40, v40, v35
  v_fmac_f32 v41, v35, v35
  v_add_f32 v40, v40, v36
  v_fmac_f32 v41, v36, v36
  v_add_f32 v40, v40, v37
  v_fmac_f32 v41, v37, v37
  v_add_f32 v40, v40, v38
  v_fmac_f32 v41, v38, v38
  v_add_f32 v40, v40, v39
  v_fmac_f32 v41, v39, v39
  s_nop 0
  v_add_f32_dpp v40, v40, v40 row_ror:8 row_mask:0xf bank_mask:0xf
  v_add_f32_dpp v41, v41, v41 row_ror:8 row_mask:0xf bank_mask:0xf
  s_nop 0
  v_add_f32_dpp v40, v40, v40 row_ror:4 row_mask:0xf bank_mask:0xf
  v_add_f32_dpp v41, v41, v41 row_ror:4 row_mask:0xf bank_mask:0xf
  s_nop 0
  v_add_f32_dpp v40, v40, v40 row_ror:2 row_mask:0xf bank_mask:0xf
  v_add_f32_dpp v41, v41, v41 row_ror:2 row_mask:0xf bank_mask:0xf
  s_nop 0
  v_add_f32_dpp v40, v40, v40 row_ror:1 row_mask:0xf bank_mask:0xf
  v_add_f32_dpp v41, v41, v41 row_ror:1 row_mask:0xf bank_mask:0xf
  v_mov_b32 v42, v40
  v_mov_b32 v44, v41
  s_nop 0
  v_permlane32_swap_b32 v40, v42
  v_permlane32_swap_b32 v41, v44
  v_add_f32 v40, v40, v42
  v_add_f32 v41, v41, v44
  v_mov_b32 v42, v40
  v_mov_b32 v44, v41
  s_nop 0
  v_permlane16_swap_b32 v40, v42
  v_permlane16_swap_b32 v41, v44
  v_add_f32 v40, v40, v42
  v_add_f32 v41, v41, v44
  v_mul_f32 v40, 0x3b000000, v40
  v_mul_f32 v41, 0x3b000000, v41
  v_fma_f32 v41, -v40, v40, v41
  v_max_f32 v41, 0, v41
  v_add_f32 v41, 0x3727c5ac, v41
  v_rsq_f32 v41, v41
  v_sub_f32 v32, v32, v40
  v_sub_f32 v33, v33, v40
  v_sub_f32 v34, v34, v40
  v_sub_f32 v35, v35, v40
  v_sub_f32 v36, v36, v40
  v_sub_f32 v37, v37, v40
  v_sub_f32 v38, v38, v40
  v_sub_f32 v39, v39, v40
  v_mul_f32 v32, v32, v41
  v_mul_f32 v33, v33, v41
  v_mul_f32 v34, v34, v41
  v_mul_f32 v35, v35, v41
  v_mul_f32 v36, v36, v41
  v_mul_f32 v37, v37, v41
  v_mul_f32 v38, v38, v41
  v_mul_f32 v39, v39, v41
  v_cvt_pk_bf16_f32 v28, v32, v33
  v_cvt_pk_bf16_f32 v29, v34, v35
  v_cvt_pk_bf16_f32 v30, v36, v37
  v_cvt_pk_bf16_f32 v31, v38, v39
  s_lshl_b32 s29, s20, 6
  s_add_u32 s29, s29, s91
  s_lshl_b32 s29, s29, 15
  s_add_u32 s29, s29, 84934656
  s_cmp_eq_u32 s7, 0
  s_cbranch_scc0 L_xs_191
  buffer_store_dwordx4 v[28:31], v43, s[8:11], s29 offen
  s_branch L_xe_192
L_xs_191:
  buffer_store_dwordx4 v[28:31], v43, s[8:11], s29 offen sc1
L_xe_192:
L_lne_186:
  s_waitcnt vmcnt(0)
  v_mov_b32 v14, 1
  s_mov_b64 exec, 1
  s_cmp_lt_u32 s36, s88
  s_cbranch_scc0 L_lnf_193
  s_lshl_b32 s27, s20, 6
  s_add_u32 s27, s27, s36
  s_lshl_b32 s27, s27, 7
  s_add_u32 s27, s27, 294912
  s_lshl_b32 s31, s5, 2
  s_add_u32 s27, s27, s31
  s_cmp_eq_u32 s7, 0
  s_cbranch_scc0 L_xs_194
  buffer_store_dword v14, v1, s[8:11], s27 offen
  s_branch L_xe_195
L_xs_194:
  buffer_store_dword v14, v1, s[8:11], s27 offen sc1
L_xe_195:
  s_cmp_lt_u32 s37, s88
  s_cbranch_scc0 L_lnf_193
  s_lshl_b32 s27, s20, 6
  s_add_u32 s27, s27, s37
  s_lshl_b32 s27, s27, 7
  s_add_u32 s27, s27, 294912
  s_lshl_b32 s31, s5, 2
  s_add_u32 s27, s27, s31
  s_cmp_eq_u32 s7, 0
  s_cbranch_scc0 L_xs_196
  buffer_store_dword v14, v1, s[8:11], s27 offen
  s_branch L_xe_197
L_xs_196:
  buffer_store_dword v14, v1, s[8:11], s27 offen sc1
L_xe_197:
  s_cmp_lt_u32 s91, s88
  s_cbranch_scc0 L_lnf_193
  s_lshl_b32 s27, s20, 6
  s_add_u32 s27, s27, s91
  s_lshl_b32 s27, s27, 7
  s_add_u32 s27, s27, 294912
  s_lshl_b32 s31, s5, 2
  s_add_u32 s27, s27, s31
  s_cmp_eq_u32 s7, 0
  s_cbranch_scc0 L_xs_198
  buffer_store_dword v14, v1, s[8:11], s27 offen
  s_branch L_xe_199
L_xs_198:
  buffer_store_dword v14, v1, s[8:11], s27 offen sc1
L_xe_199:
L_lnf_193:
  s_mov_b64 exec, -1
W_kv:
  v_lshrrev_b32 v20, 7, v1
  v_mul_u32_u24 v20, 7, v20
  v_add_u32 v20, s21, v20
  s_sub_u32 s28, s88, 1
  v_add_u32 v22, 56, v20
  v_cmp_lt_u32 vcc, s28, v20
  v_mov_b32 v24, s21
  s_nop 0
  v_cndmask_b32 v20, v20, v24, vcc
  v_cmp_lt_u32 vcc, s28, v22
  v_mov_b32 v24, s21
  s_nop 0
  v_cndmask_b32 v22, v22, v24, vcc
  v_and_b32 v24, 0x70, v1
  v_lshl_add_u32 v21, v20, 7, v24
  v_lshl_add_u32 v22, v22, 7, v24
  s_lshl_b32 s27, s20, 13
  s_add_u32 s27, s27, 294912
L_hb_200:
  buffer_load_dwordx4 v[24:27], v21, s[8:11], s27 offen sc1
  buffer_load_dwordx4 v[28:31], v22, s[8:11], s27 offen sc1
  s_waitcnt vmcnt(0)
  v_min3_u32 v24, v24, v25, v26
  v_min3_u32 v24, v24, v27, v28
  v_min3_u32 v24, v24, v29, v30
  v_min_u32 v24, v24, v31
  v_cmp_eq_u32 vcc, 0, v24
  s_cbranch_vccz L_hb_200_ok
  s_add_u32 s39, s39, 1
  s_cmp_gt_u32 s39, 0x10000
  s_cbranch_scc1 L_abort
  s_branch L_hb_200
L_hb_200_ok:
  s_add_u32 s28, s33, s89
  s_lshl_b32 s27, s20, 6
  s_add_u32 s27, s27, s21
  s_lshl_b32 s27, s27, 15
  s_add_u32 s27, s27, 84934656
  s_lshl_b32 s29, s4, 13
  s_add_u32 s27, s27, s29
  s_add_u32 m0, s28, 0
  s_nop 0
  buffer_load_dwordx4 v1, s[8:11], s27 offen offset:0 sc1 lds
  buffer_load_dwordx4 v1, s[8:11], s27 offen offset:1024 sc1 lds
  buffer_load_dwordx4 v1, s[8:11], s27 offen offset:2048 sc1 lds
  buffer_load_dwordx4 v1, s[8:11], s27 offen offset:3072 sc1 lds
  s_add_u32 m0, s28, 4096
  s_add_u32 s27, s27, 4096
  buffer_load_dwordx4 v1, s[8:11], s27 offen offset:0 sc1 lds
  buffer_load_dwordx4 v1, s[8:11], s27 offen offset:1024 sc1 lds
  buffer_load_dwordx4 v1, s[8:11], s27 offen offset:2048 sc1 lds
  buffer_load_dwordx4 v1, s[8:11], s27 offen offset:3072 sc1 lds
  s_mov_b32 s91, 0
  s_waitcnt vmcnt(0)
W_kvl:
  s_add_u32 s28, s89, 32768
  v_add_u32 v84, s28, v1
  v_add_u32 v85, 0x10000, v84
  s_xor_b32 s89, s89, 24576
  s_waitcnt vmcnt(4)
  s_barrier
  ds_read_b128 v[20:23], v84 offset:0
  ds_read_b128 v[24:27], v84 offset:1024
  ds_read_b128 v[28:31], v84 offset:2048
  ds_read_b128 v[32:35], v84 offset:3072
  ds_read_b128 v[36:39], v84 offset:4096
  ds_read_b128 v[40:43], v84 offset:5120
  ds_read_b128 v[44:47], v84 offset:6144
  s_cmp_eq_u32 s32, 0
  s_cbranch_scc1 L_fp_201
  s_cmp_eq_u32 s4, 0
  s_cbranch_scc0 L_fp_201_z
  v_mov_b32 v14, 1
  s_mov_b64 exec, 1
  buffer_store_dword v14, v1, s[8:11], s32 offen sc1
  s_mov_b64 exec, -1
L_fp_201_z:
  s_mov_b32 s32, 0
L_fp_201:
  s_mov_b32 s32, s91
  s_add_u32 s23, s21, 7
  s_min_u32 s30, s23, s88
  s_cmp_lt_u32 s23, s88
  s_cselect_b32 s30, s23, s21
  s_lshl_b32 s27, s20, 6
  s_add_u32 s27, s27, s30
  s_lshl_b32 s27, s27, 15
  s_add_u32 s27, s27, 84934656
  s_lshl_b32 s29, s4, 13
  s_add_u32 s27, s27, s29
  s_add_u32 s28, s33, s89
  s_waitcnt lgkmcnt(6)
  v_mfma_f32_32x32x16_bf16 v[92:107], a[0:3], v[20:23], 0
  ds_read_b128 v[48:51], v84 offset:7168
  v_mfma_f32_32x32x16_bf16 v[108:123], v[20:23], a[128:131], 0
  s_waitcnt lgkmcnt(6)
  v_mfma_f32_32x32x16_bf16 v[92:107], a[4:7], v[24:27], v[92:107]
  ds_read_b128 v[20:23], v84 offset:32768
  v_mfma_f32_32x32x16_bf16 v[108:123], v[24:27], a[132:135], v[108:123]
  s_waitcnt lgkmcnt(6)
  v_mfma_f32_32x32x16_bf16 v[92:107], a[8:11], v[28:31], v[92:107]
  ds_read_b128 v[24:27], v84 offset:33792
  v_mfma_f32_32x32x16_bf16 v[108:123], v[28:31], a[136:139], v[108:123]
  s_waitcnt lgkmcnt(6)
  v_mfma_f32_32x32x16_bf16 v[92:107], a[12:15], v[32:35], v[92:107]
  ds_read_b128 v[28:31], v84 offset:34816
  v_mfma_f32_32x32x16_bf16 v[108:123], v[32:35], a[140:143], v[108:123]
  s_waitcnt lgkmcnt(6)
  v_mfma_f32_32x32x16_bf16 v[92:107], a[16:19], v[36:39], v[92:107]
  ds_read_b128 v[32:35], v84 offset:35840
  v_mfma_f32_32x32x16_bf16 v[108:123], v[36:39], a[144:147], v[108:123]
  s_add_u32 m0, s28, 0
  s_nop 0
  buffer_load_dwordx4 v1, s[8:11], s27 offen offset:0 sc1 lds
  s_waitcnt lgkmcnt(6)
  v_mfma_f32_32x32x16_bf16 v[92:107], a[20:23], v[40:43], v[92:107]
  ds_read_b128 v[36:39], v84 offset:36864
  v_mfma_f32_32x32x16_bf16 v[108:123], v[40:43], a[148:151], v[108:123]
  s_waitcnt lgkmcnt(6)
  v_mfma_f32_32x32x16_bf16 v[92:107], a[24:27], v[44:47], v[92:107]
  ds_read_b128 v[40:43], v84 offset:37888
  v_mfma_f32_32x32x16_bf16 v[108:123], v[44:47], a[152:155], v[108:123]
  buffer_load_dwordx4 v1, s[8:11], s27 offen offset:1024 sc1 lds
  s_waitcnt lgkmcnt(6)
  v_mfma_f32_32x32x16_bf16 v[92:107], a[28:31], v[48:51], v[92:107]
  ds_read_b128 v[44:47], v84 offset:38912
  v_mfma_f32_32x32x16_bf16 v[108:123], v[48:51], a[156:159], v[108:123]
  s_waitcnt lgkmcnt(6)
  v_mfma_f32_32x32x16_bf16 v[92:107], a[32:35], v[20:23], v[92:107]
  ds_read_b128 v[48:51], v84 offset:39936
  v_mfma_f32_32x32x16_bf16 v[108:123], v[20:23], a[160:163], v[108:123]
  buffer_load_dwordx4 v1, s[8:11], s27 offen offset:2048 sc1 lds
  s_waitcnt lgkmcnt(6)
  v_mfma_f32_32x32x16_bf16 v[92:107], a[36:39], v[24:27], v[92:107]
  ds_read_b128 v[20:23], v85 offset:0
  v_mfma_f32_32x32x16_bf16 v[108:123], v[24:27], a[164:167], v[108:123]
  s_waitcnt lgkmcnt(6)
  v_mfma_f32_32x32x16_bf16 v[92:107], a[40:43], v[28:31], v[92:107]
  ds_read_b128 v[24:27], v85 offset:1024
  v_mfma_f32_32x32x16_bf16 v[108:123], v[28:31], a[168:171], v[108:123]
  buffer_load_dwordx4 v1, s[8:11], s27 offen offset:3072 sc1 lds
  s_waitcnt lgkmcnt(6)
  v_mfma_f32_32x32x16_bf16 v[92:107], a[44:47], v[32:35], v[92:107]
  ds_read_b128 v[28:31], v85 offset:2048
  v_mfma_f32_32x32x16_bf16 v[108:123], v[32:35], a[172:175], v[108:123]
  s_waitcnt lgkmcnt(6)
  v_mfma_f32_32x32x16_bf16 v[92:107], a[48:51], v[36:39], v[92:107]
  ds_read_b128 v[32:35], v85 offset:3072
  v_mfma_f32_32x32x16_bf16 v[108:123], v[36:39], a[176:179], v[108:123]
  s_add_u32 m0, s28, 4096
  s_add_u32 s27, s27, 4096
  buffer_load_dwordx4 v1, s[8:11], s27 offen offset:0 sc1 lds
  s_waitcnt lgkmcnt(6)
  v_mfma_f32_32x32x16_bf16 v[92:107], a[52:55], v[40:43], v[92:107]
  ds_read_b128 v[36:39], v85 offset:4096
  v_mfma_f32_32x32x16_bf16 v[108:123], v[40:43], a[180:183], v[108:123]
  s_waitcnt lgkmcnt(6)
  v_mfma_f32_32x32x16_bf16 v[92:107], a[56:59], v[44:47], v[92:107]
  ds_read_b128 v[40:43], v85 offset:5120
  v_mfma_f32_32x32x16_bf16 v[108:123], v[44:47], a[184:187], v[108:123]
  buffer_load_dwordx4 v1, s[8:11], s27 offen offset:1024 sc1 lds
  s_waitcnt lgkmcnt(6)
  v_mfma_f32_32x32x16_bf16 v[92:107], a[60:63], v[48:51], v[92:107]
  ds_read_b128 v[44:47], v85 offset:6144
  v_mfma_f32_32x32x16_bf16 v[108:123], v[48:51], a[188:191], v[108:123]
  s_waitcnt lgkmcnt(6)
  v_mfma_f32_32x32x16_bf16 v[92:107], a[64:67], v[20:23], v[92:107]
  ds_read_b128 v[48:51], v85 offset:7168
  v_mfma_f32_32x32x16_bf16 v[108:123], v[20:23], a[192:195], v[108:123]
  buffer_load_dwordx4 v1, s[8:11], s27 offen offset:2048 sc1 lds
  s_waitcnt lgkmcnt(6)
  v_mfma_f32_32x32x16_bf16 v[92:107], a[68:71], v[24:27], v[92:107]
  ds_read_b128 v[20:23], v85 offset:32768
  v_mfma_f32_32x32x16_bf16 v[108:123], v[24:27], a[196:199], v[108:123]
  s_waitcnt lgkmcnt(6)
  v_mfma_f32_32x32x16_bf16 v[92:107], a[72:75], v[28:31], v[92:107]
  ds_read_b128 v[24:27], v85 offset:33792
  v_mfma_f32_32x32x16_bf16 v[108:123], v[28:31], a[200:203], v[108:123]
  buffer_load_dwordx4 v1, s[8:11], s27 offen offset:3072 sc1 lds
  s_waitcnt lgkmcnt(6)
  v_mfma_f32_32x32x16_bf16 v[92:107], a[76:79], v[32:35], v[92:107]
  ds_read_b128 v[28:31], v85 offset:34816
  v_mfma_f32_32x32x16_bf16 v[108:123], v[32:35], a[204:207], v[108:123]
  s_waitcnt lgkmcnt(6)
  v_mfma_f32_32x32x16_bf16 v[92:107], a[80:83], v[36:39], v[92:107]
  ds_read_b128 v[32:35], v85 offset:35840
  v_mfma_f32_32x32x16_bf16 v[108:123], v[36:39], a[208:211], v[108:123]
  s_waitcnt lgkmcnt(6)
  v_mfma_f32_32x32x16_bf16 v[92:107], a[84:87], v[40:43], v[92:107]
  ds_read_b128 v[36:39], v85 offset:36864
  v_mfma_f32_32x32x16_bf16 v[108:123], v[40:43], a[212:215], v[108:123]
  s_waitcnt lgkmcnt(6)
  v_mfma_f32_32x32x16_bf16 v[92:107], a[88:91], v[44:47], v[92:107]
  ds_read_b128 v[40:43], v85 offset:37888
  v_mfma_f32_32x32x16_bf16 v[108:123], v[44:47], a[216:219], v[108:123]
  s_waitcnt lgkmcnt(6)
  v_mfma_f32_32x32x16_bf16 v[92:107], a[92:95], v[48:51], v[92:107]
  ds_read_b128 v[44:47], v85 offset:38912
  v_mfma_f32_32x32x16_bf16 v[108:123], v[48:51], a[220:223], v[108:123]
  s_waitcnt lgkmcnt(6)
  v_mfma_f32_32x32x16_bf16 v[92:107], a[96:99], v[20:23], v[92:107]
  ds_read_b128 v[48:51], v85 offset:39936
  v_mfma_f32_32x32x16_bf16 v[108:123], v[20:23], a[224:227], v[108:123]
  s_waitcnt lgkmcnt(6)
  v_mfma_f32_32x32x16_bf16 v[92:107], a[100:103], v[24:27], v[92:107]
  v_mfma_f32_32x32x16_bf16 v[108:123], v[24:27], a[228:231], v[108:123]
  s_waitcnt lgkmcnt(5)
  v_mfma_f32_32x32x16_bf16 v[92:107], a[104:107], v[28:31], v[92:107]
  v_mfma_f32_32x32x16_bf16 v[108:123], v[28:31], a[232:235], v[108:123]
  s_waitcnt lgkmcnt(4)
  v_mfma_f32_32x32x16_bf16 v[92:107], a[108:111], v[32:35], v[92:107]
  v_mfma_f32_32x32x16_bf16 v[108:123], v[32:35], a[236:239], v[108:123]
  s_waitcnt lgkmcnt(3)
  v_mfma_f32_32x32x16_bf16 v[92:107], a[112:115], v[36:39], v[92:107]
  v_mfma_f32_32x32x16_bf16 v[108:123], v[36:39], a[240:243], v[108:123]
  s_waitcnt lgkmcnt(2)
  v_mfma_f32_32x32x16_bf16 v[92:107], a[116:119], v[40:43], v[92:107]
  v_mfma_f32_32x32x16_bf16 v[108:123], v[40:43], a[244:247], v[108:123]
  s_waitcnt lgkmcnt(1)
  v_mfma_f32_32x32x16_bf16 v[92:107], a[120:123], v[44:47], v[92:107]
  v_mfma_f32_32x32x16_bf16 v[108:123], v[44:47], a[248:251], v[108:123]
  s_waitcnt lgkmcnt(0)
  v_mfma_f32_32x32x16_bf16 v[92:107], a[124:127], v[48:51], v[92:107]
  v_mfma_f32_32x32x16_bf16 v[108:123], v[48:51], a[252:255], v[108:123]
  s_lshl_b32 s27, s20, 6
  s_add_u32 s27, s27, s21
  s_lshl_b32 s27, s27, 5
  s_add_u32 s27, s27, 0
  s_add_u32 s27, s27, s5
  s_lshl_b32 s27, s27, 14
  s_add_u32 s27, s27, 17825792
  s_lshl_b32 s28, s4, 10
  s_add_u32 s29, s27, s28
  s_add_u32 s30, s29, s28
  s_add_u32 s30, s30, 8192
  v_cvt_pk_bf16_f32 v52, v92, v93
  v_cvt_pk_bf16_f32 v53, v94, v95
  v_cvt_pk_bf16_f32 v54, v96, v97
  v_cvt_pk_bf16_f32 v55, v98, v99
  v_cvt_pk_bf16_f32 v56, v100, v101
  v_cvt_pk_bf16_f32 v57, v102, v103
  v_cvt_pk_bf16_f32 v58, v104, v105
  v_cvt_pk_bf16_f32 v59, v106, v107
  buffer_store_dwordx4 v[52:55], v2, s[8:11], s29 offen offset:0 sc1
  buffer_store_dwordx4 v[56:59], v2, s[8:11], s29 offen offset:512 sc1
  v_cvt_pk_bf16_f32 v60, v108, v109
  v_cvt_pk_bf16_f32 v61, v110, v111
  v_cvt_pk_bf16_f32 v62, v112, v113
  v_cvt_pk_bf16_f32 v63, v114, v115
  v_cvt_pk_bf16_f32 v64, v116, v117
  v_cvt_pk_bf16_f32 v65, v118, v119
  v_cvt_pk_bf16_f32 v66, v120, v121
  v_cvt_pk_bf16_f32 v67, v122, v123
  buffer_store_dwordx4 v[60:63], v3, s[8:11], s30 offen offset:0 sc1
  buffer_store_dwordx4 v[64:67], v3, s[8:11], s30 offen offset:512 sc1
  s_lshl_b32 s27, s20, 5
  s_add_u32 s27, s27, s5
  s_lshl_b32 s27, s27, 6
  s_add_u32 s27, s27, s21
  s_lshl_b32 s27, s27, 2
  s_add_u32 s91, s27, 270336
  s_mov_b32 s21, s23
  s_cmp_lt_u32 s21, s88
  s_cbranch_scc1 W_kvl
  s_waitcnt vmcnt(0)
  s_barrier
  s_cmp_eq_u32 s32, 0
  s_cbranch_scc1 L_fp_202
  s_cmp_eq_u32 s4, 0
  s_cbranch_scc0 L_fp_202_z
  v_mov_b32 v14, 1
  s_mov_b64 exec, 1
  buffer_store_dword v14, v1, s[8:11], s32 offen sc1
  s_mov_b64 exec, -1
L_fp_202_z:
  s_mov_b32 s32, 0
L_fp_202:
  s_mov_b32 s32, s91
  s_cmp_eq_u32 s32, 0
  s_cbranch_scc1 L_fp_203
  s_cmp_eq_u32 s4, 0
  s_cbranch_scc0 L_fp_203_z
  v_mov_b32 v14, 1
  s_mov_b64 exec, 1
  buffer_store_dword v14, v1, s[8:11], s32 offen sc1
  s_mov_b64 exec, -1
L_fp_203_z:
  s_mov_b32 s32, 0
L_fp_203:
  s_mov_b32 s22, 1
  s_cmp_eq_u32 s88, 7
  s_cselect_b32 s88, 14, 64
  s_cmp_lt_u32 s21, 64
  s_cbranch_scc0 W_Ad
  s_cmp_eq_u32 s20, 0
  s_cbranch_scc0 W_idft
  s_mov_b32 s88, 64
  s_branch W_kv
W_Ad:
  s_cmp_eq_u32 s20, 0
  s_cbranch_scc0 W_q2
  v_lshrrev_b32 v116, 4, v1
  v_lshrrev_b32 v117, 4, v116
  v_and_b32 v118, 15, v116
  v_lshlrev_b32 v120, 2, v117
  v_xor_b32 v118, v118, v120
  v_lshlrev_b32 v119, 13, v117
  v_lshl_add_u32 v119, v118, 4, v119
  s_lshl_b32 s27, s5, 8
  s_lshl_b32 s28, s4, 17
  s_add_u32 s27, s27, s28
  v_add_u32 v119, s27, v119
  v_lshlrev_b32 v120, 10, v117
  v_lshrrev_b32 v117, 2, v118
  v_lshl_add_u32 v120, v117, 8, v120
  v_and_b32 v117, 3, v118
  v_lshl_add_u32 v120, v117, 4, v120
  s_lshl_b32 s27, s5, 17
  s_lshl_b32 s28, s4, 14
  s_add_u32 s27, s27, s28
  v_add_u32 v120, s27, v120
  v_bfe_u32 v117, v116, 5, 1
  v_lshlrev_b32 v121, 11, v117
  v_bfe_u32 v117, v116, 2, 2
  v_lshl_add_u32 v121, v117, 8, v121
  v_xor_b32 v117, s4, v117
  v_lshl_add_u32 v121, v117, 6, v121
  v_bfe_u32 v117, v116, 4, 1
  v_lshl_add_u32 v121, v117, 5, v121
  v_and_b32 v117, 1, v116
  v_lshl_add_u32 v121, v117, 4, v121
  v_bfe_u32 v117, v116, 1, 1
  v_lshl_add_u32 v121, v117, 3, v121
  v_add_u32 v121, 32768, v121
  v_add_u32 v122, 0x10000, v121
  s_lshl_b32 s29, s4, 12
  s_add_u32 s23, s29, 32768
  s_barrier
  s_add_u32 m0, s23, 0
  s_mov_b32 s28, 0
  buffer_load_dwordx4 v120, s[84:87], s28 offen lds
  s_add_u32 m0, s23, 1024
  s_mov_b32 s28, 4096
  buffer_load_dwordx4 v120, s[84:87], s28 offen lds
  s_add_u32 m0, s23, 2048
  s_mov_b32 s28, 8192
  buffer_load_dwordx4 v120, s[84:87], s28 offen lds
  s_add_u32 m0, s23, 3072
  s_mov_b32 s28, 12288
  buffer_load_dwordx4 v120, s[84:87], s28 offen lds
  s_waitcnt vmcnt(0)
  s_barrier
  s_add_u32 m0, s23, 16384
  s_mov_b32 s28, 65536
  buffer_load_dwordx4 v120, s[84:87], s28 offen lds
  s_add_u32 m0, s23, 17408
  s_mov_b32 s28, 69632
  buffer_load_dwordx4 v120, s[84:87], s28 offen lds
  s_add_u32 m0, s23, 18432
  s_mov_b32 s28, 73728
  buffer_load_dwordx4 v120, s[84:87], s28 offen lds
  s_add_u32 m0, s23, 19456
  s_mov_b32 s28, 77824
  buffer_load_dwordx4 v120, s[84:87], s28 offen lds
  ds_read_b64_tr_b16 v[128:129], v121 offset:0
  ds_read_b64_tr_b16 v[130:131], v121 offset:1024
  ds_read_b64_tr_b16 v[132:133], v121 offset:4096
  ds_read_b64_tr_b16 v[134:135], v121 offset:5120
  ds_read_b64_tr_b16 v[136:137], v121 offset:8192
  ds_read_b64_tr_b16 v[138:139], v121 offset:9216
  ds_read_b64_tr_b16 v[140:141], v121 offset:12288
  ds_read_b64_tr_b16 v[142:143], v121 offset:13312
  s_waitcnt lgkmcnt(0)
  s_waitcnt vmcnt(0)
  s_barrier
  s_add_u32 m0, s23, 32768
  s_mov_b32 s28, 64
  buffer_load_dwordx4 v120, s[84:87], s28 offen lds
  s_add_u32 m0, s23, 33792
  s_mov_b32 s28, 4160
  buffer_load_dwordx4 v120, s[84:87], s28 offen lds
  s_add_u32 m0, s23, 34816
  s_mov_b32 s28, 8256
  buffer_load_dwordx4 v120, s[84:87], s28 offen lds
  s_add_u32 m0, s23, 35840
  s_mov_b32 s28, 12352
  buffer_load_dwordx4 v120, s[84:87], s28 offen lds
  ds_read_b64_tr_b16 v[144:145], v121 offset:16384
  ds_read_b64_tr_b16 v[146:147], v121 offset:17408
  ds_read_b64_tr_b16 v[148:149], v121 offset:20480
  ds_read_b64_tr_b16 v[150:151], v121 offset:21504
  ds_read_b64_tr_b16 v[152:153], v121 offset:24576
  ds_read_b64_tr_b16 v[154:155], v121 offset:25600
  ds_read_b64_tr_b16 v[156:157], v121 offset:28672
  ds_read_b64_tr_b16 v[158:159], v121 offset:29696
  s_waitcnt lgkmcnt(0)
  s_waitcnt vmcnt(0)
  s_barrier
  s_add_u32 m0, s23, 49152
  s_mov_b32 s28, 65600
  buffer_load_dwordx4 v120, s[84:87], s28 offen lds
  s_add_u32 m0, s23, 50176
  s_mov_b32 s28, 69696
  buffer_load_dwordx4 v120, s[84:87], s28 offen lds
  s_add_u32 m0, s23, 51200
  s_mov_b32 s28, 73792
  buffer_load_dwordx4 v120, s[84:87], s28 offen lds
  s_add_u32 m0, s23, 52224
  s_mov_b32 s28, 77888
  buffer_load_dwordx4 v120, s[84:87], s28 offen lds
  ds_read_b64_tr_b16 v[160:161], v121 offset:32768
  ds_read_b64_tr_b16 v[162:163], v121 offset:33792
  ds_read_b64_tr_b16 v[164:165], v121 offset:36864
  ds_read_b64_tr_b16 v[166:167], v121 offset:37888
  ds_read_b64_tr_b16 v[168:169], v121 offset:40960
  ds_read_b64_tr_b16 v[170:171], v121 offset:41984
  ds_read_b64_tr_b16 v[172:173], v121 offset:45056
  ds_read_b64_tr_b16 v[174:175], v121 offset:46080
  s_waitcnt lgkmcnt(0)
  s_waitcnt vmcnt(0)
  s_barrier
  s_add_u32 m0, s23, 65536
  s_mov_b32 s28, 128
  buffer_load_dwordx4 v120, s[84:87], s28 offen lds
  s_add_u32 m0, s23, 66560
  s_mov_b32 s28, 4224
  buffer_load_dwordx4 v120, s[84:87], s28 offen lds
  s_add_u32 m0, s23, 67584
  s_mov_b32 s28, 8320
  buffer_load_dwordx4 v120, s[84:87], s28 offen lds
  s_add_u32 m0, s23, 68608
  s_mov_b32 s28, 12416
  buffer_load_dwordx4 v120, s[84:87], s28 offen lds
  ds_read_b64_tr_b16 v[176:177], v121 offset:49152
  ds_read_b64_tr_b16 v[178:179], v121 offset:50176
  ds_read_b64_tr_b16 v[180:181], v121 offset:53248
  ds_read_b64_tr_b16 v[182:183], v121 offset:54272
  ds_read_b64_tr_b16 v[184:185], v121 offset:57344
  ds_read_b64_tr_b16 v[186:187], v121 offset:58368
  ds_read_b64_tr_b16 v[188:189], v121 offset:61440
  ds_read_b64_tr_b16 v[190:191], v121 offset:62464
  s_waitcnt lgkmcnt(0)
  s_waitcnt vmcnt(0)
  s_barrier
  s_add_u32 m0, s23, 81920
  s_mov_b32 s28, 65664
  buffer_load_dwordx4 v120, s[84:87], s28 offen lds
  s_add_u32 m0, s23, 82944
  s_mov_b32 s28, 69760
  buffer_load_dwordx4 v120, s[84:87], s28 offen lds
  s_add_u32 m0, s23, 83968
  s_mov_b32 s28, 73856
  buffer_load_dwordx4 v120, s[84:87], s28 offen lds
  s_add_u32 m0, s23, 84992
  s_mov_b32 s28, 77952
  buffer_load_dwordx4 v120, s[84:87], s28 offen lds
  ds_read_b64_tr_b16 v[192:193], v122 offset:0
  ds_read_b64_tr_b16 v[194:195], v122 offset:1024
  ds_read_b64_tr_b16 v[196:197], v122 offset:4096
  ds_read_b64_tr_b16 v[198:199], v122 offset:5120
  ds_read_b64_tr_b16 v[200:201], v122 offset:8192
  ds_read_b64_tr_b16 v[202:203], v122 offset:9216
  ds_read_b64_tr_b16 v[204:205], v122 offset:12288
  ds_read_b64_tr_b16 v[206:207], v122 offset:13312
  s_waitcnt lgkmcnt(0)
  s_waitcnt vmcnt(0)
  s_barrier
  s_add_u32 m0, s23, 98304
  s_mov_b32 s28, 192
  buffer_load_dwordx4 v120, s[84:87], s28 offen lds
  s_add_u32 m0, s23, 99328
  s_mov_b32 s28, 4288
  buffer_load_dwordx4 v120, s[84:87], s28 offen lds
  s_add_u32 m0, s23, 100352
  s_mov_b32 s28, 8384
  buffer_load_dwordx4 v120, s[84:87], s28 offen lds
  s_add_u32 m0, s23, 101376
  s_mov_b32 s28, 12480
  buffer_load_dwordx4 v120, s[84:87], s28 offen lds
  ds_read_b64_tr_b16 v[208:209], v122 offset:16384
  ds_read_b64_tr_b16 v[210:211], v122 offset:17408
  ds_read_b64_tr_b16 v[212:213], v122 offset:20480
  ds_read_b64_tr_b16 v[214:215], v122 offset:21504
  ds_read_b64_tr_b16 v[216:217], v122 offset:24576
  ds_read_b64_tr_b16 v[218:219], v122 offset:25600
  ds_read_b64_tr_b16 v[220:221], v122 offset:28672
  ds_read_b64_tr_b16 v[222:223], v122 offset:29696
  s_waitcnt lgkmcnt(0)
  s_waitcnt vmcnt(0)
  s_barrier
  s_add_u32 m0, s23, 114688
  s_mov_b32 s28, 65728
  buffer_load_dwordx4 v120, s[84:87], s28 offen lds
  s_add_u32 m0, s23, 115712
  s_mov_b32 s28, 69824
  buffer_load_dwordx4 v120, s[84:87], s28 offen lds
  s_add_u32 m0, s23, 116736
  s_mov_b32 s28, 73920
  buffer_load_dwordx4 v120, s[84:87], s28 offen lds
  s_add_u32 m0, s23, 117760
  s_mov_b32 s28, 78016
  buffer_load_dwordx4 v120, s[84:87], s28 offen lds
  ds_read_b64_tr_b16 v[224:225], v122 offset:32768
  ds_read_b64_tr_b16 v[226:227], v122 offset:33792
  ds_read_b64_tr_b16 v[228:229], v122 offset:36864
  ds_read_b64_tr_b16 v[230:231], v122 offset:37888
  ds_read_b64_tr_b16 v[232:233], v122 offset:40960
  ds_read_b64_tr_b16 v[234:235], v122 offset:41984
  ds_read_b64_tr_b16 v[236:237], v122 offset:45056
  ds_read_b64_tr_b16 v[238:239], v122 offset:46080
  s_waitcnt lgkmcnt(0)
  s_waitcnt vmcnt(0)
  s_barrier
  ds_read_b64_tr_b16 v[240:241], v122 offset:49152
  ds_read_b64_tr_b16 v[242:243], v122 offset:50176
  ds_read_b64_tr_b16 v[244:245], v122 offset:53248
  ds_read_b64_tr_b16 v[246:247], v122 offset:54272
  ds_read_b64_tr_b16 v[248:249], v122 offset:57344
  ds_read_b64_tr_b16 v[250:251], v122 offset:58368
  ds_read_b64_tr_b16 v[252:253], v122 offset:61440
  ds_read_b64_tr_b16 v[254:255], v122 offset:62464
  s_waitcnt lgkmcnt(0)
  s_lshl_b32 s30, s34, 2
  s_add_u32 s30, s30, s4
  s_mul_i32 s30, s30, 36864
  s_add_u32 s30, s30, 118489088
  v_lshrrev_b32 v20, 8, v1
  v_bfe_u32 v21, v1, 4, 4
  s_lshl_b32 s27, s4, 4
  v_add_u32 v22, s27, v21
  s_mov_b32 s36, 0x3b000000
  s_lshl_b32 s27, s5, 3
  v_lshrrev_b32 v23, 1, v21
  v_add_u32 v23, s27, v23
  v_cmp_eq_u32 vcc, 0, v23
  v_mov_b32 v25, 0x100
  s_nop 0
  v_cndmask_b32 v23, v23, v25, vcc
  v_and_b32 v22, 1, v21
  v_cvt_f32_u32 v22, v22
  v_mul_f32 v22, 0x3e800000, v22
  s_lshl_b32 s27, s4, 7
  s_add_u32 s27, s27, 0
  v_lshl_add_u32 v24, v20, 3, s27
  v_mul_lo_u32 v25, v24, v23
  v_and_b32 v26, 511, v25
  v_cvt_f32_u32 v26, v26
  v_fma_f32 v26, v26, s36, v22
  v_cos_f32 v26, v26
  v_add_u32 v25, v25, v23
  v_and_b32 v27, 511, v25
  v_cvt_f32_u32 v27, v27
  v_fma_f32 v27, v27, s36, v22
  v_cos_f32 v27, v27
  v_add_u32 v25, v25, v23
  v_cvt_pk_bf16_f32 v28, v26, v27
  v_and_b32 v26, 511, v25
  v_cvt_f32_u32 v26, v26
  v_fma_f32 v26, v26, s36, v22
  v_cos_f32 v26, v26
  v_add_u32 v25, v25, v23
  v_and_b32 v27, 511, v25
  v_cvt_f32_u32 v27, v27
  v_fma_f32 v27, v27, s36, v22
  v_cos_f32 v27, v27
  v_add_u32 v25, v25, v23
  v_cvt_pk_bf16_f32 v29, v26, v27
  v_and_b32 v26, 511, v25
  v_cvt_f32_u32 v26, v26
  v_fma_f32 v26, v26, s36, v22
  v_cos_f32 v26, v26
  v_add_u32 v25, v25, v23
  v_and_b32 v27, 511, v25
  v_cvt_f32_u32 v27, v27
  v_fma_f32 v27, v27, s36, v22
  v_cos_f32 v27, v27
  v_add_u32 v25, v25, v23
  v_cvt_pk_bf16_f32 v30, v26, v27
  v_and_b32 v26, 511, v25
  v_cvt_f32_u32 v26, v26
  v_fma_f32 v26, v26, s36, v22
  v_cos_f32 v26, v26
  v_add_u32 v25, v25, v23
  v_and_b32 v27, 511, v25
  v_cvt_f32_u32 v27, v27
  v_fma_f32 v27, v27, s36, v22
  v_cos_f32 v27, v27
  v_add_u32 v25, v25, v23
  v_cvt_pk_bf16_f32 v31, v26, v27
  s_lshl_b32 s27, s4, 7
  s_add_u32 s27, s27, 32
  v_lshl_add_u32 v24, v20, 3, s27
  v_mul_lo_u32 v25, v24, v23
  v_and_b32 v26, 511, v25
  v_cvt_f32_u32 v26, v26
  v_fma_f32 v26, v26, s36, v22
  v_cos_f32 v26, v26
  v_add_u32 v25, v25, v23
  v_and_b32 v27, 511, v25
  v_cvt_f32_u32 v27, v27
  v_fma_f32 v27, v27, s36, v22
  v_cos_f32 v27, v27
  v_add_u32 v25, v25, v23
  v_cvt_pk_bf16_f32 v32, v26, v27
  v_and_b32 v26, 511, v25
  v_cvt_f32_u32 v26, v26
  v_fma_f32 v26, v26, s36, v22
  v_cos_f32 v26, v26
  v_add_u32 v25, v25, v23
  v_and_b32 v27, 511, v25
  v_cvt_f32_u32 v27, v27
  v_fma_f32 v27, v27, s36, v22
  v_cos_f32 v27, v27
  v_add_u32 v25, v25, v23
  v_cvt_pk_bf16_f32 v33, v26, v27
  v_and_b32 v26, 511, v25
  v_cvt_f32_u32 v26, v26
  v_fma_f32 v26, v26, s36, v22
  v_cos_f32 v26, v26
  v_add_u32 v25, v25, v23
  v_and_b32 v27, 511, v25
  v_cvt_f32_u32 v27, v27
  v_fma_f32 v27, v27, s36, v22
  v_cos_f32 v27, v27
  v_add_u32 v25, v25, v23
  v_cvt_pk_bf16_f32 v34, v26, v27
  v_and_b32 v26, 511, v25
  v_cvt_f32_u32 v26, v26
  v_fma_f32 v26, v26, s36, v22
  v_cos_f32 v26, v26
  v_add_u32 v25, v25, v23
  v_and_b32 v27, 511, v25
  v_cvt_f32_u32 v27, v27
  v_fma_f32 v27, v27, s36, v22
  v_cos_f32 v27, v27
  v_add_u32 v25, v25, v23
  v_cvt_pk_bf16_f32 v35, v26, v27
  s_lshl_b32 s27, s4, 7
  s_add_u32 s27, s27, 64
  v_lshl_add_u32 v24, v20, 3, s27
  v_mul_lo_u32 v25, v24, v23
  v_and_b32 v26, 511, v25
  v_cvt_f32_u32 v26, v26
  v_fma_f32 v26, v26, s36, v22
  v_cos_f32 v26, v26
  v_add_u32 v25, v25, v23
  v_and_b32 v27, 511, v25
  v_cvt_f32_u32 v27, v27
  v_fma_f32 v27, v27, s36, v22
  v_cos_f32 v27, v27
  v_add_u32 v25, v25, v23
  v_cvt_pk_bf16_f32 v36, v26, v27
  v_and_b32 v26, 511, v25
  v_cvt_f32_u32 v26, v26
  v_fma_f32 v26, v26, s36, v22
  v_cos_f32 v26, v26
  v_add_u32 v25, v25, v23
  v_and_b32 v27, 511, v25
  v_cvt_f32_u32 v27, v27
  v_fma_f32 v27, v27, s36, v22
  v_cos_f32 v27, v27
  v_add_u32 v25, v25, v23
  v_cvt_pk_bf16_f32 v37, v26, v27
  v_and_b32 v26, 511, v25
  v_cvt_f32_u32 v26, v26
  v_fma_f32 v26, v26, s36, v22
  v_cos_f32 v26, v26
  v_add_u32 v25, v25, v23
  v_and_b32 v27, 511, v25
  v_cvt_f32_u32 v27, v27
  v_fma_f32 v27, v27, s36, v22
  v_cos_f32 v27, v27
  v_add_u32 v25, v25, v23
  v_cvt_pk_bf16_f32 v38, v26, v27
  v_and_b32 v26, 511, v25
  v_cvt_f32_u32 v26, v26
  v_fma_f32 v26, v26, s36, v22
  v_cos_f32 v26, v26
  v_add_u32 v25, v25, v23
  v_and_b32 v27, 511, v25
  v_cvt_f32_u32 v27, v27
  v_fma_f32 v27, v27, s36, v22
  v_cos_f32 v27, v27
  v_add_u32 v25, v25, v23
  v_cvt_pk_bf16_f32 v39, v26, v27
  s_lshl_b32 s27, s4, 7
  s_add_u32 s27, s27, 96
  v_lshl_add_u32 v24, v20, 3, s27
  v_mul_lo_u32 v25, v24, v23
  v_and_b32 v26, 511, v25
  v_cvt_f32_u32 v26, v26
  v_fma_f32 v26, v26, s36, v22
  v_cos_f32 v26, v26
  v_add_u32 v25, v25, v23
  v_and_b32 v27, 511, v25
  v_cvt_f32_u32 v27, v27
  v_fma_f32 v27, v27, s36, v22
  v_cos_f32 v27, v27
  v_add_u32 v25, v25, v23
  v_cvt_pk_bf16_f32 v40, v26, v27
  v_and_b32 v26, 511, v25
  v_cvt_f32_u32 v26, v26
  v_fma_f32 v26, v26, s36, v22
  v_cos_f32 v26, v26
  v_add_u32 v25, v25, v23
  v_and_b32 v27, 511, v25
  v_cvt_f32_u32 v27, v27
  v_fma_f32 v27, v27, s36, v22
  v_cos_f32 v27, v27
  v_add_u32 v25, v25, v23
  v_cvt_pk_bf16_f32 v41, v26, v27
  v_and_b32 v26, 511, v25
  v_cvt_f32_u32 v26, v26
  v_fma_f32 v26, v26, s36, v22
  v_cos_f32 v26, v26
  v_add_u32 v25, v25, v23
  v_and_b32 v27, 511, v25
  v_cvt_f32_u32 v27, v27
  v_fma_f32 v27, v27, s36, v22
  v_cos_f32 v27, v27
  v_add_u32 v25, v25, v23
  v_cvt_pk_bf16_f32 v42, v26, v27
  v_and_b32 v26, 511, v25
  v_cvt_f32_u32 v26, v26
  v_fma_f32 v26, v26, s36, v22
  v_cos_f32 v26, v26
  v_add_u32 v25, v25, v23
  v_and_b32 v27, 511, v25
  v_cvt_f32_u32 v27, v27
  v_fma_f32 v27, v27, s36, v22
  v_cos_f32 v27, v27
  v_add_u32 v25, v25, v23
  v_cvt_pk_bf16_f32 v43, v26, v27
  s_add_u32 s27, s30, 32768
  buffer_store_dwordx4 v[28:31], v1, s[8:11], s27 offen sc1
  s_add_u32 s27, s30, 33792
  buffer_store_dwordx4 v[32:35], v1, s[8:11], s27 offen sc1
  s_add_u32 s27, s30, 34816
  buffer_store_dwordx4 v[36:39], v1, s[8:11], s27 offen sc1
  s_add_u32 s27, s30, 35840
  buffer_store_dwordx4 v[40:43], v1, s[8:11], s27 offen sc1
  s_nop 1
W_q2:
  v_mov_b32 v20, -1
  v_mov_b32 v21, -1
  v_mov_b32 v22, -1
  v_mov_b32 v23, -1
  v_lshrrev_b32 v24, 6, v1
  v_lshlrev_b32 v24, 15, v24
  v_and_b32 v25, 0x30, v1
  v_add_u32 v24, v24, v25
  s_and_b32 s27, s4, 1
  s_lshl_b32 s27, s27, 20
  s_lshr_b32 s28, s4, 1
  s_lshl_b32 s28, s28, 6
  s_add_u32 s27, s27, s28
  s_lshl_b32 s28, s20, 21
  s_add_u32 s27, s27, s28
  s_add_u32 s27, s27, 99614720
  s_lshl_b32 s28, s34, 7
  s_add_u32 s28, s28, s27
  buffer_store_dwordx4 v[20:23], v24, s[8:11], s28 offen sc1
  s_add_u32 s28, s28, 524288
  buffer_store_dwordx4 v[20:23], v24, s[8:11], s28 offen sc1
  s_cmp_eq_u32 s25, 2
  s_cbranch_scc0 W_cf
  s_lshl_b32 s28, s35, 7
  s_add_u32 s28, s28, s27
  buffer_store_dwordx4 v[20:23], v24, s[8:11], s28 offen sc1
  s_add_u32 s28, s28, 524288
  buffer_store_dwordx4 v[20:23], v24, s[8:11], s28 offen sc1
W_cf:
  s_cmp_eq_u32 s4, 0
  s_cbranch_scc0 W_cg
  v_lshrrev_b32 v24, 6, v1
  v_lshlrev_b32 v24, 12, v24
  v_add_u32 v24, v24, v25
  s_cmp_eq_u32 s6, 0
  s_cselect_b32 s28, 7, s6
  s_add_u32 s28, s28, 56
  s_lshl_b32 s28, s28, 6
  s_lshl_b32 s27, s20, 5
  s_add_u32 s27, s27, s5
  s_lshl_b32 s27, s27, 16
  s_add_u32 s27, s27, s28
  s_add_u32 s27, s27, 163577856
  buffer_store_dwordx4 v[20:23], v24, s[8:11], s27 offen sc1
W_cg:
  s_load_dwordx2 s[72:73], s[0:1], 16
  s_nop 0
  v_lshrrev_b32 v20, 4, v1
  v_lshrrev_b32 v21, 4, v20
  v_and_b32 v22, 15, v20
  v_lshlrev_b32 v23, 2, v21
  v_xor_b32 v22, v22, v23
  v_lshlrev_b32 v23, 13, v21
  v_lshl_add_u32 v23, v22, 4, v23
  s_lshl_b32 s27, s5, 8
  s_lshl_b32 s28, s4, 17
  s_add_u32 s27, s27, s28
  v_add_u32 v23, s27, v23
  s_lshl_b32 s29, s4, 12
  s_add_u32 s29, s29, 32768
  s_waitcnt lgkmcnt(0)
  s_mov_b32 s74, 0x400000
  s_mov_b32 s75, 0x20000
  s_barrier
  s_add_u32 m0, s29, 0
  s_mov_b32 s28, 0
  buffer_load_dwordx4 v23, s[72:75], s28 offen lds
  s_add_u32 m0, s29, 1024
  s_mov_b32 s28, 32768
  buffer_load_dwordx4 v23, s[72:75], s28 offen lds
  s_add_u32 m0, s29, 2048
  s_mov_b32 s28, 65536
  buffer_load_dwordx4 v23, s[72:75], s28 offen lds
  s_add_u32 m0, s29, 3072
  s_mov_b32 s28, 98304
  buffer_load_dwordx4 v23, s[72:75], s28 offen lds
  s_waitcnt vmcnt(0)
  s_add_u32 m0, s29, 16384
  s_mov_b32 s28, 524288
  buffer_load_dwordx4 v23, s[72:75], s28 offen lds
  s_add_u32 m0, s29, 17408
  s_mov_b32 s28, 557056
  buffer_load_dwordx4 v23, s[72:75], s28 offen lds
  s_add_u32 m0, s29, 18432
  s_mov_b32 s28, 589824
  buffer_load_dwordx4 v23, s[72:75], s28 offen lds
  s_add_u32 m0, s29, 19456
  s_mov_b32 s28, 622592
  buffer_load_dwordx4 v23, s[72:75], s28 offen lds
  s_waitcnt vmcnt(0)
  s_add_u32 m0, s29, 32768
  s_mov_b32 s28, 1048576
  buffer_load_dwordx4 v23, s[72:75], s28 offen lds
  s_add_u32 m0, s29, 33792
  s_mov_b32 s28, 1081344
  buffer_load_dwordx4 v23, s[72:75], s28 offen lds
  s_add_u32 m0, s29, 34816
  s_mov_b32 s28, 1114112
  buffer_load_dwordx4 v23, s[72:75], s28 offen lds
  s_add_u32 m0, s29, 35840
  s_mov_b32 s28, 1146880
  buffer_load_dwordx4 v23, s[72:75], s28 offen lds
  s_waitcnt vmcnt(0)
  s_add_u32 m0, s29, 49152
  s_mov_b32 s28, 1572864
  buffer_load_dwordx4 v23, s[72:75], s28 offen lds
  s_add_u32 m0, s29, 50176
  s_mov_b32 s28, 1605632
  buffer_load_dwordx4 v23, s[72:75], s28 offen lds
  s_add_u32 m0, s29, 51200
  s_mov_b32 s28, 1638400
  buffer_load_dwordx4 v23, s[72:75], s28 offen lds
  s_add_u32 m0, s29, 52224
  s_mov_b32 s28, 1671168
  buffer_load_dwordx4 v23, s[72:75], s28 offen lds
  s_waitcnt vmcnt(0)
  s_add_u32 m0, s29, 65536
  s_mov_b32 s28, 2097152
  buffer_load_dwordx4 v23, s[72:75], s28 offen lds
  s_add_u32 m0, s29, 66560
  s_mov_b32 s28, 2129920
  buffer_load_dwordx4 v23, s[72:75], s28 offen lds
  s_add_u32 m0, s29, 67584
  s_mov_b32 s28, 2162688
  buffer_load_dwordx4 v23, s[72:75], s28 offen lds
  s_add_u32 m0, s29, 68608
  s_mov_b32 s28, 2195456
  buffer_load_dwordx4 v23, s[72:75], s28 offen lds
  s_waitcnt vmcnt(0)
  s_add_u32 m0, s29, 81920
  s_mov_b32 s28, 2621440
  buffer_load_dwordx4 v23, s[72:75], s28 offen lds
  s_add_u32 m0, s29, 82944
  s_mov_b32 s28, 2654208
  buffer_load_dwordx4 v23, s[72:75], s28 offen lds
  s_add_u32 m0, s29, 83968
  s_mov_b32 s28, 2686976
  buffer_load_dwordx4 v23, s[72:75], s28 offen lds
  s_add_u32 m0, s29, 84992
  s_mov_b32 s28, 2719744
  buffer_load_dwordx4 v23, s[72:75], s28 offen lds
  s_waitcnt vmcnt(0)
  s_add_u32 m0, s29, 98304
  s_mov_b32 s28, 3145728
  buffer_load_dwordx4 v23, s[72:75], s28 offen lds
  s_add_u32 m0, s29, 99328
  s_mov_b32 s28, 3178496
  buffer_load_dwordx4 v23, s[72:75], s28 offen lds
  s_add_u32 m0, s29, 100352
  s_mov_b32 s28, 3211264
  buffer_load_dwordx4 v23, s[72:75], s28 offen lds
  s_add_u32 m0, s29, 101376
  s_mov_b32 s28, 3244032
  buffer_load_dwordx4 v23, s[72:75], s28 offen lds
  s_waitcnt vmcnt(0)
  s_add_u32 m0, s29, 114688
  s_mov_b32 s28, 3670016
  buffer_load_dwordx4 v23, s[72:75], s28 offen lds
  s_add_u32 m0, s29, 115712
  s_mov_b32 s28, 3702784
  buffer_load_dwordx4 v23, s[72:75], s28 offen lds
  s_add_u32 m0, s29, 116736
  s_mov_b32 s28, 3735552
  buffer_load_dwordx4 v23, s[72:75], s28 offen lds
  s_add_u32 m0, s29, 117760
  s_mov_b32 s28, 3768320
  buffer_load_dwordx4 v23, s[72:75], s28 offen lds
  s_mov_b32 s21, s6
  s_mov_b32 s24, s6
  s_mov_b32 s22, s6
  s_cmp_eq_u32 s20, 0
  s_cselect_b32 s26, 43, 43
W_C:
  s_cmp_ge_u32 s21, 57
  s_cbranch_scc1 W_Cd
  s_cmp_lt_u32 s21, s26
  s_cbranch_scc1 W_C0
W_Cd:
  s_cmp_lt_u32 s21, 64
  s_cbranch_scc1 W_Ce
  s_cmp_lt_u32 s22, s24
  s_cbranch_scc1 W_dftd
W_Ce:
  s_cmp_lt_u32 s24, s21
  s_cbranch_scc1 W_row
  s_add_u32 s27, s22, 7
  s_sub_u32 s28, s21, 57
  s_cmp_lt_u32 s28, 0
  s_cselect_b32 s27, s27, s22
  s_cmp_lt_u32 s27, s24
  s_cbranch_scc1 W_dftd
  s_cmp_lt_u32 s21, 64
  s_cbranch_scc0 W_Cend
W_C0:
  s_cmp_eq_u32 s20, 0
  s_cbranch_scc0 W_C1
  s_sub_u32 s27, s21, 21
  s_cmp_lt_u32 s27, 7
  s_cbranch_scc0 W_tb1
  s_lshl_b32 s30, s34, 2
  s_add_u32 s30, s30, s4
  s_mul_i32 s30, s30, 36864
  s_add_u32 s30, s30, 118489088
  v_lshrrev_b32 v20, 8, v1
  v_bfe_u32 v21, v1, 4, 4
  s_lshl_b32 s27, s4, 4
  v_add_u32 v22, s27, v21
  s_cmp_eq_u32 s5, 0
  s_cbranch_scc0 L_g1_204
  s_mov_b32 s36, 0x3d000000
  v_add_u32 v23, 0, v21
  v_lshlrev_b32 v24, 3, v20
  v_mul_lo_u32 v25, v23, v24
  v_and_b32 v26, 31, v25
  v_cvt_f32_u32 v26, v26
  v_mul_f32 v26, s36, v26
  v_sin_f32 v27, v26
  v_cos_f32 v26, v26
  v_add_u32 v25, v25, v23
  v_and_b32 v58, 31, v25
  v_cvt_f32_u32 v58, v58
  v_mul_f32 v58, s36, v58
  v_sin_f32 v59, v58
  v_cos_f32 v58, v58
  v_add_u32 v25, v25, v23
  v_cvt_pk_bf16_f32 v28, v26, v58
  v_cvt_pk_bf16_f32 v36, v27, v59
  v_cvt_pk_bf16_f32 v44, -v27, -v59
  v_and_b32 v26, 31, v25
  v_cvt_f32_u32 v26, v26
  v_mul_f32 v26, s36, v26
  v_sin_f32 v27, v26
  v_cos_f32 v26, v26
  v_add_u32 v25, v25, v23
  v_and_b32 v58, 31, v25
  v_cvt_f32_u32 v58, v58
  v_mul_f32 v58, s36, v58
  v_sin_f32 v59, v58
  v_cos_f32 v58, v58
  v_add_u32 v25, v25, v23
  v_cvt_pk_bf16_f32 v29, v26, v58
  v_cvt_pk_bf16_f32 v37, v27, v59
  v_cvt_pk_bf16_f32 v45, -v27, -v59
  v_and_b32 v26, 31, v25
  v_cvt_f32_u32 v26, v26
  v_mul_f32 v26, s36, v26
  v_sin_f32 v27, v26
  v_cos_f32 v26, v26
  v_add_u32 v25, v25, v23
  v_and_b32 v58, 31, v25
  v_cvt_f32_u32 v58, v58
  v_mul_f32 v58, s36, v58
  v_sin_f32 v59, v58
  v_cos_f32 v58, v58
  v_add_u32 v25, v25, v23
  v_cvt_pk_bf16_f32 v30, v26, v58
  v_cvt_pk_bf16_f32 v38, v27, v59
  v_cvt_pk_bf16_f32 v46, -v27, -v59
  v_and_b32 v26, 31, v25
  v_cvt_f32_u32 v26, v26
  v_mul_f32 v26, s36, v26
  v_sin_f32 v27, v26
  v_cos_f32 v26, v26
  v_add_u32 v25, v25, v23
  v_and_b32 v58, 31, v25
  v_cvt_f32_u32 v58, v58
  v_mul_f32 v58, s36, v58
  v_sin_f32 v59, v58
  v_cos_f32 v58, v58
  v_add_u32 v25, v25, v23
  v_cvt_pk_bf16_f32 v31, v26, v58
  v_cvt_pk_bf16_f32 v39, v27, v59
  v_cvt_pk_bf16_f32 v47, -v27, -v59
  v_add_u32 v23, 16, v21
  v_lshlrev_b32 v24, 3, v20
  v_mul_lo_u32 v25, v23, v24
  v_and_b32 v26, 31, v25
  v_cvt_f32_u32 v26, v26
  v_mul_f32 v26, s36, v26
  v_sin_f32 v27, v26
  v_cos_f32 v26, v26
  v_add_u32 v25, v25, v23
  v_and_b32 v58, 31, v25
  v_cvt_f32_u32 v58, v58
  v_mul_f32 v58, s36, v58
  v_sin_f32 v59, v58
  v_cos_f32 v58, v58
  v_add_u32 v25, v25, v23
  v_cvt_pk_bf16_f32 v32, v26, v58
  v_cvt_pk_bf16_f32 v40, v27, v59
  v_cvt_pk_bf16_f32 v48, -v27, -v59
  v_and_b32 v26, 31, v25
  v_cvt_f32_u32 v26, v26
  v_mul_f32 v26, s36, v26
  v_sin_f32 v27, v26
  v_cos_f32 v26, v26
  v_add_u32 v25, v25, v23
  v_and_b32 v58, 31, v25
  v_cvt_f32_u32 v58, v58
  v_mul_f32 v58, s36, v58
  v_sin_f32 v59, v58
  v_cos_f32 v58, v58
  v_add_u32 v25, v25, v23
  v_cvt_pk_bf16_f32 v33, v26, v58
  v_cvt_pk_bf16_f32 v41, v27, v59
  v_cvt_pk_bf16_f32 v49, -v27, -v59
  v_and_b32 v26, 31, v25
  v_cvt_f32_u32 v26, v26
  v_mul_f32 v26, s36, v26
  v_sin_f32 v27, v26
  v_cos_f32 v26, v26
  v_add_u32 v25, v25, v23
  v_and_b32 v58, 31, v25
  v_cvt_f32_u32 v58, v58
  v_mul_f32 v58, s36, v58
  v_sin_f32 v59, v58
  v_cos_f32 v58, v58
  v_add_u32 v25, v25, v23
  v_cvt_pk_bf16_f32 v34, v26, v58
  v_cvt_pk_bf16_f32 v42, v27, v59
  v_cvt_pk_bf16_f32 v50, -v27, -v59
  v_and_b32 v26, 31, v25
  v_cvt_f32_u32 v26, v26
  v_mul_f32 v26, s36, v26
  v_sin_f32 v27, v26
  v_cos_f32 v26, v26
  v_add_u32 v25, v25, v23
  v_and_b32 v58, 31, v25
  v_cvt_f32_u32 v58, v58
  v_mul_f32 v58, s36, v58
  v_sin_f32 v59, v58
  v_cos_f32 v58, v58
  v_add_u32 v25, v25, v23
  v_cvt_pk_bf16_f32 v35, v26, v58
  v_cvt_pk_bf16_f32 v43, v27, v59
  v_cvt_pk_bf16_f32 v51, -v27, -v59
  s_add_u32 s27, s30, 0
  buffer_store_dwordx4 v[28:31], v1, s[8:11], s27 offen sc1
  s_add_u32 s27, s30, 1024
  buffer_store_dwordx4 v[32:35], v1, s[8:11], s27 offen sc1
  s_add_u32 s27, s30, 2048
  buffer_store_dwordx4 v[36:39], v1, s[8:11], s27 offen sc1
  s_add_u32 s27, s30, 3072
  buffer_store_dwordx4 v[40:43], v1, s[8:11], s27 offen sc1
  s_add_u32 s27, s30, 4096
  buffer_store_dwordx4 v[44:47], v1, s[8:11], s27 offen sc1
  s_add_u32 s27, s30, 5120
  buffer_store_dwordx4 v[48:51], v1, s[8:11], s27 offen sc1
  s_nop 1
  s_mov_b32 s36, 0x3c800000
  v_lshlrev_b32 v24, 2, v20
  v_add_u32 v24, 0, v24
  v_mul_lo_u32 v25, v22, v24
  v_and_b32 v26, 63, v25
  v_cvt_f32_u32 v26, v26
  v_mul_f32 v26, s36, v26
  v_sin_f32 v27, v26
  v_cos_f32 v26, v26
  v_add_u32 v25, v25, v22
  v_and_b32 v58, 63, v25
  v_cvt_f32_u32 v58, v58
  v_mul_f32 v58, s36, v58
  v_sin_f32 v59, v58
  v_cos_f32 v58, v58
  v_add_u32 v25, v25, v22
  v_cvt_pk_bf16_f32 v28, v26, v58
  v_cvt_pk_bf16_f32 v36, v27, v59
  v_cvt_pk_bf16_f32 v44, -v27, -v59
  v_and_b32 v26, 63, v25
  v_cvt_f32_u32 v26, v26
  v_mul_f32 v26, s36, v26
  v_sin_f32 v27, v26
  v_cos_f32 v26, v26
  v_add_u32 v25, v25, v22
  v_and_b32 v58, 63, v25
  v_cvt_f32_u32 v58, v58
  v_mul_f32 v58, s36, v58
  v_sin_f32 v59, v58
  v_cos_f32 v58, v58
  v_add_u32 v25, v25, v22
  v_cvt_pk_bf16_f32 v29, v26, v58
  v_cvt_pk_bf16_f32 v37, v27, v59
  v_cvt_pk_bf16_f32 v45, -v27, -v59
  v_lshlrev_b32 v24, 2, v20
  v_add_u32 v24, 16, v24
  v_mul_lo_u32 v25, v22, v24
  v_and_b32 v26, 63, v25
  v_cvt_f32_u32 v26, v26
  v_mul_f32 v26, s36, v26
  v_sin_f32 v27, v26
  v_cos_f32 v26, v26
  v_add_u32 v25, v25, v22
  v_and_b32 v58, 63, v25
  v_cvt_f32_u32 v58, v58
  v_mul_f32 v58, s36, v58
  v_sin_f32 v59, v58
  v_cos_f32 v58, v58
  v_add_u32 v25, v25, v22
  v_cvt_pk_bf16_f32 v30, v26, v58
  v_cvt_pk_bf16_f32 v38, v27, v59
  v_cvt_pk_bf16_f32 v46, -v27, -v59
  v_and_b32 v26, 63, v25
  v_cvt_f32_u32 v26, v26
  v_mul_f32 v26, s36, v26
  v_sin_f32 v27, v26
  v_cos_f32 v26, v26
  v_add_u32 v25, v25, v22
  v_and_b32 v58, 63, v25
  v_cvt_f32_u32 v58, v58
  v_mul_f32 v58, s36, v58
  v_sin_f32 v59, v58
  v_cos_f32 v58, v58
  v_add_u32 v25, v25, v22
  v_cvt_pk_bf16_f32 v31, v26, v58
  v_cvt_pk_bf16_f32 v39, v27, v59
  v_cvt_pk_bf16_f32 v47, -v27, -v59
  v_lshlrev_b32 v24, 2, v20
  v_add_u32 v24, 32, v24
  v_mul_lo_u32 v25, v22, v24
  v_and_b32 v26, 63, v25
  v_cvt_f32_u32 v26, v26
  v_mul_f32 v26, s36, v26
  v_sin_f32 v27, v26
  v_cos_f32 v26, v26
  v_add_u32 v25, v25, v22
  v_and_b32 v58, 63, v25
  v_cvt_f32_u32 v58, v58
  v_mul_f32 v58, s36, v58
  v_sin_f32 v59, v58
  v_cos_f32 v58, v58
  v_add_u32 v25, v25, v22
  v_cvt_pk_bf16_f32 v32, v26, v58
  v_cvt_pk_bf16_f32 v40, v27, v59
  v_cvt_pk_bf16_f32 v48, -v27, -v59
  v_and_b32 v26, 63, v25
  v_cvt_f32_u32 v26, v26
  v_mul_f32 v26, s36, v26
  v_sin_f32 v27, v26
  v_cos_f32 v26, v26
  v_add_u32 v25, v25, v22
  v_and_b32 v58, 63, v25
  v_cvt_f32_u32 v58, v58
  v_mul_f32 v58, s36, v58
  v_sin_f32 v59, v58
  v_cos_f32 v58, v58
  v_add_u32 v25, v25, v22
  v_cvt_pk_bf16_f32 v33, v26, v58
  v_cvt_pk_bf16_f32 v41, v27, v59
  v_cvt_pk_bf16_f32 v49, -v27, -v59
  v_lshlrev_b32 v24, 2, v20
  v_add_u32 v24, 48, v24
  v_mul_lo_u32 v25, v22, v24
  v_and_b32 v26, 63, v25
  v_cvt_f32_u32 v26, v26
  v_mul_f32 v26, s36, v26
  v_sin_f32 v27, v26
  v_cos_f32 v26, v26
  v_add_u32 v25, v25, v22
  v_and_b32 v58, 63, v25
  v_cvt_f32_u32 v58, v58
  v_mul_f32 v58, s36, v58
  v_sin_f32 v59, v58
  v_cos_f32 v58, v58
  v_add_u32 v25, v25, v22
  v_cvt_pk_bf16_f32 v34, v26, v58
  v_cvt_pk_bf16_f32 v42, v27, v59
  v_cvt_pk_bf16_f32 v50, -v27, -v59
  v_and_b32 v26, 63, v25
  v_cvt_f32_u32 v26, v26
  v_mul_f32 v26, s36, v26
  v_sin_f32 v27, v26
  v_cos_f32 v26, v26
  v_add_u32 v25, v25, v22
  v_and_b32 v58, 63, v25
  v_cvt_f32_u32 v58, v58
  v_mul_f32 v58, s36, v58
  v_sin_f32 v59, v58
  v_cos_f32 v58, v58
  v_add_u32 v25, v25, v22
  v_cvt_pk_bf16_f32 v35, v26, v58
  v_cvt_pk_bf16_f32 v43, v27, v59
  v_cvt_pk_bf16_f32 v51, -v27, -v59
  s_add_u32 s27, s30, 6144
  buffer_store_dwordx4 v[28:31], v1, s[8:11], s27 offen sc1
  s_add_u32 s27, s30, 7168
  buffer_store_dwordx4 v[32:35], v1, s[8:11], s27 offen sc1
  s_add_u32 s27, s30, 8192
  buffer_store_dwordx4 v[36:39], v1, s[8:11], s27 offen sc1
  s_add_u32 s27, s30, 9216
  buffer_store_dwordx4 v[40:43], v1, s[8:11], s27 offen sc1
  s_add_u32 s27, s30, 10240
  buffer_store_dwordx4 v[44:47], v1, s[8:11], s27 offen sc1
  s_add_u32 s27, s30, 11264
  buffer_store_dwordx4 v[48:51], v1, s[8:11], s27 offen sc1
  s_nop 1
  s_mov_b32 s36, 0x3a000000
  v_lshlrev_b32 v24, 2, v20
  v_add_u32 v24, 0, v24
  v_mul_lo_u32 v25, v24, v22
  v_and_b32 v28, 2047, v25
  v_cvt_f32_u32 v28, v28
  v_mul_f32 v28, s36, v28
  v_sin_f32 v36, v28
  v_cos_f32 v28, v28
  v_add_u32 v25, v25, v22
  v_and_b32 v29, 2047, v25
  v_cvt_f32_u32 v29, v29
  v_mul_f32 v29, s36, v29
  v_sin_f32 v37, v29
  v_cos_f32 v29, v29
  v_add_u32 v25, v25, v22
  v_and_b32 v30, 2047, v25
  v_cvt_f32_u32 v30, v30
  v_mul_f32 v30, s36, v30
  v_sin_f32 v38, v30
  v_cos_f32 v30, v30
  v_add_u32 v25, v25, v22
  v_and_b32 v31, 2047, v25
  v_cvt_f32_u32 v31, v31
  v_mul_f32 v31, s36, v31
  v_sin_f32 v39, v31
  v_cos_f32 v31, v31
  v_add_u32 v25, v25, v22
  v_lshlrev_b32 v24, 2, v20
  v_add_u32 v24, 16, v24
  v_mul_lo_u32 v25, v24, v22
  v_and_b32 v32, 2047, v25
  v_cvt_f32_u32 v32, v32
  v_mul_f32 v32, s36, v32
  v_sin_f32 v40, v32
  v_cos_f32 v32, v32
  v_add_u32 v25, v25, v22
  v_and_b32 v33, 2047, v25
  v_cvt_f32_u32 v33, v33
  v_mul_f32 v33, s36, v33
  v_sin_f32 v41, v33
  v_cos_f32 v33, v33
  v_add_u32 v25, v25, v22
  v_and_b32 v34, 2047, v25
  v_cvt_f32_u32 v34, v34
  v_mul_f32 v34, s36, v34
  v_sin_f32 v42, v34
  v_cos_f32 v34, v34
  v_add_u32 v25, v25, v22
  v_and_b32 v35, 2047, v25
  v_cvt_f32_u32 v35, v35
  v_mul_f32 v35, s36, v35
  v_sin_f32 v43, v35
  v_cos_f32 v35, v35
  v_add_u32 v25, v25, v22
  v_add_u32 v23, 0, v21
  v_lshlrev_b32 v24, 2, v20
  s_lshl_b32 s27, s4, 4
  v_add_u32 v24, s27, v24
  v_mul_lo_u32 v25, v24, v23
  v_and_b32 v44, 2047, v25
  v_cvt_f32_u32 v44, v44
  v_mul_f32 v44, s36, v44
  v_sin_f32 v52, v44
  v_cos_f32 v44, v44
  v_add_u32 v25, v25, v23
  v_and_b32 v45, 2047, v25
  v_cvt_f32_u32 v45, v45
  v_mul_f32 v45, s36, v45
  v_sin_f32 v53, v45
  v_cos_f32 v45, v45
  v_add_u32 v25, v25, v23
  v_and_b32 v46, 2047, v25
  v_cvt_f32_u32 v46, v46
  v_mul_f32 v46, s36, v46
  v_sin_f32 v54, v46
  v_cos_f32 v46, v46
  v_add_u32 v25, v25, v23
  v_and_b32 v47, 2047, v25
  v_cvt_f32_u32 v47, v47
  v_mul_f32 v47, s36, v47
  v_sin_f32 v55, v47
  v_cos_f32 v47, v47
  v_add_u32 v25, v25, v23
  v_add_u32 v23, 16, v21
  v_lshlrev_b32 v24, 2, v20
  s_lshl_b32 s27, s4, 4
  v_add_u32 v24, s27, v24
  v_mul_lo_u32 v25, v24, v23
  v_and_b32 v48, 2047, v25
  v_cvt_f32_u32 v48, v48
  v_mul_f32 v48, s36, v48
  v_sin_f32 v56, v48
  v_cos_f32 v48, v48
  v_add_u32 v25, v25, v23
  v_and_b32 v49, 2047, v25
  v_cvt_f32_u32 v49, v49
  v_mul_f32 v49, s36, v49
  v_sin_f32 v57, v49
  v_cos_f32 v49, v49
  v_add_u32 v25, v25, v23
  v_and_b32 v50, 2047, v25
  v_cvt_f32_u32 v50, v50
  v_mul_f32 v50, s36, v50
  v_sin_f32 v58, v50
  v_cos_f32 v50, v50
  v_add_u32 v25, v25, v23
  v_and_b32 v51, 2047, v25
  v_cvt_f32_u32 v51, v51
  v_mul_f32 v51, s36, v51
  v_sin_f32 v59, v51
  v_cos_f32 v51, v51
  v_add_u32 v25, v25, v23
  s_add_u32 s27, s30, 12288
  buffer_store_dwordx4 v[28:31], v1, s[8:11], s27 offen sc1
  s_add_u32 s27, s30, 13312
  buffer_store_dwordx4 v[32:35], v1, s[8:11], s27 offen sc1
  s_add_u32 s27, s30, 14336
  buffer_store_dwordx4 v[36:39], v1, s[8:11], s27 offen sc1
  s_add_u32 s27, s30, 15360
  buffer_store_dwordx4 v[40:43], v1, s[8:11], s27 offen sc1
  s_add_u32 s27, s30, 16384
  buffer_store_dwordx4 v[44:47], v1, s[8:11], s27 offen sc1
  s_add_u32 s27, s30, 17408
  buffer_store_dwordx4 v[48:51], v1, s[8:11], s27 offen sc1
  s_add_u32 s27, s30, 18432
  buffer_store_dwordx4 v[52:55], v1, s[8:11], s27 offen sc1
  s_add_u32 s27, s30, 19456
  buffer_store_dwordx4 v[56:59], v1, s[8:11], s27 offen sc1
  s_nop 1
L_g1_204:
  s_branch W_C1
W_tb1:
  s_sub_u32 s27, s21, 28
  s_cmp_lt_u32 s27, 7
  s_cbranch_scc0 W_tb2
  s_lshl_b32 s30, s34, 2
  s_add_u32 s30, s30, s4
  s_mul_i32 s30, s30, 36864
  s_add_u32 s30, s30, 118489088
  v_lshrrev_b32 v20, 8, v1
  v_bfe_u32 v21, v1, 4, 4
  s_lshl_b32 s27, s4, 4
  v_add_u32 v22, s27, v21
  s_mov_b32 s36, 0x3b000000
  s_lshl_b32 s27, s5, 4
  v_add_u32 v23, s27, v21
  s_lshl_b32 s27, s4, 6
  s_add_u32 s27, s27, 0
  v_lshl_add_u32 v24, v20, 2, s27
  v_cmp_eq_u32 vcc, 0, v24
  v_mov_b32 v25, 0x100
  s_nop 0
  v_cndmask_b32 v24, v24, v25, vcc
  v_mul_lo_u32 v25, v24, v23
  v_and_b32 v26, 511, v25
  v_cvt_f32_u32 v26, v26
  v_mul_f32 v26, s36, v26
  v_sin_f32 v27, v26
  v_cos_f32 v26, v26
  s_nop 0
  v_cvt_pk_bf16_f32 v28, v26, -v27
  s_lshl_b32 s27, s4, 6
  s_add_u32 s27, s27, 1
  v_lshl_add_u32 v24, v20, 2, s27
  v_mul_lo_u32 v25, v24, v23
  v_and_b32 v26, 511, v25
  v_cvt_f32_u32 v26, v26
  v_mul_f32 v26, s36, v26
  v_sin_f32 v27, v26
  v_cos_f32 v26, v26
  s_nop 0
  v_cvt_pk_bf16_f32 v29, v26, -v27
  s_lshl_b32 s27, s4, 6
  s_add_u32 s27, s27, 2
  v_lshl_add_u32 v24, v20, 2, s27
  v_mul_lo_u32 v25, v24, v23
  v_and_b32 v26, 511, v25
  v_cvt_f32_u32 v26, v26
  v_mul_f32 v26, s36, v26
  v_sin_f32 v27, v26
  v_cos_f32 v26, v26
  s_nop 0
  v_cvt_pk_bf16_f32 v30, v26, -v27
  s_lshl_b32 s27, s4, 6
  s_add_u32 s27, s27, 3
  v_lshl_add_u32 v24, v20, 2, s27
  v_mul_lo_u32 v25, v24, v23
  v_and_b32 v26, 511, v25
  v_cvt_f32_u32 v26, v26
  v_mul_f32 v26, s36, v26
  v_sin_f32 v27, v26
  v_cos_f32 v26, v26
  s_nop 0
  v_cvt_pk_bf16_f32 v31, v26, -v27
  s_lshl_b32 s27, s4, 6
  s_add_u32 s27, s27, 16
  v_lshl_add_u32 v24, v20, 2, s27
  v_mul_lo_u32 v25, v24, v23
  v_and_b32 v26, 511, v25
  v_cvt_f32_u32 v26, v26
  v_mul_f32 v26, s36, v26
  v_sin_f32 v27, v26
  v_cos_f32 v26, v26
  s_nop 0
  v_cvt_pk_bf16_f32 v32, v26, -v27
  s_lshl_b32 s27, s4, 6
  s_add_u32 s27, s27, 17
  v_lshl_add_u32 v24, v20, 2, s27
  v_mul_lo_u32 v25, v24, v23
  v_and_b32 v26, 511, v25
  v_cvt_f32_u32 v26, v26
  v_mul_f32 v26, s36, v26
  v_sin_f32 v27, v26
  v_cos_f32 v26, v26
  s_nop 0
  v_cvt_pk_bf16_f32 v33, v26, -v27
  s_lshl_b32 s27, s4, 6
  s_add_u32 s27, s27, 18
  v_lshl_add_u32 v24, v20, 2, s27
  v_mul_lo_u32 v25, v24, v23
  v_and_b32 v26, 511, v25
  v_cvt_f32_u32 v26, v26
  v_mul_f32 v26, s36, v26
  v_sin_f32 v27, v26
  v_cos_f32 v26, v26
  s_nop 0
  v_cvt_pk_bf16_f32 v34, v26, -v27
  s_lshl_b32 s27, s4, 6
  s_add_u32 s27, s27, 19
  v_lshl_add_u32 v24, v20, 2, s27
  v_mul_lo_u32 v25, v24, v23
  v_and_b32 v26, 511, v25
  v_cvt_f32_u32 v26, v26
  v_mul_f32 v26, s36, v26
  v_sin_f32 v27, v26
  v_cos_f32 v26, v26
  s_nop 0
  v_cvt_pk_bf16_f32 v35, v26, -v27
  s_lshl_b32 s27, s4, 6
  s_add_u32 s27, s27, 32
  v_lshl_add_u32 v24, v20, 2, s27
  v_mul_lo_u32 v25, v24, v23
  v_and_b32 v26, 511, v25
  v_cvt_f32_u32 v26, v26
  v_mul_f32 v26, s36, v26
  v_sin_f32 v27, v26
  v_cos_f32 v26, v26
  s_nop 0
  v_cvt_pk_bf16_f32 v36, v26, -v27
  s_lshl_b32 s27, s4, 6
  s_add_u32 s27, s27, 33
  v_lshl_add_u32 v24, v20, 2, s27
  v_mul_lo_u32 v25, v24, v23
  v_and_b32 v26, 511, v25
  v_cvt_f32_u32 v26, v26
  v_mul_f32 v26, s36, v26
  v_sin_f32 v27, v26
  v_cos_f32 v26, v26
  s_nop 0
  v_cvt_pk_bf16_f32 v37, v26, -v27
  s_lshl_b32 s27, s4, 6
  s_add_u32 s27, s27, 34
  v_lshl_add_u32 v24, v20, 2, s27
  v_mul_lo_u32 v25, v24, v23
  v_and_b32 v26, 511, v25
  v_cvt_f32_u32 v26, v26
  v_mul_f32 v26, s36, v26
  v_sin_f32 v27, v26
  v_cos_f32 v26, v26
  s_nop 0
  v_cvt_pk_bf16_f32 v38, v26, -v27
  s_lshl_b32 s27, s4, 6
  s_add_u32 s27, s27, 35
  v_lshl_add_u32 v24, v20, 2, s27
  v_mul_lo_u32 v25, v24, v23
  v_and_b32 v26, 511, v25
  v_cvt_f32_u32 v26, v26
  v_mul_f32 v26, s36, v26
  v_sin_f32 v27, v26
  v_cos_f32 v26, v26
  s_nop 0
  v_cvt_pk_bf16_f32 v39, v26, -v27
  s_lshl_b32 s27, s4, 6
  s_add_u32 s27, s27, 48
  v_lshl_add_u32 v24, v20, 2, s27
  v_mul_lo_u32 v25, v24, v23
  v_and_b32 v26, 511, v25
  v_cvt_f32_u32 v26, v26
  v_mul_f32 v26, s36, v26
  v_sin_f32 v27, v26
  v_cos_f32 v26, v26
  s_nop 0
  v_cvt_pk_bf16_f32 v40, v26, -v27
  s_lshl_b32 s27, s4, 6
  s_add_u32 s27, s27, 49
  v_lshl_add_u32 v24, v20, 2, s27
  v_mul_lo_u32 v25, v24, v23
  v_and_b32 v26, 511, v25
  v_cvt_f32_u32 v26, v26
  v_mul_f32 v26, s36, v26
  v_sin_f32 v27, v26
  v_cos_f32 v26, v26
  s_nop 0
  v_cvt_pk_bf16_f32 v41, v26, -v27
  s_lshl_b32 s27, s4, 6
  s_add_u32 s27, s27, 50
  v_lshl_add_u32 v24, v20, 2, s27
  v_mul_lo_u32 v25, v24, v23
  v_and_b32 v26, 511, v25
  v_cvt_f32_u32 v26, v26
  v_mul_f32 v26, s36, v26
  v_sin_f32 v27, v26
  v_cos_f32 v26, v26
  s_nop 0
  v_cvt_pk_bf16_f32 v42, v26, -v27
  s_lshl_b32 s27, s4, 6
  s_add_u32 s27, s27, 51
  v_lshl_add_u32 v24, v20, 2, s27
  v_mul_lo_u32 v25, v24, v23
  v_and_b32 v26, 511, v25
  v_cvt_f32_u32 v26, v26
  v_mul_f32 v26, s36, v26
  v_sin_f32 v27, v26
  v_cos_f32 v26, v26
  s_nop 0
  v_cvt_pk_bf16_f32 v43, v26, -v27
  s_add_u32 s27, s30, 28672
  buffer_store_dwordx4 v[28:31], v1, s[8:11], s27 offen sc1
  s_add_u32 s27, s30, 29696
  buffer_store_dwordx4 v[32:35], v1, s[8:11], s27 offen sc1
  s_add_u32 s27, s30, 30720
  buffer_store_dwordx4 v[36:39], v1, s[8:11], s27 offen sc1
  s_add_u32 s27, s30, 31744
  buffer_store_dwordx4 v[40:43], v1, s[8:11], s27 offen sc1
  s_nop 1
  s_branch W_C1
W_tb2:
  s_sub_u32 s27, s21, 35
  s_cmp_lt_u32 s27, 7
  s_cbranch_scc0 W_tb3
  s_lshl_b32 s30, s34, 2
  s_add_u32 s30, s30, s4
  s_mul_i32 s30, s30, 36864
  s_add_u32 s30, s30, 118489088
  v_lshrrev_b32 v20, 8, v1
  v_bfe_u32 v21, v1, 4, 4
  s_lshl_b32 s27, s4, 4
  v_add_u32 v22, s27, v21
  s_load_dwordx2 s[72:73], s[0:1], 64
  s_load_dwordx2 s[76:77], s[0:1], 72
  s_waitcnt lgkmcnt(0)
  s_mov_b32 s74, 1052672
  s_mov_b32 s75, 0x20000
  s_mov_b32 s78, 1052672
  s_mov_b32 s79, 0x20000
  v_lshl_add_u32 v25, v20, 7, v21
  v_mul_u32_u24 v25, 514, v25
  s_cmp_eq_u32 s34, 0
  s_cselect_b32 s28, 0x100, s34
  s_cselect_b32 s37, 0x35800000, 0
  s_cmp_eq_u32 s37, 0
  s_cselect_b32 s37, 0x36000000, s37
  s_lshl_b32 s28, s28, 1
  s_mul_i32 s29, s4, 263168
  s_add_u32 s28, s28, s29
  s_add_u32 s29, s28, 0
  v_add_u32 v52, s29, v25
  v_and_b32 v44, -4, v52
  buffer_load_dword v28, v44, s[72:75], 0 offen
  buffer_load_dword v36, v44, s[76:79], 0 offen
  v_and_b32 v52, 2, v52
  v_lshlrev_b32 v52, 3, v52
  s_add_u32 s29, s28, 16448
  v_add_u32 v53, s29, v25
  v_and_b32 v45, -4, v53
  buffer_load_dword v29, v45, s[72:75], 0 offen
  buffer_load_dword v37, v45, s[76:79], 0 offen
  v_and_b32 v53, 2, v53
  v_lshlrev_b32 v53, 3, v53
  s_add_u32 s29, s28, 32896
  v_add_u32 v54, s29, v25
  v_and_b32 v46, -4, v54
  buffer_load_dword v30, v46, s[72:75], 0 offen
  buffer_load_dword v38, v46, s[76:79], 0 offen
  v_and_b32 v54, 2, v54
  v_lshlrev_b32 v54, 3, v54
  s_add_u32 s29, s28, 49344
  v_add_u32 v55, s29, v25
  v_and_b32 v47, -4, v55
  buffer_load_dword v31, v47, s[72:75], 0 offen
  buffer_load_dword v39, v47, s[76:79], 0 offen
  v_and_b32 v55, 2, v55
  v_lshlrev_b32 v55, 3, v55
  s_add_u32 s29, s28, 8224
  v_add_u32 v56, s29, v25
  v_and_b32 v48, -4, v56
  buffer_load_dword v32, v48, s[72:75], 0 offen
  buffer_load_dword v40, v48, s[76:79], 0 offen
  v_and_b32 v56, 2, v56
  v_lshlrev_b32 v56, 3, v56
  s_add_u32 s29, s28, 24672
  v_add_u32 v57, s29, v25
  v_and_b32 v49, -4, v57
  buffer_load_dword v33, v49, s[72:75], 0 offen
  buffer_load_dword v41, v49, s[76:79], 0 offen
  v_and_b32 v57, 2, v57
  v_lshlrev_b32 v57, 3, v57
  s_add_u32 s29, s28, 41120
  v_add_u32 v58, s29, v25
  v_and_b32 v50, -4, v58
  buffer_load_dword v34, v50, s[72:75], 0 offen
  buffer_load_dword v42, v50, s[76:79], 0 offen
  v_and_b32 v58, 2, v58
  v_lshlrev_b32 v58, 3, v58
  s_add_u32 s29, s28, 57568
  v_add_u32 v59, s29, v25
  v_and_b32 v51, -4, v59
  buffer_load_dword v35, v51, s[72:75], 0 offen
  buffer_load_dword v43, v51, s[76:79], 0 offen
  v_and_b32 v59, 2, v59
  v_lshlrev_b32 v59, 3, v59
  s_waitcnt vmcnt(0)
  v_lshrrev_b32 v28, v52, v28
  v_lshlrev_b32 v28, 16, v28
  v_mul_f32 v28, s37, v28
  v_lshrrev_b32 v29, v53, v29
  v_lshlrev_b32 v29, 16, v29
  v_mul_f32 v29, s37, v29
  v_lshrrev_b32 v30, v54, v30
  v_lshlrev_b32 v30, 16, v30
  v_mul_f32 v30, s37, v30
  v_lshrrev_b32 v31, v55, v31
  v_lshlrev_b32 v31, 16, v31
  v_mul_f32 v31, s37, v31
  v_lshrrev_b32 v32, v56, v32
  v_lshlrev_b32 v32, 16, v32
  v_mul_f32 v32, s37, v32
  v_lshrrev_b32 v33, v57, v33
  v_lshlrev_b32 v33, 16, v33
  v_mul_f32 v33, s37, v33
  v_lshrrev_b32 v34, v58, v34
  v_lshlrev_b32 v34, 16, v34
  v_mul_f32 v34, s37, v34
  v_lshrrev_b32 v35, v59, v35
  v_lshlrev_b32 v35, 16, v35
  v_mul_f32 v35, s37, v35
  v_lshrrev_b32 v36, v52, v36
  v_lshlrev_b32 v36, 16, v36
  v_mul_f32 v36, s37, v36
  v_lshrrev_b32 v37, v53, v37
  v_lshlrev_b32 v37, 16, v37
  v_mul_f32 v37, s37, v37
  v_lshrrev_b32 v38, v54, v38
  v_lshlrev_b32 v38, 16, v38
  v_mul_f32 v38, s37, v38
  v_lshrrev_b32 v39, v55, v39
  v_lshlrev_b32 v39, 16, v39
  v_mul_f32 v39, s37, v39
  v_lshrrev_b32 v40, v56, v40
  v_lshlrev_b32 v40, 16, v40
  v_mul_f32 v40, s37, v40
  v_lshrrev_b32 v41, v57, v41
  v_lshlrev_b32 v41, 16, v41
  v_mul_f32 v41, s37, v41
  v_lshrrev_b32 v42, v58, v42
  v_lshlrev_b32 v42, 16, v42
  v_mul_f32 v42, s37, v42
  v_lshrrev_b32 v43, v59, v43
  v_lshlrev_b32 v43, 16, v43
  v_mul_f32 v43, s37, v43
  s_add_u32 s27, s30, 20480
  buffer_store_dwordx4 v[28:31], v1, s[8:11], s27 offen sc1
  s_add_u32 s27, s30, 21504
  buffer_store_dwordx4 v[32:35], v1, s[8:11], s27 offen sc1
  s_add_u32 s27, s30, 22528
  buffer_store_dwordx4 v[36:39], v1, s[8:11], s27 offen sc1
  s_add_u32 s27, s30, 23552
  buffer_store_dwordx4 v[40:43], v1, s[8:11], s27 offen sc1
  s_nop 1
L_gs_205:
  s_branch W_C1
W_tb3:
  s_sub_u32 s27, s21, 42
  s_cmp_lt_u32 s27, 7
  s_cbranch_scc0 W_tb4
  s_lshl_b32 s30, s34, 2
  s_add_u32 s30, s30, s4
  s_mul_i32 s30, s30, 36864
  s_add_u32 s30, s30, 118489088
  v_lshrrev_b32 v20, 8, v1
  v_bfe_u32 v21, v1, 4, 4
  s_lshl_b32 s27, s4, 4
  v_add_u32 v22, s27, v21
  s_load_dwordx2 s[72:73], s[0:1], 64
  s_load_dwordx2 s[76:77], s[0:1], 72
  s_waitcnt lgkmcnt(0)
  s_mov_b32 s74, 1052672
  s_mov_b32 s75, 0x20000
  s_mov_b32 s78, 1052672
  s_mov_b32 s79, 0x20000
  v_lshl_add_u32 v25, v20, 7, v21
  v_mul_u32_u24 v25, 514, v25
  s_cmp_eq_u32 s25, 2
  s_cbranch_scc0 L_gs_206
  s_cmp_eq_u32 s35, 0
  s_cselect_b32 s28, 0x100, s35
  s_cselect_b32 s37, 0x35800000, 0
  s_cmp_eq_u32 s37, 0
  s_cselect_b32 s37, 0x36000000, s37
  s_lshl_b32 s28, s28, 1
  s_mul_i32 s29, s4, 263168
  s_add_u32 s28, s28, s29
  s_add_u32 s29, s28, 0
  v_add_u32 v52, s29, v25
  v_and_b32 v44, -4, v52
  buffer_load_dword v28, v44, s[72:75], 0 offen
  buffer_load_dword v36, v44, s[76:79], 0 offen
  v_and_b32 v52, 2, v52
  v_lshlrev_b32 v52, 3, v52
  s_add_u32 s29, s28, 16448
  v_add_u32 v53, s29, v25
  v_and_b32 v45, -4, v53
  buffer_load_dword v29, v45, s[72:75], 0 offen
  buffer_load_dword v37, v45, s[76:79], 0 offen
  v_and_b32 v53, 2, v53
  v_lshlrev_b32 v53, 3, v53
  s_add_u32 s29, s28, 32896
  v_add_u32 v54, s29, v25
  v_and_b32 v46, -4, v54
  buffer_load_dword v30, v46, s[72:75], 0 offen
  buffer_load_dword v38, v46, s[76:79], 0 offen
  v_and_b32 v54, 2, v54
  v_lshlrev_b32 v54, 3, v54
  s_add_u32 s29, s28, 49344
  v_add_u32 v55, s29, v25
  v_and_b32 v47, -4, v55
  buffer_load_dword v31, v47, s[72:75], 0 offen
  buffer_load_dword v39, v47, s[76:79], 0 offen
  v_and_b32 v55, 2, v55
  v_lshlrev_b32 v55, 3, v55
  s_add_u32 s29, s28, 8224
  v_add_u32 v56, s29, v25
  v_and_b32 v48, -4, v56
  buffer_load_dword v32, v48, s[72:75], 0 offen
  buffer_load_dword v40, v48, s[76:79], 0 offen
  v_and_b32 v56, 2, v56
  v_lshlrev_b32 v56, 3, v56
  s_add_u32 s29, s28, 24672
  v_add_u32 v57, s29, v25
  v_and_b32 v49, -4, v57
  buffer_load_dword v33, v49, s[72:75], 0 offen
  buffer_load_dword v41, v49, s[76:79], 0 offen
  v_and_b32 v57, 2, v57
  v_lshlrev_b32 v57, 3, v57
  s_add_u32 s29, s28, 41120
  v_add_u32 v58, s29, v25
  v_and_b32 v50, -4, v58
  buffer_load_dword v34, v50, s[72:75], 0 offen
  buffer_load_dword v42, v50, s[76:79], 0 offen
  v_and_b32 v58, 2, v58
  v_lshlrev_b32 v58, 3, v58
  s_add_u32 s29, s28, 57568
  v_add_u32 v59, s29, v25
  v_and_b32 v51, -4, v59
  buffer_load_dword v35, v51, s[72:75], 0 offen
  buffer_load_dword v43, v51, s[76:79], 0 offen
  v_and_b32 v59, 2, v59
  v_lshlrev_b32 v59, 3, v59
  s_waitcnt vmcnt(0)
  v_lshrrev_b32 v28, v52, v28
  v_lshlrev_b32 v28, 16, v28
  v_mul_f32 v28, s37, v28
  v_lshrrev_b32 v29, v53, v29
  v_lshlrev_b32 v29, 16, v29
  v_mul_f32 v29, s37, v29
  v_lshrrev_b32 v30, v54, v30
  v_lshlrev_b32 v30, 16, v30
  v_mul_f32 v30, s37, v30
  v_lshrrev_b32 v31, v55, v31
  v_lshlrev_b32 v31, 16, v31
  v_mul_f32 v31, s37, v31
  v_lshrrev_b32 v32, v56, v32
  v_lshlrev_b32 v32, 16, v32
  v_mul_f32 v32, s37, v32
  v_lshrrev_b32 v33, v57, v33
  v_lshlrev_b32 v33, 16, v33
  v_mul_f32 v33, s37, v33
  v_lshrrev_b32 v34, v58, v34
  v_lshlrev_b32 v34, 16, v34
  v_mul_f32 v34, s37, v34
  v_lshrrev_b32 v35, v59, v35
  v_lshlrev_b32 v35, 16, v35
  v_mul_f32 v35, s37, v35
  v_lshrrev_b32 v36, v52, v36
  v_lshlrev_b32 v36, 16, v36
  v_mul_f32 v36, s37, v36
  v_lshrrev_b32 v37, v53, v37
  v_lshlrev_b32 v37, 16, v37
  v_mul_f32 v37, s37, v37
  v_lshrrev_b32 v38, v54, v38
  v_lshlrev_b32 v38, 16, v38
  v_mul_f32 v38, s37, v38
  v_lshrrev_b32 v39, v55, v39
  v_lshlrev_b32 v39, 16, v39
  v_mul_f32 v39, s37, v39
  v_lshrrev_b32 v40, v56, v40
  v_lshlrev_b32 v40, 16, v40
  v_mul_f32 v40, s37, v40
  v_lshrrev_b32 v41, v57, v41
  v_lshlrev_b32 v41, 16, v41
  v_mul_f32 v41, s37, v41
  v_lshrrev_b32 v42, v58, v42
  v_lshlrev_b32 v42, 16, v42
  v_mul_f32 v42, s37, v42
  v_lshrrev_b32 v43, v59, v43
  v_lshlrev_b32 v43, 16, v43
  v_mul_f32 v43, s37, v43
  s_add_u32 s27, s30, 24576
  buffer_store_dwordx4 v[28:31], v1, s[8:11], s27 offen sc1
  s_add_u32 s27, s30, 25600
  buffer_store_dwordx4 v[32:35], v1, s[8:11], s27 offen sc1
  s_add_u32 s27, s30, 26624
  buffer_store_dwordx4 v[36:39], v1, s[8:11], s27 offen sc1
  s_add_u32 s27, s30, 27648
  buffer_store_dwordx4 v[40:43], v1, s[8:11], s27 offen sc1
  s_nop 1
L_gs_206:
  s_branch W_C1
W_tb4:
W_C1:
  s_lshl_b32 s28, s4, 13
  s_lshl_b32 s27, s20, 6
  s_add_u32 s27, s27, s21
  s_lshl_b32 s27, s27, 15
  s_add_u32 s27, s27, 84934656
  s_lshl_b32 s29, s4, 13
  s_add_u32 s27, s27, s29
  s_add_u32 m0, s28, 0
  s_nop 0
  buffer_load_dwordx4 v1, s[8:11], s27 offen offset:0 sc1 lds
  buffer_load_dwordx4 v1, s[8:11], s27 offen offset:1024 sc1 lds
  buffer_load_dwordx4 v1, s[8:11], s27 offen offset:2048 sc1 lds
  buffer_load_dwordx4 v1, s[8:11], s27 offen offset:3072 sc1 lds
  s_add_u32 m0, s28, 4096
  s_add_u32 s27, s27, 4096
  buffer_load_dwordx4 v1, s[8:11], s27 offen offset:0 sc1 lds
  buffer_load_dwordx4 v1, s[8:11], s27 offen offset:1024 sc1 lds
  buffer_load_dwordx4 v1, s[8:11], s27 offen offset:2048 sc1 lds
  buffer_load_dwordx4 v1, s[8:11], s27 offen offset:3072 sc1 lds
  s_lshl_b32 s28, s20, 6
  s_add_u32 s28, s28, s21
  s_lshl_b32 s28, s28, 5
  s_add_u32 s28, s28, 0
  s_add_u32 s28, s28, s5
  s_lshl_b32 s29, s28, 12
  s_add_u32 s29, s29, 1048576
  s_lshl_b32 s28, s28, 14
  s_add_u32 s28, s28, 17825792
  buffer_load_dwordx4 v[76:79], v2, s[8:11], s28 offen offset:0 sc1
  buffer_load_dwordx4 v[80:83], v2, s[8:11], s28 offen offset:512 sc1
  buffer_load_dwordx4 v[84:87], v2, s[8:11], s28 offen offset:1024 sc1
  buffer_load_dwordx4 v[88:91], v2, s[8:11], s28 offen offset:1536 sc1
  buffer_load_dwordx4 v[92:95], v2, s[8:11], s28 offen offset:2048 sc1
  buffer_load_dwordx4 v[96:99], v2, s[8:11], s28 offen offset:2560 sc1
  buffer_load_dwordx4 v[100:103], v2, s[8:11], s28 offen offset:3072 sc1
  buffer_load_dwordx4 v[104:107], v2, s[8:11], s28 offen offset:3584 sc1
  v_add_u32 v124, 0x10000, v4
  s_waitcnt vmcnt(8)
  s_barrier
  ds_read_b64_tr_b16 v[108:109], v4 offset:0
  ds_read_b64_tr_b16 v[110:111], v4 offset:1024
  ds_read_b128 v[20:23], v1 offset:0
  ds_read_b64_tr_b16 v[112:113], v4 offset:4096
  ds_read_b64_tr_b16 v[114:115], v4 offset:5120
  ds_read_b128 v[24:27], v1 offset:1024
  ds_read_b64_tr_b16 v[116:117], v4 offset:8192
  ds_read_b64_tr_b16 v[118:119], v4 offset:9216
  ds_read_b128 v[28:31], v1 offset:2048
  s_cmp_eq_u32 s32, 0
  s_cbranch_scc1 L_fp_207
  s_cmp_eq_u32 s4, 0
  s_cbranch_scc0 L_fp_207_z
  v_mov_b32 v14, 1
  s_mov_b64 exec, 1
  buffer_store_dword v14, v1, s[8:11], s32 offen sc1
  s_mov_b64 exec, -1
L_fp_207_z:
  s_mov_b32 s32, 0
L_fp_207:
  ds_read_b64_tr_b16 v[120:121], v4 offset:12288
  ds_read_b64_tr_b16 v[122:123], v4 offset:13312
  ds_read_b128 v[32:35], v1 offset:3072
  s_waitcnt lgkmcnt(9)
  v_mfma_f32_32x32x16_bf16 v[60:75], v[108:111], v[20:23], 0
  ds_read_b64_tr_b16 v[108:109], v4 offset:16384
  ds_read_b64_tr_b16 v[110:111], v4 offset:17408
  ds_read_b128 v[20:23], v1 offset:4096
  s_waitcnt lgkmcnt(9)
  v_mfma_f32_32x32x16_bf16 v[60:75], v[112:115], v[24:27], v[60:75]
  ds_read_b64_tr_b16 v[112:113], v4 offset:20480
  ds_read_b64_tr_b16 v[114:115], v4 offset:21504
  ds_read_b128 v[24:27], v1 offset:5120
  s_waitcnt lgkmcnt(9)
  v_mfma_f32_32x32x16_bf16 v[60:75], v[116:119], v[28:31], v[60:75]
  ds_read_b64_tr_b16 v[116:117], v4 offset:24576
  ds_read_b64_tr_b16 v[118:119], v4 offset:25600
  ds_read_b128 v[28:31], v1 offset:6144
  s_waitcnt lgkmcnt(9)
  v_mfma_f32_32x32x16_bf16 v[60:75], v[120:123], v[32:35], v[60:75]
  ds_read_b64_tr_b16 v[120:121], v4 offset:28672
  ds_read_b64_tr_b16 v[122:123], v4 offset:29696
  ds_read_b128 v[32:35], v1 offset:7168
  s_waitcnt lgkmcnt(9)
  v_mfma_f32_32x32x16_bf16 v[60:75], v[108:111], v[20:23], v[60:75]
  ds_read_b64_tr_b16 v[108:109], v4 offset:32768
  ds_read_b64_tr_b16 v[110:111], v4 offset:33792
  ds_read_b128 v[20:23], v1 offset:8192
  s_waitcnt lgkmcnt(9)
  v_mfma_f32_32x32x16_bf16 v[60:75], v[112:115], v[24:27], v[60:75]
  ds_read_b64_tr_b16 v[112:113], v4 offset:36864
  ds_read_b64_tr_b16 v[114:115], v4 offset:37888
  ds_read_b128 v[24:27], v1 offset:9216
  s_waitcnt lgkmcnt(9)
  v_mfma_f32_32x32x16_bf16 v[60:75], v[116:119], v[28:31], v[60:75]
  ds_read_b64_tr_b16 v[116:117], v4 offset:40960
  ds_read_b64_tr_b16 v[118:119], v4 offset:41984
  ds_read_b128 v[28:31], v1 offset:10240
  s_waitcnt lgkmcnt(9)
  v_mfma_f32_32x32x16_bf16 v[60:75], v[120:123], v[32:35], v[60:75]
  ds_read_b64_tr_b16 v[120:121], v4 offset:45056
  ds_read_b64_tr_b16 v[122:123], v4 offset:46080
  ds_read_b128 v[32:35], v1 offset:11264
  s_waitcnt lgkmcnt(9)
  v_mfma_f32_32x32x16_bf16 v[60:75], v[108:111], v[20:23], v[60:75]
  ds_read_b64_tr_b16 v[108:109], v4 offset:49152
  ds_read_b64_tr_b16 v[110:111], v4 offset:50176
  ds_read_b128 v[20:23], v1 offset:12288
  s_waitcnt lgkmcnt(9)
  v_mfma_f32_32x32x16_bf16 v[60:75], v[112:115], v[24:27], v[60:75]
  ds_read_b64_tr_b16 v[112:113], v4 offset:53248
  ds_read_b64_tr_b16 v[114:115], v4 offset:54272
  ds_read_b128 v[24:27], v1 offset:13312
  s_waitcnt lgkmcnt(9)
  v_mfma_f32_32x32x16_bf16 v[60:75], v[116:119], v[28:31], v[60:75]
  ds_read_b64_tr_b16 v[116:117], v4 offset:57344
  ds_read_b64_tr_b16 v[118:119], v4 offset:58368
  ds_read_b128 v[28:31], v1 offset:14336
  s_waitcnt lgkmcnt(9)
  v_mfma_f32_32x32x16_bf16 v[60:75], v[120:123], v[32:35], v[60:75]
  ds_read_b64_tr_b16 v[120:121], v4 offset:61440
  ds_read_b64_tr_b16 v[122:123], v4 offset:62464
  ds_read_b128 v[32:35], v1 offset:15360
  s_waitcnt lgkmcnt(9)
  v_mfma_f32_32x32x16_bf16 v[60:75], v[108:111], v[20:23], v[60:75]
  ds_read_b64_tr_b16 v[108:109], v124 offset:0
  ds_read_b64_tr_b16 v[110:111], v124 offset:1024
  ds_read_b128 v[20:23], v1 offset:16384
  s_waitcnt lgkmcnt(9)
  v_mfma_f32_32x32x16_bf16 v[60:75], v[112:115], v[24:27], v[60:75]
  ds_read_b64_tr_b16 v[112:113], v124 offset:4096
  ds_read_b64_tr_b16 v[114:115], v124 offset:5120
  ds_read_b128 v[24:27], v1 offset:17408
  s_waitcnt lgkmcnt(9)
  v_mfma_f32_32x32x16_bf16 v[60:75], v[116:119], v[28:31], v[60:75]
  ds_read_b64_tr_b16 v[116:117], v124 offset:8192
  ds_read_b64_tr_b16 v[118:119], v124 offset:9216
  ds_read_b128 v[28:31], v1 offset:18432
  s_waitcnt lgkmcnt(9)
  v_mfma_f32_32x32x16_bf16 v[60:75], v[120:123], v[32:35], v[60:75]
  ds_read_b64_tr_b16 v[120:121], v124 offset:12288
  ds_read_b64_tr_b16 v[122:123], v124 offset:13312
  ds_read_b128 v[32:35], v1 offset:19456
  s_waitcnt lgkmcnt(9)
  v_mfma_f32_32x32x16_bf16 v[60:75], v[108:111], v[20:23], v[60:75]
  ds_read_b64_tr_b16 v[108:109], v124 offset:16384
  ds_read_b64_tr_b16 v[110:111], v124 offset:17408
  ds_read_b128 v[20:23], v1 offset:20480
  s_waitcnt lgkmcnt(9)
  v_mfma_f32_32x32x16_bf16 v[60:75], v[112:115], v[24:27], v[60:75]
  ds_read_b64_tr_b16 v[112:113], v124 offset:20480
  ds_read_b64_tr_b16 v[114:115], v124 offset:21504
  ds_read_b128 v[24:27], v1 offset:21504
  s_waitcnt lgkmcnt(9)
  v_mfma_f32_32x32x16_bf16 v[60:75], v[116:119], v[28:31], v[60:75]
  ds_read_b64_tr_b16 v[116:117], v124 offset:24576
  ds_read_b64_tr_b16 v[118:119], v124 offset:25600
  ds_read_b128 v[28:31], v1 offset:22528
  s_waitcnt lgkmcnt(9)
  v_mfma_f32_32x32x16_bf16 v[60:75], v[120:123], v[32:35], v[60:75]
  ds_read_b64_tr_b16 v[120:121], v124 offset:28672
  ds_read_b64_tr_b16 v[122:123], v124 offset:29696
  ds_read_b128 v[32:35], v1 offset:23552
  s_waitcnt lgkmcnt(9)
  v_mfma_f32_32x32x16_bf16 v[60:75], v[108:111], v[20:23], v[60:75]
  ds_read_b64_tr_b16 v[108:109], v124 offset:32768
  ds_read_b64_tr_b16 v[110:111], v124 offset:33792
  ds_read_b128 v[20:23], v1 offset:24576
  s_waitcnt lgkmcnt(9)
  v_mfma_f32_32x32x16_bf16 v[60:75], v[112:115], v[24:27], v[60:75]
  ds_read_b64_tr_b16 v[112:113], v124 offset:36864
  ds_read_b64_tr_b16 v[114:115], v124 offset:37888
  ds_read_b128 v[24:27], v1 offset:25600
  s_waitcnt lgkmcnt(9)
  v_mfma_f32_32x32x16_bf16 v[60:75], v[116:119], v[28:31], v[60:75]
  ds_read_b64_tr_b16 v[116:117], v124 offset:40960
  ds_read_b64_tr_b16 v[118:119], v124 offset:41984
  ds_read_b128 v[28:31], v1 offset:26624
  s_waitcnt lgkmcnt(9)
  v_mfma_f32_32x32x16_bf16 v[60:75], v[120:123], v[32:35], v[60:75]
  ds_read_b64_tr_b16 v[120:121], v124 offset:45056
  ds_read_b64_tr_b16 v[122:123], v124 offset:46080
  ds_read_b128 v[32:35], v1 offset:27648
  s_waitcnt lgkmcnt(9)
  v_mfma_f32_32x32x16_bf16 v[60:75], v[108:111], v[20:23], v[60:75]
  ds_read_b64_tr_b16 v[108:109], v124 offset:49152
  ds_read_b64_tr_b16 v[110:111], v124 offset:50176
  ds_read_b128 v[20:23], v1 offset:28672
  s_waitcnt lgkmcnt(9)
  v_mfma_f32_32x32x16_bf16 v[60:75], v[112:115], v[24:27], v[60:75]
  ds_read_b64_tr_b16 v[112:113], v124 offset:53248
  ds_read_b64_tr_b16 v[114:115], v124 offset:54272
  ds_read_b128 v[24:27], v1 offset:29696
  s_waitcnt lgkmcnt(9)
  v_mfma_f32_32x32x16_bf16 v[60:75], v[116:119], v[28:31], v[60:75]
  ds_read_b64_tr_b16 v[116:117], v124 offset:57344
  ds_read_b64_tr_b16 v[118:119], v124 offset:58368
  ds_read_b128 v[28:31], v1 offset:30720
  s_waitcnt lgkmcnt(9)
  v_mfma_f32_32x32x16_bf16 v[60:75], v[120:123], v[32:35], v[60:75]
  ds_read_b64_tr_b16 v[120:121], v124 offset:61440
  ds_read_b64_tr_b16 v[122:123], v124 offset:62464
  ds_read_b128 v[32:35], v1 offset:31744
  s_waitcnt lgkmcnt(9)
  v_mfma_f32_32x32x16_bf16 v[60:75], v[108:111], v[20:23], v[60:75]
  s_waitcnt lgkmcnt(6)
  v_mfma_f32_32x32x16_bf16 v[60:75], v[112:115], v[24:27], v[60:75]
  s_waitcnt lgkmcnt(3)
  v_mfma_f32_32x32x16_bf16 v[60:75], v[116:119], v[28:31], v[60:75]
  s_waitcnt lgkmcnt(0)
  v_mfma_f32_32x32x16_bf16 v[60:75], v[120:123], v[32:35], v[60:75]
  s_barrier
  s_lshl_b32 s30, s4, 11
  s_add_u32 s27, s28, s30
  s_add_u32 s27, s27, 8192
  buffer_load_dwordx4 v[52:55], v3, s[8:11], s27 offen offset:0 sc1
  buffer_load_dwordx4 v[56:59], v3, s[8:11], s27 offen offset:512 sc1
  s_add_u32 s30, s30, 0
  v_add_u32 v124, s30, v1
  s_nop 3
  v_cvt_pk_bf16_f32 v20, v60, v61
  v_cvt_pk_bf16_f32 v21, v62, v63
  v_cvt_pk_bf16_f32 v22, v64, v65
  v_cvt_pk_bf16_f32 v23, v66, v67
  v_cvt_pk_bf16_f32 v24, v68, v69
  v_cvt_pk_bf16_f32 v25, v70, v71
  v_cvt_pk_bf16_f32 v26, v72, v73
  v_cvt_pk_bf16_f32 v27, v74, v75
  ds_write_b128 v124, v[20:23]
  ds_write_b128 v124, v[24:27] offset:1024
  s_waitcnt lgkmcnt(0)
  s_barrier
  ds_read_b128 v[20:23], v1 offset:0
  ds_read_b128 v[24:27], v1 offset:1024
  ds_read_b128 v[28:31], v1 offset:2048
  ds_read_b128 v[32:35], v1 offset:3072
  ds_read_b128 v[36:39], v1 offset:4096
  ds_read_b128 v[40:43], v1 offset:5120
  ds_read_b128 v[44:47], v1 offset:6144
  ds_read_b128 v[48:51], v1 offset:7168
  s_waitcnt vmcnt(2)
  s_waitcnt lgkmcnt(7)
  v_mfma_f32_32x32x16_bf16 v[60:75], v[76:79], v[20:23], 0
  s_waitcnt lgkmcnt(6)
  v_mfma_f32_32x32x16_bf16 v[60:75], v[80:83], v[24:27], v[60:75]
  s_waitcnt lgkmcnt(5)
  v_mfma_f32_32x32x16_bf16 v[60:75], v[84:87], v[28:31], v[60:75]
  s_waitcnt lgkmcnt(4)
  v_mfma_f32_32x32x16_bf16 v[60:75], v[88:91], v[32:35], v[60:75]
  s_waitcnt lgkmcnt(3)
  v_mfma_f32_32x32x16_bf16 v[60:75], v[92:95], v[36:39], v[60:75]
  s_waitcnt lgkmcnt(2)
  v_mfma_f32_32x32x16_bf16 v[60:75], v[96:99], v[40:43], v[60:75]
  s_waitcnt lgkmcnt(1)
  v_mfma_f32_32x32x16_bf16 v[60:75], v[100:103], v[44:47], v[60:75]
  s_waitcnt lgkmcnt(0)
  v_mfma_f32_32x32x16_bf16 v[60:75], v[104:107], v[48:51], v[60:75]
  s_barrier
  s_nop 10
  v_cndmask_b32 v60, v7, v60, s[40:41]
  v_cndmask_b32 v61, v7, v61, s[42:43]
  v_cndmask_b32 v62, v7, v62, s[44:45]
  v_cndmask_b32 v63, v7, v63, s[46:47]
  v_cndmask_b32 v64, v7, v64, s[48:49]
  v_cndmask_b32 v65, v7, v65, s[50:51]
  v_cndmask_b32 v66, v7, v66, s[52:53]
  v_cndmask_b32 v67, v7, v67, s[54:55]
  v_cndmask_b32 v68, v7, v68, s[56:57]
  v_cndmask_b32 v69, v7, v69, s[58:59]
  v_cndmask_b32 v70, v7, v70, s[60:61]
  v_cndmask_b32 v71, v7, v71, s[62:63]
  v_cndmask_b32 v72, v7, v72, s[64:65]
  v_cndmask_b32 v73, v7, v73, s[66:67]
  v_cndmask_b32 v74, v7, v74, s[68:69]
  v_cndmask_b32 v75, v7, v75, s[70:71]
  v_max3_f32 v126, v60, v61, v62
  v_max3_f32 v126, v126, v63, v64
  v_max3_f32 v126, v126, v65, v66
  v_max3_f32 v126, v126, v67, v68
  v_max3_f32 v126, v126, v69, v70
  v_max3_f32 v126, v126, v71, v72
  v_max3_f32 v126, v126, v73, v74
  v_max_f32 v126, v126, v75
  v_mov_b32 v15, v126
  s_nop 1
  v_permlane32_swap_b32 v126, v15
  v_max_f32 v126, v126, v15
  v_mul_f32 v126, s90, v126
  v_fma_f32 v60, v60, s90, -v126
  v_fma_f32 v61, v61, s90, -v126
  v_fma_f32 v62, v62, s90, -v126
  v_fma_f32 v63, v63, s90, -v126
  v_fma_f32 v64, v64, s90, -v126
  v_fma_f32 v65, v65, s90, -v126
  v_fma_f32 v66, v66, s90, -v126
  v_fma_f32 v67, v67, s90, -v126
  v_fma_f32 v68, v68, s90, -v126
  v_fma_f32 v69, v69, s90, -v126
  v_fma_f32 v70, v70, s90, -v126
  v_fma_f32 v71, v71, s90, -v126
  v_fma_f32 v72, v72, s90, -v126
  v_fma_f32 v73, v73, s90, -v126
  v_fma_f32 v74, v74, s90, -v126
  v_fma_f32 v75, v75, s90, -v126
  v_exp_f32 v60, v60
  v_exp_f32 v61, v61
  v_exp_f32 v62, v62
  v_exp_f32 v63, v63
  v_exp_f32 v64, v64
  v_exp_f32 v65, v65
  v_exp_f32 v66, v66
  v_exp_f32 v67, v67
  v_exp_f32 v68, v68
  v_exp_f32 v69, v69
  v_exp_f32 v70, v70
  v_exp_f32 v71, v71
  v_exp_f32 v72, v72
  v_exp_f32 v73, v73
  v_exp_f32 v74, v74
  v_exp_f32 v75, v75
  v_cvt_pk_bf16_f32 v76, v60, v61
  v_cvt_pk_bf16_f32 v77, v62, v63
  v_cvt_pk_bf16_f32 v78, v64, v65
  v_cvt_pk_bf16_f32 v79, v66, v67
  v_cvt_pk_bf16_f32 v80, v68, v69
  v_cvt_pk_bf16_f32 v81, v70, v71
  v_cvt_pk_bf16_f32 v82, v72, v73
  v_cvt_pk_bf16_f32 v83, v74, v75
  v_add_f32 v60, v60, v68
  v_add_f32 v61, v61, v69
  v_add_f32 v62, v62, v70
  v_add_f32 v63, v63, v71
  v_add_f32 v64, v64, v72
  v_add_f32 v65, v65, v73
  v_add_f32 v66, v66, v74
  v_add_f32 v67, v67, v75
  v_add_f32 v60, v60, v64
  v_add_f32 v61, v61, v65
  v_add_f32 v62, v62, v66
  v_add_f32 v63, v63, v67
  v_add_f32 v60, v60, v62
  v_add_f32 v61, v61, v63
  v_add_f32 v127, v60, v61
  s_waitcnt vmcnt(0)
  v_mfma_f32_32x32x16_bf16 v[60:75], v[52:55], v[76:79], 0
  v_mfma_f32_32x32x16_bf16 v[60:75], v[56:59], v[80:83], v[60:75]
  s_sub_u32 s27, s21, 57
  s_cmp_lt_u32 s27, 7
  s_cbranch_scc0 W_nff
  s_mov_b32 s91, s30
  s_lshl_b32 s30, s34, 2
  s_add_u32 s30, s30, s4
  s_mul_i32 s30, s30, 36864
  s_add_u32 s30, s30, 118489088
  s_mul_i32 s37, s5, 147456
  s_sub_u32 s37, s30, s37
  s_mov_b32 s31, s34
  v_lshlrev_b32 v54, 2, v1
  s_add_u32 s27, s30, 20480
  buffer_load_dword v53, v54, s[8:11], s27 offen sc1
  s_add_u32 s27, s30, 28672
  buffer_load_dword v53, v54, s[8:11], s27 offen sc1
  s_cmp_eq_u32 s5, 5
  s_cbranch_scc0 L_tt_208
  s_add_u32 s27, s37, 0
  buffer_load_dword v53, v54, s[8:11], s27 offen sc1
  s_add_u32 s27, s37, 4096
  buffer_load_dword v53, v54, s[8:11], s27 offen sc1
  s_add_u32 s27, s37, 8192
  buffer_load_dword v53, v54, s[8:11], s27 offen sc1
  s_add_u32 s27, s37, 12288
  buffer_load_dword v53, v54, s[8:11], s27 offen sc1
  s_add_u32 s27, s37, 16384
  buffer_load_dword v53, v54, s[8:11], s27 offen sc1
L_tt_208:
  s_cmp_eq_u32 s5, 9
  s_cbranch_scc0 W_ntc
  s_getpc_b64 s[72:73]
L_tc_209:
  s_add_u32 s72, s72, W_row - L_tc_209
  s_addc_u32 s73, s73, 0
  s_lshl_b32 s27, s4, 12
  v_lshl_add_u32 v54, v1, 2, s27
  v_min_u32 v54, L_end - W_row, v54
  global_load_dword v53, v54, s[72:73]
  s_getpc_b64 s[72:73]
L_tc_210:
  s_sub_u32 s72, s72, L_tc_210 - W_layer
  s_subb_u32 s73, s73, 0
  s_lshl_b32 s27, s4, 12
  v_lshl_add_u32 v54, v1, 2, s27
  v_min_u32 v54, W_q2 - W_layer, v54
  global_load_dword v53, v54, s[72:73]
W_ntc:
  s_mov_b32 s30, s91
W_nff:
  s_lshl_b32 s27, s20, 5
  s_add_u32 s27, s27, s5
  s_lshl_b32 s27, s27, 7
  s_add_u32 s27, s27, 286720
  v_mov_b32 v52, 0
  s_add_u32 s31, s21, 1
  s_cmp_eq_u32 s21, 56
  s_cselect_b32 s31, 56, s31
  s_min_u32 s31, s31, 63
  s_mov_b32 s91, 0
  s_branch L_km_211_f
L_km_211:
  s_add_u32 s39, s39, 1
  s_cmp_gt_u32 s39, 0x10000
  s_cbranch_scc1 L_abort
  s_cmp_ge_u32 s21, 61
  s_cbranch_scc1 L_km_211_f
  s_sleep 8
L_km_211_f:
  buffer_load_dword v14, v52, s[8:11], s27 offen sc1
  s_waitcnt vmcnt(0)
  v_cmp_lt_u32 vcc, s31, v14
  s_cbranch_vccz L_km_211
L_km_211_r:
  buffer_load_dwordx4 v[76:79], v5, s[8:11], s29 offen offset:0 sc1
  buffer_load_dwordx4 v[80:83], v5, s[8:11], s29 offen offset:32 sc1
  buffer_load_dwordx4 v[84:87], v5, s[8:11], s29 offen offset:512 sc1
  buffer_load_dwordx4 v[88:91], v5, s[8:11], s29 offen offset:544 sc1
  buffer_load_dwordx4 v[92:95], v5, s[8:11], s29 offen offset:1024 sc1
  buffer_load_dwordx4 v[96:99], v5, s[8:11], s29 offen offset:1056 sc1
  buffer_load_dwordx4 v[100:103], v5, s[8:11], s29 offen offset:1536 sc1
  buffer_load_dwordx4 v[104:107], v5, s[8:11], s29 offen offset:1568 sc1
  buffer_load_dwordx2 v[56:57], v6, s[8:11], s29 offen sc1
  v_mov_b64 v[58:59], 0
  s_waitcnt vmcnt(8)
  v_mfma_f32_32x32x16_bf16 v[108:123], v[76:79], v[20:23], 0
  s_waitcnt vmcnt(7)
  v_mfma_f32_32x32x16_bf16 v[108:123], v[80:83], v[24:27], v[108:123]
  s_waitcnt vmcnt(6)
  v_mfma_f32_32x32x16_bf16 v[108:123], v[84:87], v[28:31], v[108:123]
  s_waitcnt vmcnt(5)
  v_mfma_f32_32x32x16_bf16 v[108:123], v[88:91], v[32:35], v[108:123]
  s_waitcnt vmcnt(4)
  v_mfma_f32_32x32x16_bf16 v[108:123], v[92:95], v[36:39], v[108:123]
  s_waitcnt vmcnt(3)
  v_mfma_f32_32x32x16_bf16 v[108:123], v[96:99], v[40:43], v[108:123]
  s_waitcnt vmcnt(2)
  v_mfma_f32_32x32x16_bf16 v[108:123], v[100:103], v[44:47], v[108:123]
  s_waitcnt vmcnt(1)
  v_mfma_f32_32x32x16_bf16 v[108:123], v[104:107], v[48:51], v[108:123]
  s_waitcnt vmcnt(0)
  v_cmp_eq_u32 s[72:73], -1, v56
  s_nop 9
  v_cmp_u_f32 vcc, v108, v109
  v_cmp_u_f32 s[74:75], v110, v111
  s_nop 2
  s_or_b64 s[72:73], s[72:73], vcc
  s_or_b64 s[72:73], s[72:73], s[74:75]
  s_cbranch_scc0 L_km_211_v
  s_add_u32 s91, s91, 1
  s_cmp_lt_u32 s91, 200
  s_cbranch_scc1 L_km_211_r
L_km_211_v:
  v_max3_f32 v14, v108, v109, v110
  v_max_f32 v14, v14, v111
  v_mov_b32 v15, v14
  s_nop 1
  v_permlane32_swap_b32 v14, v15
  v_max_f32 v14, v14, v15
  v_mul_f32 v14, s90, v14
  v_max_f32 v14, v14, v126
  v_fma_f32 v108, v108, s90, -v14
  v_fma_f32 v109, v109, s90, -v14
  v_fma_f32 v110, v110, s90, -v14
  v_fma_f32 v111, v111, s90, -v14
  v_sub_f32 v126, v126, v14
  v_exp_f32 v108, v108
  v_exp_f32 v109, v109
  v_exp_f32 v110, v110
  v_exp_f32 v111, v111
  v_exp_f32 v126, v126
  v_cvt_pk_bf16_f32 v76, v108, v109
  v_cvt_pk_bf16_f32 v77, v110, v111
  v_mov_b64 v[78:79], 0
  v_add_f32 v108, v108, v109
  s_nop 0
  v_mfma_f32_32x32x16_bf16 v[92:107], v[56:59], v[76:79], 0
  v_add_f32 v110, v110, v111
  v_fmac_f32 v108, v127, v126
  v_add_f32 v108, v108, v110
  v_mov_b32 v15, v108
  s_nop 1
  v_permlane32_swap_b32 v108, v15
  v_add_f32 v14, v108, v15
  v_rcp_f32 v14, v14
  v_add_u32 v15, s30, v1
  v_mul_f32 v126, v126, v14
  v_pk_mul_f32 v[60:61], v[60:61], v[126:127] op_sel_hi:[1,0]
  v_pk_mul_f32 v[62:63], v[62:63], v[126:127] op_sel_hi:[1,0]
  v_pk_mul_f32 v[64:65], v[64:65], v[126:127] op_sel_hi:[1,0]
  v_pk_mul_f32 v[66:67], v[66:67], v[126:127] op_sel_hi:[1,0]
  v_pk_mul_f32 v[68:69], v[68:69], v[126:127] op_sel_hi:[1,0]
  v_pk_mul_f32 v[70:71], v[70:71], v[126:127] op_sel_hi:[1,0]
  v_pk_mul_f32 v[72:73], v[72:73], v[126:127] op_sel_hi:[1,0]
  v_pk_mul_f32 v[74:75], v[74:75], v[126:127] op_sel_hi:[1,0]
  v_pk_fma_f32 v[60:61], v[92:93], v[14:15], v[60:61] op_sel_hi:[1,0,1]
  v_pk_fma_f32 v[62:63], v[94:95], v[14:15], v[62:63] op_sel_hi:[1,0,1]
  v_pk_fma_f32 v[64:65], v[96:97], v[14:15], v[64:65] op_sel_hi:[1,0,1]
  v_pk_fma_f32 v[66:67], v[98:99], v[14:15], v[66:67] op_sel_hi:[1,0,1]
  v_pk_fma_f32 v[68:69], v[100:101], v[14:15], v[68:69] op_sel_hi:[1,0,1]
  v_pk_fma_f32 v[70:71], v[102:103], v[14:15], v[70:71] op_sel_hi:[1,0,1]
  v_pk_fma_f32 v[72:73], v[104:105], v[14:15], v[72:73] op_sel_hi:[1,0,1]
  v_pk_fma_f32 v[74:75], v[106:107], v[14:15], v[74:75] op_sel_hi:[1,0,1]
  v_cvt_pk_bf16_f32 v20, v60, v61
  v_cvt_pk_bf16_f32 v21, v62, v63
  v_cvt_pk_bf16_f32 v22, v64, v65
  v_cvt_pk_bf16_f32 v23, v66, v67
  v_cvt_pk_bf16_f32 v24, v68, v69
  v_cvt_pk_bf16_f32 v25, v70, v71
  v_cvt_pk_bf16_f32 v26, v72, v73
  v_cvt_pk_bf16_f32 v27, v74, v75
  ds_write_b128 v15, v[20:23]
  ds_write_b128 v15, v[24:27] offset:1024
  s_waitcnt lgkmcnt(0)
  s_barrier
  ds_read_b128 v[20:23], v1 offset:0
  ds_read_b128 v[24:27], v1 offset:1024
  ds_read_b128 v[28:31], v1 offset:2048
  ds_read_b128 v[32:35], v1 offset:3072
  ds_read_b128 v[36:39], v1 offset:4096
  ds_read_b128 v[40:43], v1 offset:5120
  ds_read_b128 v[44:47], v1 offset:6144
  ds_read_b128 v[48:51], v1 offset:7168
  s_add_u32 s27, s21, 7
  s_cmp_lt_u32 s27, 64
  s_cbranch_scc0 W_ntn
  v_lshlrev_b32 v124, 2, v1
  s_lshl_b32 s28, s20, 6
  s_add_u32 s28, s28, s27
  s_lshl_b32 s28, s28, 15
  s_add_u32 s28, s28, 84934656
  s_lshl_b32 s31, s4, 13
  s_add_u32 s28, s28, s31
  s_and_b32 s31, s5, 7
  s_cmp_eq_u32 s31, 0
  s_cbranch_scc0 W_nth
  buffer_load_dword v0, v124, s[8:11], s28 offen sc1
  s_add_u32 s28, s28, 4096
  buffer_load_dword v0, v124, s[8:11], s28 offen sc1
W_nth:
  s_sub_u32 s28, s29, 1048576
  s_lshl_b32 s28, s28, 2
  s_lshl_b32 s31, s4, 12
  s_add_u32 s28, s28, s31
  s_add_u32 s28, s28, 21495808
  buffer_load_dword v0, v124, s[8:11], s28 offen sc1
W_ntn:
  s_mul_i32 s27, s21, 37
  s_lshr_b32 s27, s27, 8
  s_and_b32 s27, s27, 3
  s_lshl_b32 s31, s6, 2
  s_add_u32 s27, s27, s31
  s_lshl_b32 s27, s27, 20
  s_add_u32 s27, s27, 201326592
  s_add_u32 s28, s27, 524288
  s_waitcnt lgkmcnt(7)
  v_mfma_f32_32x32x16_bf16 v[60:75], v[128:131], v[20:23], 0
  s_waitcnt lgkmcnt(6)
  v_mfma_f32_32x32x16_bf16 v[60:75], v[132:135], v[24:27], v[60:75]
  s_waitcnt lgkmcnt(5)
  v_mfma_f32_32x32x16_bf16 v[60:75], v[136:139], v[28:31], v[60:75]
  s_waitcnt lgkmcnt(4)
  v_mfma_f32_32x32x16_bf16 v[60:75], v[140:143], v[32:35], v[60:75]
  s_waitcnt lgkmcnt(3)
  v_mfma_f32_32x32x16_bf16 v[60:75], v[144:147], v[36:39], v[60:75]
  s_waitcnt lgkmcnt(2)
  v_mfma_f32_32x32x16_bf16 v[60:75], v[148:151], v[40:43], v[60:75]
  s_waitcnt lgkmcnt(1)
  v_mfma_f32_32x32x16_bf16 v[60:75], v[152:155], v[44:47], v[60:75]
  s_waitcnt lgkmcnt(0)
  v_mfma_f32_32x32x16_bf16 v[60:75], v[156:159], v[48:51], v[60:75]
  s_barrier
  v_mfma_f32_32x32x16_bf16 v[76:91], v[160:163], v[20:23], 0
  v_mfma_f32_32x32x16_bf16 v[76:91], v[164:167], v[24:27], v[76:91]
  v_mfma_f32_32x32x16_bf16 v[76:91], v[168:171], v[28:31], v[76:91]
  v_cvt_pk_bf16_f32 v52, v60, v61
  v_cvt_pk_bf16_f32 v53, v62, v63
  v_cvt_pk_bf16_f32 v54, v64, v65
  v_cvt_pk_bf16_f32 v55, v66, v67
  v_mfma_f32_32x32x16_bf16 v[76:91], v[172:175], v[32:35], v[76:91]
  v_cvt_pk_bf16_f32 v56, v68, v69
  v_cvt_pk_bf16_f32 v57, v70, v71
  v_cvt_pk_bf16_f32 v58, v72, v73
  v_cvt_pk_bf16_f32 v59, v74, v75
  v_mfma_f32_32x32x16_bf16 v[76:91], v[176:179], v[36:39], v[76:91]
  ds_write_b128 v8, v[52:55]
  ds_write_b128 v8, v[56:59] offset:32
  v_mfma_f32_32x32x16_bf16 v[76:91], v[180:183], v[40:43], v[76:91]
  ds_read_b128 v[60:63], v15
  ds_read_b128 v[64:67], v15 offset:1024
  v_mfma_f32_32x32x16_bf16 v[76:91], v[184:187], v[44:47], v[76:91]
  v_mfma_f32_32x32x16_bf16 v[76:91], v[188:191], v[48:51], v[76:91]
  v_mfma_f32_32x32x16_bf16 v[92:107], v[192:195], v[20:23], 0
  s_waitcnt lgkmcnt(0)
  s_cmp_eq_u32 s7, 0
  s_cbranch_scc0 L_xs_212
  buffer_store_dwordx4 v[60:63], v9, s[8:11], s27 offen offset:0
  buffer_store_dwordx4 v[64:67], v9, s[8:11], s28 offen offset:0
  s_branch L_xe_213
L_xs_212:
  buffer_store_dwordx4 v[60:63], v9, s[8:11], s27 offen offset:0 sc1
  buffer_store_dwordx4 v[64:67], v9, s[8:11], s28 offen offset:0 sc1
L_xe_213:
  v_mfma_f32_32x32x16_bf16 v[92:107], v[196:199], v[24:27], v[92:107]
  v_mfma_f32_32x32x16_bf16 v[92:107], v[200:203], v[28:31], v[92:107]
  v_cvt_pk_bf16_f32 v52, v76, v77
  v_cvt_pk_bf16_f32 v53, v78, v79
  v_cvt_pk_bf16_f32 v54, v80, v81
  v_cvt_pk_bf16_f32 v55, v82, v83
  v_mfma_f32_32x32x16_bf16 v[92:107], v[204:207], v[32:35], v[92:107]
  v_cvt_pk_bf16_f32 v56, v84, v85
  v_cvt_pk_bf16_f32 v57, v86, v87
  v_cvt_pk_bf16_f32 v58, v88, v89
  v_cvt_pk_bf16_f32 v59, v90, v91
  v_mfma_f32_32x32x16_bf16 v[92:107], v[208:211], v[36:39], v[92:107]
  ds_write_b128 v8, v[52:55]
  ds_write_b128 v8, v[56:59] offset:32
  v_mfma_f32_32x32x16_bf16 v[92:107], v[212:215], v[40:43], v[92:107]
  ds_read_b128 v[76:79], v15
  ds_read_b128 v[80:83], v15 offset:1024
  v_mfma_f32_32x32x16_bf16 v[92:107], v[216:219], v[44:47], v[92:107]
  v_mfma_f32_32x32x16_bf16 v[92:107], v[220:223], v[48:51], v[92:107]
  v_mfma_f32_32x32x16_bf16 v[108:123], v[224:227], v[20:23], 0
  s_waitcnt lgkmcnt(0)
  s_cmp_eq_u32 s7, 0
  s_cbranch_scc0 L_xs_214
  buffer_store_dwordx4 v[76:79], v9, s[8:11], s27 offen offset:64
  buffer_store_dwordx4 v[80:83], v9, s[8:11], s28 offen offset:64
  s_branch L_xe_215
L_xs_214:
  buffer_store_dwordx4 v[76:79], v9, s[8:11], s27 offen offset:64 sc1
  buffer_store_dwordx4 v[80:83], v9, s[8:11], s28 offen offset:64 sc1
L_xe_215:
  v_mfma_f32_32x32x16_bf16 v[108:123], v[228:231], v[24:27], v[108:123]
  v_mfma_f32_32x32x16_bf16 v[108:123], v[232:235], v[28:31], v[108:123]
  v_cvt_pk_bf16_f32 v52, v92, v93
  v_cvt_pk_bf16_f32 v53, v94, v95
  v_cvt_pk_bf16_f32 v54, v96, v97
  v_cvt_pk_bf16_f32 v55, v98, v99
  v_mfma_f32_32x32x16_bf16 v[108:123], v[236:239], v[32:35], v[108:123]
  v_cvt_pk_bf16_f32 v56, v100, v101
  v_cvt_pk_bf16_f32 v57, v102, v103
  v_cvt_pk_bf16_f32 v58, v104, v105
  v_cvt_pk_bf16_f32 v59, v106, v107
  v_mfma_f32_32x32x16_bf16 v[108:123], v[240:243], v[36:39], v[108:123]
  ds_write_b128 v8, v[52:55]
  ds_write_b128 v8, v[56:59] offset:32
  v_mfma_f32_32x32x16_bf16 v[108:123], v[244:247], v[40:43], v[108:123]
  ds_read_b128 v[92:95], v15
  ds_read_b128 v[96:99], v15 offset:1024
  v_mfma_f32_32x32x16_bf16 v[108:123], v[248:251], v[44:47], v[108:123]
  v_mfma_f32_32x32x16_bf16 v[108:123], v[252:255], v[48:51], v[108:123]
  s_waitcnt lgkmcnt(0)
  s_cmp_eq_u32 s7, 0
  s_cbranch_scc0 L_xs_216
  buffer_store_dwordx4 v[92:95], v9, s[8:11], s27 offen offset:128
  buffer_store_dwordx4 v[96:99], v9, s[8:11], s28 offen offset:128
  s_branch L_xe_217
L_xs_216:
  buffer_store_dwordx4 v[92:95], v9, s[8:11], s27 offen offset:128 sc1
  buffer_store_dwordx4 v[96:99], v9, s[8:11], s28 offen offset:128 sc1
L_xe_217:
  s_nop 6
  v_cvt_pk_bf16_f32 v52, v108, v109
  v_cvt_pk_bf16_f32 v53, v110, v111
  v_cvt_pk_bf16_f32 v54, v112, v113
  v_cvt_pk_bf16_f32 v55, v114, v115
  v_cvt_pk_bf16_f32 v56, v116, v117
  v_cvt_pk_bf16_f32 v57, v118, v119
  v_cvt_pk_bf16_f32 v58, v120, v121
  v_cvt_pk_bf16_f32 v59, v122, v123
  ds_write_b128 v8, v[52:55]
  ds_write_b128 v8, v[56:59] offset:32
  ds_read_b128 v[108:111], v15
  ds_read_b128 v[112:115], v15 offset:1024
  s_waitcnt lgkmcnt(0)
  s_cmp_eq_u32 s7, 0
  s_cbranch_scc0 L_xs_218
  buffer_store_dwordx4 v[108:111], v9, s[8:11], s27 offen offset:192
  buffer_store_dwordx4 v[112:115], v9, s[8:11], s28 offen offset:192
  s_branch L_xe_219
L_xs_218:
  buffer_store_dwordx4 v[108:111], v9, s[8:11], s27 offen offset:192 sc1
  buffer_store_dwordx4 v[112:115], v9, s[8:11], s28 offen offset:192 sc1
L_xe_219:
  s_lshl_b32 s27, s20, 6
  s_add_u32 s27, s27, s21
  s_lshl_b32 s27, s27, 7
  s_add_u32 s27, s27, 311296
  s_lshl_b32 s31, s5, 2
  s_add_u32 s27, s27, s31
  s_waitcnt vmcnt(0)
  s_barrier
  s_cmp_eq_u32 s4, 0
  s_cbranch_scc0 L_sf_220
  v_mov_b32 v14, 1
  s_mov_b64 exec, 1
  s_cmp_eq_u32 s7, 0
  s_cbranch_scc0 L_xs_221
  buffer_store_dword v14, v1, s[8:11], s27 offen
  s_branch L_xe_222
L_xs_221:
  buffer_store_dword v14, v1, s[8:11], s27 offen sc1
L_xe_222:
  s_mov_b64 exec, -1
L_sf_220:
  s_add_u32 s21, s21, 7
  s_cmp_lt_u32 s21, 64
  s_cbranch_scc0 W_C
  s_add_u32 s27, s24, 14
  s_cmp_le_u32 s27, s21
  s_cbranch_scc0 W_C
  s_cmp_lt_u32 s22, s24
  s_cbranch_scc0 W_row
W_side:
  s_lshl_b32 s27, s20, 6
  s_add_u32 s27, s27, s24
  s_lshl_b32 s27, s27, 7
  s_add_u32 s27, s27, 311296
  s_lshl_b32 s28, s20, 6
  s_add_u32 s28, s28, s22
  s_lshl_b32 s28, s28, 7
  s_add_u32 s28, s28, 327680
  s_sub_u32 s28, s28, s27
  s_sub_u32 s28, s28, 128
  v_lshrrev_b32 v15, 2, v1
  v_mov_b32 v14, s28
  s_mov_b64 exec, s[94:95]
  v_mov_b32 v14, 0
  s_mov_b64 exec, -1
  v_add_u32 v15, v15, v14
L_sd_223:
  buffer_load_dword v14, v15, s[8:11], s27 offen sc1
  s_waitcnt vmcnt(0)
  v_cmp_eq_u32 vcc, 0, v14
  s_cbranch_vccz L_sd_223_ok
  s_add_u32 s39, s39, 1
  s_cmp_gt_u32 s39, 0x10000
  s_cbranch_scc1 L_abort
  s_branch L_sd_223
L_sd_223_ok:
  s_lshl_b32 s28, s24, 15
  s_cmp_eq_u32 s20, 0
  s_cbranch_scc0 L_row_224_x2
  buffer_load_dwordx2 v[56:57], v11, s[12:15], s28 offen
  s_branch L_row_224_xd
L_row_224_x2:
  s_add_u32 s29, s28, 97517568
  buffer_load_dwordx2 v[56:57], v11, s[8:11], s29 offen sc1
L_row_224_xd:
  s_mul_i32 s27, s24, 37
  s_lshr_b32 s27, s27, 8
  s_and_b32 s27, s27, 3
  s_lshl_b32 s31, s6, 2
  s_add_u32 s27, s27, s31
  s_lshl_b32 s27, s27, 20
  s_add_u32 s27, s27, 201326592
  buffer_load_dwordx4 v[20:23], v10, s[8:11], s27 offen sc1
  s_add_u32 s27, s27, 4096
  buffer_load_dwordx4 v[24:27], v10, s[8:11], s27 offen sc1
  s_add_u32 s27, s27, 4096
  buffer_load_dwordx4 v[28:31], v10, s[8:11], s27 offen sc1
  s_add_u32 s27, s27, 4096
  buffer_load_dwordx4 v[32:35], v10, s[8:11], s27 offen sc1
  s_add_u32 s27, s27, 4096
  buffer_load_dwordx4 v[36:39], v10, s[8:11], s27 offen sc1
  s_add_u32 s27, s27, 4096
  buffer_load_dwordx4 v[40:43], v10, s[8:11], s27 offen sc1
  s_add_u32 s27, s27, 4096
  buffer_load_dwordx4 v[44:47], v10, s[8:11], s27 offen sc1
  s_add_u32 s27, s27, 4096
  buffer_load_dwordx4 v[48:51], v10, s[8:11], s27 offen sc1
  s_lshl_b32 s30, s34, 2
  s_add_u32 s30, s30, s4
  s_mul_i32 s30, s30, 36864
  s_add_u32 s30, s30, 118489088
  s_add_u32 s30, s30, 32768
  buffer_load_dwordx4 v[100:103], v1, s[8:11], s30 offen offset:0 sc1
  buffer_load_dwordx4 v[104:107], v1, s[8:11], s30 offen offset:1024 sc1
  buffer_load_dwordx4 v[108:111], v1, s[8:11], s30 offen offset:2048 sc1
  buffer_load_dwordx4 v[112:115], v1, s[8:11], s30 offen offset:3072 sc1
  s_lshl_b32 s27, s20, 6
  s_add_u32 s27, s27, s22
  s_lshl_b32 s27, s27, 15
  s_add_u32 s27, s27, 89128960
  s_lshl_b32 s28, s4, 13
  s_add_u32 s27, s27, s28
  buffer_load_dwordx4 v[68:71], v1, s[8:11], s27 offen offset:0 sc1
  buffer_load_dwordx4 v[72:75], v1, s[8:11], s27 offen offset:1024 sc1
  buffer_load_dwordx4 v[76:79], v1, s[8:11], s27 offen offset:2048 sc1
  buffer_load_dwordx4 v[80:83], v1, s[8:11], s27 offen offset:3072 sc1
  s_add_u32 s27, s27, 4096
  buffer_load_dwordx4 v[84:87], v1, s[8:11], s27 offen offset:0 sc1
  buffer_load_dwordx4 v[88:91], v1, s[8:11], s27 offen offset:1024 sc1
  buffer_load_dwordx4 v[92:95], v1, s[8:11], s27 offen offset:2048 sc1
  buffer_load_dwordx4 v[96:99], v1, s[8:11], s27 offen offset:3072 sc1
  s_waitcnt vmcnt(19)
  v_lshlrev_b32 v60, 16, v56
  v_and_b32 v61, 0xffff0000, v56
  v_lshlrev_b32 v62, 16, v57
  v_and_b32 v63, 0xffff0000, v57
  v_mfma_f32_16x16x32_bf16 v[52:55], v[16:19], v[20:23], 0
  s_waitcnt vmcnt(18)
  v_mfma_f32_16x16x32_bf16 v[52:55], v[16:19], v[24:27], v[52:55]
  s_waitcnt vmcnt(17)
  v_mfma_f32_16x16x32_bf16 v[52:55], v[16:19], v[28:31], v[52:55]
  s_waitcnt vmcnt(16)
  v_mfma_f32_16x16x32_bf16 v[52:55], v[16:19], v[32:35], v[52:55]
  s_waitcnt vmcnt(15)
  v_mfma_f32_16x16x32_bf16 v[52:55], v[16:19], v[36:39], v[52:55]
  s_waitcnt vmcnt(14)
  v_mfma_f32_16x16x32_bf16 v[52:55], v[16:19], v[40:43], v[52:55]
  s_waitcnt vmcnt(13)
  v_mfma_f32_16x16x32_bf16 v[52:55], v[16:19], v[44:47], v[52:55]
  s_waitcnt vmcnt(12)
  v_mfma_f32_16x16x32_bf16 v[52:55], v[16:19], v[48:51], v[52:55]
  v_lshrrev_b32 v36, 5, v1
  s_lshl_b32 s27, s4, 4
  s_add_u32 s27, s27, 8192
  v_add_u32 v36, s27, v36
  v_mov_b32 v37, 8192
  s_nop 2
  v_cvt_pk_bf16_f32 v52, v52, v53
  v_cvt_pk_bf16_f32 v53, v54, v55
  v_lshlrev_b32 v58, 16, v53
  v_and_b32 v59, 0xffff0000, v53
  v_lshlrev_b32 v56, 16, v52
  v_and_b32 v57, 0xffff0000, v52
  v_add_f32 v60, v60, v56
  v_add_f32 v61, v61, v57
  v_add_f32 v62, v62, v58
  v_add_f32 v63, v63, v59
  v_cvt_pk_bf16_f32 v56, v60, v61
  v_cvt_pk_bf16_f32 v57, v62, v63
  v_lshlrev_b32 v60, 16, v56
  v_and_b32 v61, 0xffff0000, v56
  v_lshlrev_b32 v62, 16, v57
  v_and_b32 v63, 0xffff0000, v57
  v_add_f32 v52, v60, v61
  v_mul_f32 v53, v60, v60
  v_add_f32 v54, v62, v63
  v_fmac_f32 v53, v61, v61
  v_add_f32 v52, v52, v54
  v_fmac_f32 v53, v62, v62
  v_fmac_f32 v53, v63, v63
  v_add_f32_dpp v52, v52, v52 row_ror:8 row_mask:0xf bank_mask:0xf
  s_nop 0
  v_add_f32_dpp v53, v53, v53 row_ror:8 row_mask:0xf bank_mask:0xf
  v_add_f32_dpp v52, v52, v52 row_ror:4 row_mask:0xf bank_mask:0xf
  s_nop 0
  v_add_f32_dpp v53, v53, v53 row_ror:4 row_mask:0xf bank_mask:0xf
  v_add_f32_dpp v52, v52, v52 row_ror:2 row_mask:0xf bank_mask:0xf
  s_nop 0
  v_add_f32_dpp v53, v53, v53 row_ror:2 row_mask:0xf bank_mask:0xf
  v_add_f32_dpp v52, v52, v52 row_ror:1 row_mask:0xf bank_mask:0xf
  s_nop 0
  v_add_f32_dpp v53, v53, v53 row_ror:1 row_mask:0xf bank_mask:0xf
  s_mov_b64 exec, 0x10001
  ds_write_b64 v36, v[52:53]
  s_mov_b64 exec, -1
  s_lshl_b32 s29, s20, 6
  s_add_u32 s29, s29, s24
  s_lshl_b32 s29, s29, 15
  s_add_u32 s29, s29, 89128960
  s_lshl_b32 s28, s20, 6
  s_add_u32 s28, s28, s24
  s_lshl_b32 s28, s28, 15
  s_add_u32 s28, s28, 93323264
  s_waitcnt lgkmcnt(0)
  s_barrier
  ds_read_b128 v[20:23], v37 offset:0
  ds_read_b128 v[24:27], v37 offset:16
  ds_read_b128 v[28:31], v37 offset:32
  ds_read_b128 v[32:35], v37 offset:48
  s_waitcnt lgkmcnt(0)
  v_add_f32 v20, v20, v28
  v_add_f32 v21, v21, v29
  v_add_f32 v22, v22, v30
  v_add_f32 v23, v23, v31
  v_add_f32 v24, v24, v32
  v_add_f32 v25, v25, v33
  v_add_f32 v26, v26, v34
  v_add_f32 v27, v27, v35
  v_add_f32 v20, v20, v24
  v_add_f32 v21, v21, v25
  v_add_f32 v22, v22, v26
  v_add_f32 v23, v23, v27
  v_add_f32 v20, v20, v22
  v_add_f32 v21, v21, v23
  v_mul_f32 v20, 0x3b000000, v20
  v_mul_f32 v21, 0x3b000000, v21
  v_fma_f32 v21, -v20, v20, v21
  v_max_f32 v21, 0, v21
  v_add_f32 v21, 0x3727c5ac, v21
  v_rsq_f32 v21, v21
  v_sub_f32 v60, v60, v20
  v_sub_f32 v61, v61, v20
  v_sub_f32 v62, v62, v20
  v_sub_f32 v63, v63, v20
  v_mul_f32 v60, v60, v21
  v_mul_f32 v61, v61, v21
  v_mul_f32 v62, v62, v21
  v_mul_f32 v63, v63, v21
  v_cvt_pk_bf16_f32 v60, v60, v61
  v_cvt_pk_bf16_f32 v61, v62, v63
  s_mov_b64 exec, s[94:95]
  s_cmp_eq_u32 s7, 0
  s_cbranch_scc0 L_xs_225
  buffer_store_dwordx2 v[60:61], v13, s[8:11], s29 offen
  buffer_store_dwordx2 v[56:57], v11, s[8:11], s28 offen
  s_branch L_xe_226
L_xs_225:
  buffer_store_dwordx2 v[60:61], v13, s[8:11], s29 offen sc1
  buffer_store_dwordx2 v[56:57], v11, s[8:11], s28 offen sc1
L_xe_226:
  s_mov_b64 exec, -1
  v_lshrrev_b32 v64, 4, v1
  v_bfe_u32 v65, v64, 1, 2
  v_lshlrev_b32 v65, 8, v65
  v_and_b32 v66, 1, v64
  v_lshl_add_u32 v65, v66, 3, v65
  v_lshrrev_b32 v66, 3, v64
  v_lshl_add_u32 v66, v66, 4, v65
  s_lshr_b32 s28, s4, 1
  s_lshl_b32 s28, s28, 10
  s_and_b32 s29, s4, 1
  s_lshl_b32 s29, s29, 7
  s_add_u32 s28, s28, s29
  s_add_u32 s28, s28, 0
  v_add_u32 v66, s28, v66
  s_lshl_b32 s28, s4, 11
  s_add_u32 s28, s28, 0
  v_add_u32 v65, s28, v1
  v_lshrrev_b32 v67, 3, v64
  v_lshlrev_b32 v67, 12, v67
  v_and_b32 v64, 7, v64
  v_lshl_add_u32 v67, v64, 2, v67
  s_lshl_b32 s27, s20, 5
  s_add_u32 s27, s27, s5
  s_lshl_b32 s30, s27, 6
  s_add_u32 s30, s30, s22
  s_lshl_b32 s30, s30, 2
  s_add_u32 s30, s30, 354304
  s_lshl_b32 s27, s27, 16
  s_and_b32 s28, s4, 1
  s_lshl_b32 s28, s28, 15
  s_add_u32 s27, s27, s28
  s_lshl_b32 s28, s22, 6
  s_add_u32 s27, s27, s28
  s_lshr_b32 s28, s4, 1
  s_lshl_b32 s28, s28, 5
  s_add_u32 s27, s27, s28
  s_add_u32 s27, s27, 163577856
  s_waitcnt vmcnt(9)
  v_mfma_f32_16x16x32_bf16 v[116:119], v[68:71], v[100:103], 0
  s_waitcnt vmcnt(8)
  v_mfma_f32_16x16x32_bf16 v[120:123], v[72:75], v[100:103], 0
  s_waitcnt vmcnt(7)
  v_mfma_f32_16x16x32_bf16 v[116:119], v[76:79], v[104:107], v[116:119]
  s_waitcnt vmcnt(6)
  v_mfma_f32_16x16x32_bf16 v[120:123], v[80:83], v[104:107], v[120:123]
  s_waitcnt vmcnt(5)
  v_mfma_f32_16x16x32_bf16 v[116:119], v[84:87], v[108:111], v[116:119]
  s_waitcnt vmcnt(4)
  v_mfma_f32_16x16x32_bf16 v[120:123], v[88:91], v[108:111], v[120:123]
  s_waitcnt vmcnt(3)
  v_mfma_f32_16x16x32_bf16 v[116:119], v[92:95], v[112:115], v[116:119]
  s_waitcnt vmcnt(2)
  v_mfma_f32_16x16x32_bf16 v[120:123], v[96:99], v[112:115], v[120:123]
  s_nop 5
  ds_write_b128 v65, v[116:119] offset:0
  s_nop 0
  ds_write_b128 v65, v[120:123] offset:1024
  s_waitcnt lgkmcnt(0)
  s_barrier
  ds_read_b64 v[68:69], v66 offset:0
  ds_read_b64 v[70:71], v66 offset:2048
  ds_read_b64 v[72:73], v66 offset:4096
  ds_read_b64 v[74:75], v66 offset:6144
  s_waitcnt lgkmcnt(0)
  v_add_f32 v68, v68, v70
  v_add_f32 v72, v72, v74
  v_add_f32 v69, v69, v71
  v_add_f32 v73, v73, v75
  v_add_f32 v68, v68, v72
  v_add_f32 v69, v69, v73
  v_cvt_pk_bf16_f32 v68, v68, v69
  buffer_store_dword v68, v67, s[8:11], s27 offen sc1
  s_mov_b32 s32, s30
  s_lshl_b32 s27, s20, 6
  s_add_u32 s27, s27, s24
  s_lshl_b32 s27, s27, 7
  s_add_u32 s27, s27, 327680
  s_lshl_b32 s31, s5, 2
  s_add_u32 s27, s27, s31
  s_waitcnt vmcnt(1)
  s_barrier
  s_cmp_eq_u32 s4, 0
  s_cbranch_scc0 L_sf_227
  v_mov_b32 v14, 1
  s_mov_b64 exec, 1
  s_cmp_eq_u32 s7, 0
  s_cbranch_scc0 L_xs_228
  buffer_store_dword v14, v1, s[8:11], s27 offen
  s_branch L_xe_229
L_xs_228:
  buffer_store_dword v14, v1, s[8:11], s27 offen sc1
L_xe_229:
  s_mov_b64 exec, -1
L_sf_227:
  s_add_u32 s24, s24, 7
  s_add_u32 s22, s22, 7
  s_branch W_C
W_row:
  s_lshl_b32 s28, s24, 15
  s_cmp_eq_u32 s20, 0
  s_cbranch_scc0 L_row_230_x2
  buffer_load_dwordx2 v[64:65], v11, s[12:15], s28 offen
  s_branch L_row_230_xd
L_row_230_x2:
  s_add_u32 s29, s28, 97517568
  buffer_load_dwordx2 v[64:65], v11, s[8:11], s29 offen sc1
L_row_230_xd:
  s_lshl_b32 s27, s20, 6
  s_add_u32 s27, s27, s24
  s_lshl_b32 s27, s27, 7
  s_add_u32 s27, s27, 311296
  v_lshrrev_b32 v15, 2, v1
  v_and_b32 v15, 0x7c, v15
L_wf_231:
  buffer_load_dword v14, v15, s[8:11], s27 offen sc1
  s_waitcnt vmcnt(0)
  v_cmp_eq_u32 vcc, 0, v14
  s_cbranch_vccz L_wf_231_ok
  s_add_u32 s39, s39, 1
  s_cmp_gt_u32 s39, 0x10000
  s_cbranch_scc1 L_abort
  s_branch L_wf_231
L_wf_231_ok:
  s_mul_i32 s27, s24, 37
  s_lshr_b32 s27, s27, 8
  s_and_b32 s27, s27, 3
  s_lshl_b32 s31, s6, 2
  s_add_u32 s27, s27, s31
  s_lshl_b32 s27, s27, 20
  s_add_u32 s27, s27, 201326592
  buffer_load_dwordx4 v[28:31], v10, s[8:11], s27 offen sc1
  s_add_u32 s27, s27, 4096
  buffer_load_dwordx4 v[32:35], v10, s[8:11], s27 offen sc1
  s_add_u32 s27, s27, 4096
  buffer_load_dwordx4 v[36:39], v10, s[8:11], s27 offen sc1
  s_add_u32 s27, s27, 4096
  buffer_load_dwordx4 v[40:43], v10, s[8:11], s27 offen sc1
  s_add_u32 s27, s27, 4096
  buffer_load_dwordx4 v[44:47], v10, s[8:11], s27 offen sc1
  s_add_u32 s27, s27, 4096
  buffer_load_dwordx4 v[48:51], v10, s[8:11], s27 offen sc1
  s_add_u32 s27, s27, 4096
  buffer_load_dwordx4 v[52:55], v10, s[8:11], s27 offen sc1
  s_add_u32 s27, s27, 4096
  buffer_load_dwordx4 v[56:59], v10, s[8:11], s27 offen sc1
  s_waitcnt vmcnt(7)
  v_lshlrev_b32 v68, 16, v64
  v_and_b32 v69, 0xffff0000, v64
  v_lshlrev_b32 v70, 16, v65
  v_and_b32 v71, 0xffff0000, v65
  v_mfma_f32_16x16x32_bf16 v[60:63], v[16:19], v[28:31], 0
  s_waitcnt vmcnt(6)
  v_mfma_f32_16x16x32_bf16 v[60:63], v[16:19], v[32:35], v[60:63]
  s_waitcnt vmcnt(5)
  v_mfma_f32_16x16x32_bf16 v[60:63], v[16:19], v[36:39], v[60:63]
  s_waitcnt vmcnt(4)
  v_mfma_f32_16x16x32_bf16 v[60:63], v[16:19], v[40:43], v[60:63]
  s_waitcnt vmcnt(3)
  v_mfma_f32_16x16x32_bf16 v[60:63], v[16:19], v[44:47], v[60:63]
  s_waitcnt vmcnt(2)
  v_mfma_f32_16x16x32_bf16 v[60:63], v[16:19], v[48:51], v[60:63]
  s_waitcnt vmcnt(1)
  v_mfma_f32_16x16x32_bf16 v[60:63], v[16:19], v[52:55], v[60:63]
  s_waitcnt vmcnt(0)
  v_mfma_f32_16x16x32_bf16 v[60:63], v[16:19], v[56:59], v[60:63]
  v_lshrrev_b32 v44, 5, v1
  s_lshl_b32 s27, s4, 4
  s_add_u32 s27, s27, 8192
  v_add_u32 v44, s27, v44
  v_mov_b32 v45, 8192
  s_nop 2
  v_cvt_pk_bf16_f32 v60, v60, v61
  v_cvt_pk_bf16_f32 v61, v62, v63
  v_lshlrev_b32 v66, 16, v61
  v_and_b32 v67, 0xffff0000, v61
  v_lshlrev_b32 v64, 16, v60
  v_and_b32 v65, 0xffff0000, v60
  v_add_f32 v68, v68, v64
  v_add_f32 v69, v69, v65
  v_add_f32 v70, v70, v66
  v_add_f32 v71, v71, v67
  v_cvt_pk_bf16_f32 v64, v68, v69
  v_cvt_pk_bf16_f32 v65, v70, v71
  v_lshlrev_b32 v68, 16, v64
  v_and_b32 v69, 0xffff0000, v64
  v_lshlrev_b32 v70, 16, v65
  v_and_b32 v71, 0xffff0000, v65
  v_add_f32 v60, v68, v69
  v_mul_f32 v61, v68, v68
  v_add_f32 v62, v70, v71
  v_fmac_f32 v61, v69, v69
  v_add_f32 v60, v60, v62
  v_fmac_f32 v61, v70, v70
  v_fmac_f32 v61, v71, v71
  v_add_f32_dpp v60, v60, v60 row_ror:8 row_mask:0xf bank_mask:0xf
  s_nop 0
  v_add_f32_dpp v61, v61, v61 row_ror:8 row_mask:0xf bank_mask:0xf
  v_add_f32_dpp v60, v60, v60 row_ror:4 row_mask:0xf bank_mask:0xf
  s_nop 0
  v_add_f32_dpp v61, v61, v61 row_ror:4 row_mask:0xf bank_mask:0xf
  v_add_f32_dpp v60, v60, v60 row_ror:2 row_mask:0xf bank_mask:0xf
  s_nop 0
  v_add_f32_dpp v61, v61, v61 row_ror:2 row_mask:0xf bank_mask:0xf
  v_add_f32_dpp v60, v60, v60 row_ror:1 row_mask:0xf bank_mask:0xf
  s_nop 0
  v_add_f32_dpp v61, v61, v61 row_ror:1 row_mask:0xf bank_mask:0xf
  s_mov_b64 exec, 0x10001
  ds_write_b64 v44, v[60:61]
  s_mov_b64 exec, -1
  s_lshl_b32 s29, s20, 6
  s_add_u32 s29, s29, s24
  s_lshl_b32 s29, s29, 15
  s_add_u32 s29, s29, 89128960
  s_lshl_b32 s28, s20, 6
  s_add_u32 s28, s28, s24
  s_lshl_b32 s28, s28, 15
  s_add_u32 s28, s28, 93323264
  s_waitcnt lgkmcnt(0)
  s_barrier
  ds_read_b128 v[28:31], v45 offset:0
  ds_read_b128 v[32:35], v45 offset:16
  ds_read_b128 v[36:39], v45 offset:32
  ds_read_b128 v[40:43], v45 offset:48
  s_waitcnt lgkmcnt(0)
  v_add_f32 v28, v28, v36
  v_add_f32 v29, v29, v37
  v_add_f32 v30, v30, v38
  v_add_f32 v31, v31, v39
  v_add_f32 v32, v32, v40
  v_add_f32 v33, v33, v41
  v_add_f32 v34, v34, v42
  v_add_f32 v35, v35, v43
  v_add_f32 v28, v28, v32
  v_add_f32 v29, v29, v33
  v_add_f32 v30, v30, v34
  v_add_f32 v31, v31, v35
  v_add_f32 v28, v28, v30
  v_add_f32 v29, v29, v31
  v_mul_f32 v28, 0x3b000000, v28
  v_mul_f32 v29, 0x3b000000, v29
  v_fma_f32 v29, -v28, v28, v29
  v_max_f32 v29, 0, v29
  v_add_f32 v29, 0x3727c5ac, v29
  v_rsq_f32 v29, v29
  v_sub_f32 v68, v68, v28
  v_sub_f32 v69, v69, v28
  v_sub_f32 v70, v70, v28
  v_sub_f32 v71, v71, v28
  v_mul_f32 v68, v68, v29
  v_mul_f32 v69, v69, v29
  v_mul_f32 v70, v70, v29
  v_mul_f32 v71, v71, v29
  v_cvt_pk_bf16_f32 v68, v68, v69
  v_cvt_pk_bf16_f32 v69, v70, v71
  s_mov_b64 exec, s[94:95]
  s_cmp_eq_u32 s7, 0
  s_cbranch_scc0 L_xs_232
  buffer_store_dwordx2 v[68:69], v13, s[8:11], s29 offen
  buffer_store_dwordx2 v[64:65], v11, s[8:11], s28 offen
  s_branch L_xe_233
L_xs_232:
  buffer_store_dwordx2 v[68:69], v13, s[8:11], s29 offen sc1
  buffer_store_dwordx2 v[64:65], v11, s[8:11], s28 offen sc1
L_xe_233:
  s_mov_b64 exec, -1
  s_lshl_b32 s27, s20, 6
  s_add_u32 s27, s27, s24
  s_lshl_b32 s27, s27, 7
  s_add_u32 s27, s27, 327680
  s_lshl_b32 s31, s5, 2
  s_add_u32 s27, s27, s31
  s_waitcnt vmcnt(0)
  s_barrier
  s_cmp_eq_u32 s4, 0
  s_cbranch_scc0 L_sf_234
  v_mov_b32 v14, 1
  s_mov_b64 exec, 1
  s_cmp_eq_u32 s7, 0
  s_cbranch_scc0 L_xs_235
  buffer_store_dword v14, v1, s[8:11], s27 offen
  s_branch L_xe_236
L_xs_235:
  buffer_store_dword v14, v1, s[8:11], s27 offen sc1
L_xe_236:
  s_mov_b64 exec, -1
L_sf_234:
  s_add_u32 s24, s24, 7
  s_cmp_lt_u32 s21, 64
  s_cbranch_scc1 W_C
  s_lshl_b32 s30, s34, 2
  s_add_u32 s30, s30, s4
  s_mul_i32 s30, s30, 36864
  s_add_u32 s30, s30, 118489088
  s_mul_i32 s37, s5, 147456
  s_sub_u32 s37, s30, s37
  s_mov_b32 s31, s34
  s_add_u32 s27, s37, 12288
  buffer_load_dwordx4 v[112:115], v1, s[8:11], s27 offen offset:0 sc1
  s_add_u32 s27, s37, 12288
  buffer_load_dwordx4 v[116:119], v1, s[8:11], s27 offen offset:1024 sc1
  s_add_u32 s27, s37, 12288
  buffer_load_dwordx4 v[120:123], v1, s[8:11], s27 offen offset:2048 sc1
  s_add_u32 s27, s37, 12288
  buffer_load_dwordx4 v[124:127], v1, s[8:11], s27 offen offset:3072 sc1
  s_add_u32 s27, s37, 4096
  buffer_load_dwordx4 v[88:91], v1, s[8:11], s27 offen offset:2048 sc1
  s_add_u32 s27, s37, 4096
  buffer_load_dwordx4 v[92:95], v1, s[8:11], s27 offen offset:3072 sc1
  s_add_u32 s27, s37, 8192
  buffer_load_dwordx4 v[96:99], v1, s[8:11], s27 offen offset:0 sc1
  s_add_u32 s27, s37, 8192
  buffer_load_dwordx4 v[100:103], v1, s[8:11], s27 offen offset:1024 sc1
  s_add_u32 s27, s37, 8192
  buffer_load_dwordx4 v[104:107], v1, s[8:11], s27 offen offset:2048 sc1
  s_add_u32 s27, s37, 8192
  buffer_load_dwordx4 v[108:111], v1, s[8:11], s27 offen offset:3072 sc1
  v_lshrrev_b32 v32, 8, v1
  v_bfe_u32 v33, v1, 4, 4
  v_lshrrev_b32 v34, 2, v33
  v_and_b32 v35, 3, v33
  v_lshl_add_u32 v28, v32, 3, v34
  v_lshlrev_b32 v20, 7, v28
  v_lshl_add_u32 v20, v35, 3, v20
  s_lshl_b32 s28, s4, 5
  v_add_u32 v20, s28, v20
  v_mul_u32_u24 v25, 40, v28
  v_lshl_add_u32 v25, v35, 3, v25
  s_mul_i32 s29, s4, 2560
  v_add_u32 v25, s29, v25
  v_mul_u32_u24 v24, 40, v33
  v_lshl_add_u32 v24, v32, 3, v24
  v_add_u32 v24, s29, v24
  v_mul_u32_u24 v21, 72, v33
  v_lshl_add_u32 v21, v32, 3, v21
  s_mul_i32 s29, s4, 1152
  v_add_u32 v21, s29, v21
  v_lshl_add_u32 v28, v32, 2, v34
  v_mul_u32_u24 v22, 72, v28
  v_lshl_add_u32 v22, v35, 3, v22
  s_lshr_b32 s29, s4, 1
  s_lshl_b32 s29, s29, 10
  v_add_u32 v23, s29, v1
  s_and_b32 s29, s4, 1
  s_lshl_b32 s29, s29, 3
  v_add_u32 v23, s29, v23
  v_mul_u32_u24 v26, 0x90, v33
  v_lshl_add_u32 v26, v32, 3, v26
  v_add_u32 v26, s28, v26
  v_lshrrev_b32 v28, 7, v1
  v_mul_u32_u24 v27, 0x90, v28
  v_and_b32 v28, 0x70, v1
  v_add_u32 v27, v27, v28
  s_mul_i32 s29, s4, 2304
  v_add_u32 v27, s29, v27
  v_lshrrev_b32 v0, 6, v1
  v_lshlrev_b32 v0, 15, v0
  v_and_b32 v28, 0x30, v1
  v_add_u32 v0, v0, v28
  s_and_b32 s29, s4, 1
  s_lshl_b32 s29, s29, 20
  s_lshr_b32 s28, s4, 1
  s_lshl_b32 s28, s28, 6
  s_add_u32 s29, s29, s28
  s_lshl_b32 s28, s31, 7
  s_add_u32 s29, s29, s28
  s_lshl_b32 s28, s20, 21
  s_add_u32 s29, s29, s28
  v_add_u32 v0, s29, v0
  s_branch W_C
W_dftd:
  s_lshl_b32 s30, s34, 2
  s_add_u32 s30, s30, s4
  s_mul_i32 s30, s30, 36864
  s_add_u32 s30, s30, 118489088
  s_add_u32 s30, s30, 32768
  buffer_load_dwordx4 v[64:67], v1, s[8:11], s30 offen offset:0 sc1
  buffer_load_dwordx4 v[68:71], v1, s[8:11], s30 offen offset:1024 sc1
  buffer_load_dwordx4 v[72:75], v1, s[8:11], s30 offen offset:2048 sc1
  buffer_load_dwordx4 v[76:79], v1, s[8:11], s30 offen offset:3072 sc1
  v_lshrrev_b32 v28, 4, v1
  v_bfe_u32 v29, v28, 1, 2
  v_lshlrev_b32 v29, 8, v29
  v_and_b32 v30, 1, v28
  v_lshl_add_u32 v29, v30, 3, v29
  v_lshrrev_b32 v30, 3, v28
  v_lshl_add_u32 v30, v30, 4, v29
  s_lshr_b32 s28, s4, 1
  s_lshl_b32 s28, s28, 10
  s_and_b32 s29, s4, 1
  s_lshl_b32 s29, s29, 7
  s_add_u32 s28, s28, s29
  s_add_u32 s28, s28, 0
  v_add_u32 v30, s28, v30
  s_lshl_b32 s28, s4, 11
  s_add_u32 s28, s28, 0
  v_add_u32 v29, s28, v1
  v_lshrrev_b32 v31, 3, v28
  v_lshlrev_b32 v31, 12, v31
  v_and_b32 v28, 7, v28
  v_lshl_add_u32 v31, v28, 2, v31
  s_lshl_b32 s27, s20, 6
  s_add_u32 s27, s27, s22
  s_lshl_b32 s27, s27, 7
  s_add_u32 s27, s27, 327680
  v_lshrrev_b32 v15, 2, v1
  v_and_b32 v15, 0x7c, v15
L_wf_237:
  buffer_load_dword v14, v15, s[8:11], s27 offen sc1
  s_waitcnt vmcnt(0)
  v_cmp_eq_u32 vcc, 0, v14
  s_cbranch_vccz L_wf_237_ok
  s_add_u32 s39, s39, 1
  s_cmp_gt_u32 s39, 0x10000
  s_cbranch_scc1 L_abort
  s_branch L_wf_237
L_wf_237_ok:
  s_barrier
  s_cmp_eq_u32 s32, 0
  s_cbranch_scc1 L_fp_238
  s_cmp_eq_u32 s4, 0
  s_cbranch_scc0 L_fp_238_z
  v_mov_b32 v14, 1
  s_mov_b64 exec, 1
  buffer_store_dword v14, v1, s[8:11], s32 offen sc1
  s_mov_b64 exec, -1
L_fp_238_z:
  s_mov_b32 s32, 0
L_fp_238:
  s_lshl_b32 s27, s20, 6
  s_add_u32 s27, s27, s22
  s_lshl_b32 s27, s27, 15
  s_add_u32 s27, s27, 89128960
  s_lshl_b32 s28, s4, 13
  s_add_u32 s27, s27, s28
  buffer_load_dwordx4 v[32:35], v1, s[8:11], s27 offen offset:0 sc1
  buffer_load_dwordx4 v[36:39], v1, s[8:11], s27 offen offset:1024 sc1
  buffer_load_dwordx4 v[40:43], v1, s[8:11], s27 offen offset:2048 sc1
  buffer_load_dwordx4 v[44:47], v1, s[8:11], s27 offen offset:3072 sc1
  s_add_u32 s27, s27, 4096
  buffer_load_dwordx4 v[48:51], v1, s[8:11], s27 offen offset:0 sc1
  buffer_load_dwordx4 v[52:55], v1, s[8:11], s27 offen offset:1024 sc1
  buffer_load_dwordx4 v[56:59], v1, s[8:11], s27 offen offset:2048 sc1
  buffer_load_dwordx4 v[60:63], v1, s[8:11], s27 offen offset:3072 sc1
  s_lshl_b32 s27, s20, 5
  s_add_u32 s27, s27, s5
  s_lshl_b32 s30, s27, 6
  s_add_u32 s30, s30, s22
  s_lshl_b32 s30, s30, 2
  s_add_u32 s30, s30, 354304
  s_lshl_b32 s27, s27, 16
  s_and_b32 s28, s4, 1
  s_lshl_b32 s28, s28, 15
  s_add_u32 s27, s27, s28
  s_lshl_b32 s28, s22, 6
  s_add_u32 s27, s27, s28
  s_lshr_b32 s28, s4, 1
  s_lshl_b32 s28, s28, 5
  s_add_u32 s27, s27, s28
  s_add_u32 s27, s27, 163577856
  s_waitcnt vmcnt(7)
  v_mfma_f32_16x16x32_bf16 v[80:83], v[32:35], v[64:67], 0
  s_waitcnt vmcnt(6)
  v_mfma_f32_16x16x32_bf16 v[84:87], v[36:39], v[64:67], 0
  s_waitcnt vmcnt(5)
  v_mfma_f32_16x16x32_bf16 v[80:83], v[40:43], v[68:71], v[80:83]
  s_waitcnt vmcnt(4)
  v_mfma_f32_16x16x32_bf16 v[84:87], v[44:47], v[68:71], v[84:87]
  s_waitcnt vmcnt(3)
  v_mfma_f32_16x16x32_bf16 v[80:83], v[48:51], v[72:75], v[80:83]
  s_waitcnt vmcnt(2)
  v_mfma_f32_16x16x32_bf16 v[84:87], v[52:55], v[72:75], v[84:87]
  s_waitcnt vmcnt(1)
  v_mfma_f32_16x16x32_bf16 v[80:83], v[56:59], v[76:79], v[80:83]
  s_waitcnt vmcnt(0)
  v_mfma_f32_16x16x32_bf16 v[84:87], v[60:63], v[76:79], v[84:87]
  s_nop 5
  ds_write_b128 v29, v[80:83] offset:0
  s_nop 0
  ds_write_b128 v29, v[84:87] offset:1024
  s_waitcnt lgkmcnt(0)
  s_barrier
  ds_read_b64 v[32:33], v30 offset:0
  ds_read_b64 v[34:35], v30 offset:2048
  ds_read_b64 v[36:37], v30 offset:4096
  ds_read_b64 v[38:39], v30 offset:6144
  s_waitcnt lgkmcnt(0)
  v_add_f32 v32, v32, v34
  v_add_f32 v36, v36, v38
  v_add_f32 v33, v33, v35
  v_add_f32 v37, v37, v39
  v_add_f32 v32, v32, v36
  v_add_f32 v33, v33, v37
  v_cvt_pk_bf16_f32 v32, v32, v33
  buffer_store_dword v32, v31, s[8:11], s27 offen sc1
  s_mov_b32 s32, s30
  s_barrier
  s_cmp_lt_u32 s22, 57
  s_cbranch_scc1 W_dl
  s_cmp_eq_u32 s32, 0
  s_cbranch_scc1 L_fp_239
  s_cmp_eq_u32 s4, 0
  s_cbranch_scc0 L_fp_239_z
  v_mov_b32 v14, 1
  s_mov_b64 exec, 1
  buffer_store_dword v14, v1, s[8:11], s32 offen sc1
  s_mov_b64 exec, -1
L_fp_239_z:
  s_mov_b32 s32, 0
L_fp_239:
W_dl:
  s_add_u32 s22, s22, 7
  s_branch W_C
W_Cend:
  s_waitcnt vmcnt(0)
  s_barrier
  s_cmp_eq_u32 s32, 0
  s_cbranch_scc1 L_fp_240
  s_cmp_eq_u32 s4, 0
  s_cbranch_scc0 L_fp_240_z
  v_mov_b32 v14, 1
  s_mov_b64 exec, 1
  buffer_store_dword v14, v1, s[8:11], s32 offen sc1
  s_mov_b64 exec, -1
L_fp_240_z:
  s_mov_b32 s32, 0
L_fp_240:
  s_lshl_b32 s30, s34, 2
  s_add_u32 s30, s30, s4
  s_mul_i32 s30, s30, 36864
  s_add_u32 s30, s30, 118489088
  s_mul_i32 s37, s5, 147456
  s_sub_u32 s37, s30, s37
  s_mov_b32 s31, s34
  s_add_u32 s27, s37, 0
  buffer_load_dwordx4 v[64:67], v1, s[8:11], s27 offen offset:0 sc1
  s_add_u32 s27, s37, 0
  buffer_load_dwordx4 v[68:71], v1, s[8:11], s27 offen offset:1024 sc1
  s_add_u32 s27, s37, 0
  buffer_load_dwordx4 v[72:75], v1, s[8:11], s27 offen offset:2048 sc1
  s_add_u32 s27, s37, 0
  buffer_load_dwordx4 v[76:79], v1, s[8:11], s27 offen offset:3072 sc1
  s_add_u32 s27, s37, 4096
  buffer_load_dwordx4 v[80:83], v1, s[8:11], s27 offen offset:0 sc1
  s_add_u32 s27, s37, 4096
  buffer_load_dwordx4 v[84:87], v1, s[8:11], s27 offen offset:1024 sc1
  s_lshl_b32 s28, s20, 8
  s_add_u32 s31, s31, s28
  s_cmp_eq_u32 s4, 1
  s_cbranch_scc0 L_zf_241_ok
  s_lshr_b32 s27, s31, 3
  s_lshl_b32 s27, s27, 8
  s_add_u32 s27, s27, 354304
  v_lshrrev_b32 v28, 2, v1
L_zf_241:
  buffer_load_dword v29, v28, s[8:11], s27 offen sc1
  s_waitcnt vmcnt(0)
  v_cmp_eq_u32 vcc, 0, v29
  s_cbranch_vccz L_zf_241_ok
  s_add_u32 s39, s39, 1
  s_cmp_gt_u32 s39, 0x10000
  s_cbranch_scc1 L_abort
  s_sleep 1
  s_branch L_zf_241
L_zf_241_ok:
  s_lshl_b32 s29, s31, 13
  s_lshl_b32 s28, s4, 11
  s_add_u32 s29, s29, s28
  s_add_u32 s27, s29, 163577856
  s_add_u32 m0, s28, 0
  s_mov_b32 s91, 0
L_zf_241_z:
  s_barrier
  s_add_u32 s27, s29, 163577856
  buffer_load_dwordx4 v1, s[8:11], s27 offen sc1 lds
  buffer_load_dwordx4 v1, s[8:11], s27 offen offset:1024 sc1 lds
  s_waitcnt vmcnt(0)
  s_barrier
  ds_read_b64_tr_b16 v[48:49], v20 offset:0
  ds_read_b64_tr_b16 v[50:51], v20 offset:512
  ds_read_b64_tr_b16 v[52:53], v20 offset:4096
  ds_read_b64_tr_b16 v[54:55], v20 offset:4608
  s_waitcnt lgkmcnt(0)
  v_mfma_f32_16x16x32_bf16 v[32:35], v[64:67], v[48:51], 0
  v_mfma_f32_16x16x32_bf16 v[40:43], v[64:67], v[52:55], 0
  v_mfma_f32_16x16x32_bf16 v[36:39], v[68:71], v[48:51], 0
  v_mfma_f32_16x16x32_bf16 v[44:47], v[68:71], v[52:55], 0
  v_mfma_f32_16x16x32_bf16 v[32:35], v[72:75], v[52:55], v[32:35]
  v_mfma_f32_16x16x32_bf16 v[40:43], v[80:83], v[48:51], v[40:43]
  v_mfma_f32_16x16x32_bf16 v[36:39], v[76:79], v[52:55], v[36:39]
  v_mfma_f32_16x16x32_bf16 v[44:47], v[84:87], v[48:51], v[44:47]
  s_nop 3
  v_cmp_u_f32 vcc, v32, v40
  s_nop 1
  v_cndmask_b32 v56, 0, 1, vcc
  v_pk_mul_f32 v[28:29], v[32:33], v[112:113]
  v_pk_mul_f32 v[30:31], v[40:41], v[112:113]
  v_pk_fma_f32 v[28:29], v[40:41], v[120:121], v[28:29]
  v_pk_fma_f32 v[30:31], v[32:33], v[120:121], v[30:31] neg_lo:[1,0,0] neg_hi:[1,0,0]
  v_cvt_pk_bf16_f32 v32, v28, v29
  v_cvt_pk_bf16_f32 v40, v30, v31
  v_pk_mul_f32 v[28:29], v[34:35], v[114:115]
  v_pk_mul_f32 v[30:31], v[42:43], v[114:115]
  v_pk_fma_f32 v[28:29], v[42:43], v[122:123], v[28:29]
  v_pk_fma_f32 v[30:31], v[34:35], v[122:123], v[30:31] neg_lo:[1,0,0] neg_hi:[1,0,0]
  v_cvt_pk_bf16_f32 v33, v28, v29
  v_cvt_pk_bf16_f32 v41, v30, v31
  v_pk_mul_f32 v[28:29], v[36:37], v[116:117]
  v_pk_mul_f32 v[30:31], v[44:45], v[116:117]
  v_pk_fma_f32 v[28:29], v[44:45], v[124:125], v[28:29]
  v_pk_fma_f32 v[30:31], v[36:37], v[124:125], v[30:31] neg_lo:[1,0,0] neg_hi:[1,0,0]
  v_cvt_pk_bf16_f32 v34, v28, v29
  v_cvt_pk_bf16_f32 v42, v30, v31
  v_pk_mul_f32 v[28:29], v[38:39], v[118:119]
  v_pk_mul_f32 v[30:31], v[46:47], v[118:119]
  v_pk_fma_f32 v[28:29], v[46:47], v[126:127], v[28:29]
  v_pk_fma_f32 v[30:31], v[38:39], v[126:127], v[30:31] neg_lo:[1,0,0] neg_hi:[1,0,0]
  v_cvt_pk_bf16_f32 v35, v28, v29
  v_cvt_pk_bf16_f32 v43, v30, v31
  ds_write_b64 v21, v[32:33] offset:10240
  ds_write_b64 v21, v[34:35] offset:10272
  ds_write_b64 v21, v[40:41] offset:14848
  ds_write_b64 v21, v[42:43] offset:14880
  s_lshl_b32 s27, s4, 6
  v_lshrrev_b32 v57, 4, v1
  v_add_u32 v58, s27, v57
  ds_write_b8 v58, v56 offset:27648
  s_add_u32 s27, s30, 20480
  buffer_load_dwordx4 v[112:115], v1, s[8:11], s27 offen offset:0 sc1
  s_add_u32 s27, s30, 20480
  buffer_load_dwordx4 v[116:119], v1, s[8:11], s27 offen offset:1024 sc1
  s_add_u32 s27, s30, 20480
  buffer_load_dwordx4 v[120:123], v1, s[8:11], s27 offen offset:2048 sc1
  s_add_u32 s27, s30, 20480
  buffer_load_dwordx4 v[124:127], v1, s[8:11], s27 offen offset:3072 sc1
  v_lshlrev_b32 v57, 2, v57
  s_waitcnt lgkmcnt(0)
  s_barrier
  ds_read_b32 v28, v57 offset:27648
  ds_read_b64_tr_b16 v[48:49], v22 offset:10240
  ds_read_b64_tr_b16 v[50:51], v22 offset:11392
  ds_read_b64_tr_b16 v[56:57], v22 offset:14848
  ds_read_b64_tr_b16 v[58:59], v22 offset:16000
  ds_read_b64_tr_b16 v[52:53], v22 offset:12544
  ds_read_b64_tr_b16 v[54:55], v22 offset:13696
  ds_read_b64_tr_b16 v[60:61], v22 offset:17152
  ds_read_b64_tr_b16 v[62:63], v22 offset:18304
  s_waitcnt lgkmcnt(4)
  v_cmp_ne_u32 vcc, 0, v28
  s_cbranch_vccz L_zf_241_g
  s_add_u32 s91, s91, 1
  s_cmp_lt_u32 s91, 200
  s_cbranch_scc0 L_zf_241_g
  s_waitcnt vmcnt(0) lgkmcnt(0)
  s_add_u32 s27, s37, 12288
  buffer_load_dwordx4 v[112:115], v1, s[8:11], s27 offen offset:0 sc1
  s_add_u32 s27, s37, 12288
  buffer_load_dwordx4 v[116:119], v1, s[8:11], s27 offen offset:1024 sc1
  s_add_u32 s27, s37, 12288
  buffer_load_dwordx4 v[120:123], v1, s[8:11], s27 offen offset:2048 sc1
  s_add_u32 s27, s37, 12288
  buffer_load_dwordx4 v[124:127], v1, s[8:11], s27 offen offset:3072 sc1
  s_branch L_zf_241_z
L_zf_241_g:
  v_mfma_f32_16x16x32_bf16 v[32:35], v[88:91], v[48:51], 0
  v_mfma_f32_16x16x32_bf16 v[40:43], v[88:91], v[56:59], 0
  v_mfma_f32_16x16x32_bf16 v[32:35], v[96:99], v[56:59], v[32:35]
  v_mfma_f32_16x16x32_bf16 v[40:43], v[104:107], v[48:51], v[40:43]
  ds_read_b64_tr_b16 v[48:49], v22 offset:10272
  ds_read_b64_tr_b16 v[50:51], v22 offset:11424
  ds_read_b64_tr_b16 v[56:57], v22 offset:14880
  ds_read_b64_tr_b16 v[58:59], v22 offset:16032
  s_waitcnt lgkmcnt(4)
  v_mfma_f32_16x16x32_bf16 v[32:35], v[92:95], v[52:55], v[32:35]
  v_mfma_f32_16x16x32_bf16 v[40:43], v[92:95], v[60:63], v[40:43]
  v_mfma_f32_16x16x32_bf16 v[32:35], v[100:103], v[60:63], v[32:35]
  v_mfma_f32_16x16x32_bf16 v[40:43], v[108:111], v[52:55], v[40:43]
  ds_read_b64_tr_b16 v[52:53], v22 offset:12576
  ds_read_b64_tr_b16 v[54:55], v22 offset:13728
  ds_read_b64_tr_b16 v[60:61], v22 offset:17184
  ds_read_b64_tr_b16 v[62:63], v22 offset:18336
  s_waitcnt lgkmcnt(4)
  v_mfma_f32_16x16x32_bf16 v[36:39], v[88:91], v[48:51], 0
  v_mfma_f32_16x16x32_bf16 v[44:47], v[88:91], v[56:59], 0
  v_mfma_f32_16x16x32_bf16 v[36:39], v[96:99], v[56:59], v[36:39]
  v_mfma_f32_16x16x32_bf16 v[44:47], v[104:107], v[48:51], v[44:47]
  s_waitcnt lgkmcnt(0)
  v_mfma_f32_16x16x32_bf16 v[36:39], v[92:95], v[52:55], v[36:39]
  v_mfma_f32_16x16x32_bf16 v[44:47], v[92:95], v[60:63], v[44:47]
  v_mfma_f32_16x16x32_bf16 v[36:39], v[100:103], v[60:63], v[36:39]
  v_mfma_f32_16x16x32_bf16 v[44:47], v[108:111], v[52:55], v[44:47]
  s_waitcnt vmcnt(0)
  v_pk_mul_f32 v[28:29], v[32:33], v[112:113]
  v_pk_mul_f32 v[30:31], v[40:41], v[112:113]
  v_pk_fma_f32 v[28:29], v[40:41], v[120:121], v[28:29] neg_lo:[1,0,0] neg_hi:[1,0,0]
  v_pk_fma_f32 v[30:31], v[32:33], v[120:121], v[30:31]
  v_cvt_pk_bf16_f32 v32, v28, v29
  v_cvt_pk_bf16_f32 v40, -v30, -v31
  v_pk_mul_f32 v[28:29], v[34:35], v[114:115]
  v_pk_mul_f32 v[30:31], v[42:43], v[114:115]
  v_pk_fma_f32 v[28:29], v[42:43], v[122:123], v[28:29] neg_lo:[1,0,0] neg_hi:[1,0,0]
  v_pk_fma_f32 v[30:31], v[34:35], v[122:123], v[30:31]
  v_cvt_pk_bf16_f32 v33, v28, v29
  v_cvt_pk_bf16_f32 v41, -v30, -v31
  v_pk_mul_f32 v[28:29], v[36:37], v[116:117]
  v_pk_mul_f32 v[30:31], v[44:45], v[116:117]
  v_pk_fma_f32 v[28:29], v[44:45], v[124:125], v[28:29] neg_lo:[1,0,0] neg_hi:[1,0,0]
  v_pk_fma_f32 v[30:31], v[36:37], v[124:125], v[30:31]
  v_cvt_pk_bf16_f32 v34, v28, v29
  v_cvt_pk_bf16_f32 v42, -v30, -v31
  v_pk_mul_f32 v[28:29], v[38:39], v[118:119]
  v_pk_mul_f32 v[30:31], v[46:47], v[118:119]
  v_pk_fma_f32 v[28:29], v[46:47], v[126:127], v[28:29] neg_lo:[1,0,0] neg_hi:[1,0,0]
  v_pk_fma_f32 v[30:31], v[38:39], v[126:127], v[30:31]
  v_cvt_pk_bf16_f32 v35, v28, v29
  v_cvt_pk_bf16_f32 v43, -v30, -v31
  ds_write_b64 v23, v[32:33] offset:19456
  ds_write_b64 v23, v[34:35] offset:23552
  ds_write_b64 v23, v[40:41] offset:21504
  ds_write_b64 v23, v[42:43] offset:25600
  s_add_u32 s27, s37, 16384
  buffer_load_dwordx4 v[112:115], v1, s[8:11], s27 offen offset:0 sc1
  s_add_u32 s27, s37, 16384
  buffer_load_dwordx4 v[116:119], v1, s[8:11], s27 offen offset:1024 sc1
  s_add_u32 s27, s37, 16384
  buffer_load_dwordx4 v[120:123], v1, s[8:11], s27 offen offset:2048 sc1
  s_add_u32 s27, s37, 16384
  buffer_load_dwordx4 v[124:127], v1, s[8:11], s27 offen offset:3072 sc1
  s_waitcnt lgkmcnt(0)
  s_barrier
  ds_read_b128 v[48:51], v1 offset:19456
  ds_read_b128 v[56:59], v1 offset:21504
  ds_read_b128 v[52:55], v1 offset:20480
  ds_read_b128 v[60:63], v1 offset:22528
  s_waitcnt lgkmcnt(2)
  v_mfma_f32_16x16x32_bf16 v[32:35], v[88:91], v[48:51], 0
  v_mfma_f32_16x16x32_bf16 v[40:43], v[88:91], v[56:59], 0
  v_mfma_f32_16x16x32_bf16 v[32:35], v[96:99], v[56:59], v[32:35]
  v_mfma_f32_16x16x32_bf16 v[40:43], v[104:107], v[48:51], v[40:43]
  ds_read_b128 v[48:51], v1 offset:23552
  ds_read_b128 v[56:59], v1 offset:25600
  s_waitcnt lgkmcnt(2)
  v_mfma_f32_16x16x32_bf16 v[32:35], v[92:95], v[52:55], v[32:35]
  v_mfma_f32_16x16x32_bf16 v[40:43], v[92:95], v[60:63], v[40:43]
  v_mfma_f32_16x16x32_bf16 v[32:35], v[100:103], v[60:63], v[32:35]
  v_mfma_f32_16x16x32_bf16 v[40:43], v[108:111], v[52:55], v[40:43]
  ds_read_b128 v[52:55], v1 offset:24576
  ds_read_b128 v[60:63], v1 offset:26624
  s_waitcnt lgkmcnt(2)
  v_mfma_f32_16x16x32_bf16 v[36:39], v[88:91], v[48:51], 0
  v_mfma_f32_16x16x32_bf16 v[44:47], v[88:91], v[56:59], 0
  v_mfma_f32_16x16x32_bf16 v[36:39], v[96:99], v[56:59], v[36:39]
  v_mfma_f32_16x16x32_bf16 v[44:47], v[104:107], v[48:51], v[44:47]
  s_waitcnt lgkmcnt(0)
  v_mfma_f32_16x16x32_bf16 v[36:39], v[92:95], v[52:55], v[36:39]
  v_mfma_f32_16x16x32_bf16 v[44:47], v[92:95], v[60:63], v[44:47]
  v_mfma_f32_16x16x32_bf16 v[36:39], v[100:103], v[60:63], v[36:39]
  v_mfma_f32_16x16x32_bf16 v[44:47], v[108:111], v[52:55], v[44:47]
  s_waitcnt vmcnt(0)
  v_pk_mul_f32 v[28:29], v[32:33], v[112:113]
  v_pk_mul_f32 v[30:31], v[40:41], v[112:113]
  v_pk_fma_f32 v[28:29], v[40:41], v[120:121], v[28:29]
  v_pk_fma_f32 v[30:31], v[32:33], v[120:121], v[30:31] neg_lo:[1,0,0] neg_hi:[1,0,0]
  v_cvt_pk_bf16_f32 v32, v28, v29
  v_cvt_pk_bf16_f32 v40, v30, v31
  v_pk_mul_f32 v[28:29], v[34:35], v[114:115]
  v_pk_mul_f32 v[30:31], v[42:43], v[114:115]
  v_pk_fma_f32 v[28:29], v[42:43], v[122:123], v[28:29]
  v_pk_fma_f32 v[30:31], v[34:35], v[122:123], v[30:31] neg_lo:[1,0,0] neg_hi:[1,0,0]
  v_cvt_pk_bf16_f32 v33, v28, v29
  v_cvt_pk_bf16_f32 v41, v30, v31
  v_pk_mul_f32 v[28:29], v[36:37], v[116:117]
  v_pk_mul_f32 v[30:31], v[44:45], v[116:117]
  v_pk_fma_f32 v[28:29], v[44:45], v[124:125], v[28:29]
  v_pk_fma_f32 v[30:31], v[36:37], v[124:125], v[30:31] neg_lo:[1,0,0] neg_hi:[1,0,0]
  v_cvt_pk_bf16_f32 v34, v28, v29
  v_cvt_pk_bf16_f32 v42, v30, v31
  v_pk_mul_f32 v[28:29], v[38:39], v[118:119]
  v_pk_mul_f32 v[30:31], v[46:47], v[118:119]
  v_pk_fma_f32 v[28:29], v[46:47], v[126:127], v[28:29]
  v_pk_fma_f32 v[30:31], v[38:39], v[126:127], v[30:31] neg_lo:[1,0,0] neg_hi:[1,0,0]
  v_cvt_pk_bf16_f32 v35, v28, v29
  v_cvt_pk_bf16_f32 v43, v30, v31
  ds_write_b64 v24, v[32:33] offset:0
  ds_write_b64 v24, v[34:35] offset:640
  ds_write_b64 v24, v[40:41] offset:1280
  ds_write_b64 v24, v[42:43] offset:1920
  ds_read_b64_tr_b16 v[48:49], v25 offset:0
  ds_read_b64_tr_b16 v[50:51], v25 offset:160
  ds_read_b64_tr_b16 v[52:53], v25 offset:1280
  ds_read_b64_tr_b16 v[54:55], v25 offset:1440
  s_waitcnt lgkmcnt(0)
  v_mfma_f32_16x16x32_bf16 v[32:35], v[48:51], v[64:67], 0
  v_mfma_f32_16x16x32_bf16 v[40:43], v[52:55], v[64:67], 0
  v_mfma_f32_16x16x32_bf16 v[36:39], v[48:51], v[68:71], 0
  v_mfma_f32_16x16x32_bf16 v[44:47], v[52:55], v[68:71], 0
  v_mfma_f32_16x16x32_bf16 v[32:35], v[52:55], v[72:75], v[32:35]
  v_mfma_f32_16x16x32_bf16 v[40:43], v[48:51], v[80:83], v[40:43]
  v_mfma_f32_16x16x32_bf16 v[36:39], v[52:55], v[76:79], v[36:39]
  v_mfma_f32_16x16x32_bf16 v[44:47], v[48:51], v[84:87], v[44:47]
  v_cvt_pk_bf16_f32 v32, v32, v33
  v_cvt_pk_bf16_f32 v33, v34, v35
  ds_write_b64 v26, v[32:33] offset:10240
  s_nop 3
  v_cvt_pk_bf16_f32 v36, v36, v37
  v_cvt_pk_bf16_f32 v37, v38, v39
  ds_write_b64 v26, v[36:37] offset:12544
  v_cvt_pk_bf16_f32 v40, -v40, -v41
  v_cvt_pk_bf16_f32 v41, -v42, -v43
  ds_write_b64 v26, v[40:41] offset:14848
  v_cvt_pk_bf16_f32 v44, -v44, -v45
  v_cvt_pk_bf16_f32 v45, -v46, -v47
  ds_write_b64 v26, v[44:45] offset:17152
  s_mov_b32 s27, 99614720
  s_mov_b32 s28, 100139008
  s_waitcnt lgkmcnt(0)
  s_barrier
  ds_read_b128 v[48:51], v27 offset:10240
  ds_read_b128 v[52:55], v27 offset:11392
  s_waitcnt lgkmcnt(1)
  buffer_store_dwordx4 v[48:51], v0, s[8:11], s27 offen sc1
  s_waitcnt lgkmcnt(0)
  buffer_store_dwordx4 v[52:55], v0, s[8:11], s28 offen sc1
  s_lshl_b32 s27, s31, 2
  s_add_u32 s27, s27, 352256
  v_mov_b32 v28, 1
  s_barrier
  s_cmp_eq_u32 s4, 0
  s_cbranch_scc0 L_zf_241_nf
  s_mov_b64 exec, 1
  buffer_store_dword v28, v1, s[8:11], s27 offen sc1
  s_mov_b64 exec, -1
L_zf_241_nf:
  s_cmp_eq_u32 s20, 0
  s_cbranch_scc0 L_zf_241_n2
  s_cmp_eq_u32 s4, 1
  s_add_u32 s32, s27, 24576
L_zf_241_n2:
  s_add_u32 s20, s20, 1
  s_cmp_lt_u32 s20, 2
  s_cbranch_scc1 W_layer
  v_lshrrev_b32 v20, 4, v1
  s_and_b32 s30, s5, 7
  s_lshl_b32 s30, s30, 2
  s_add_u32 s30, s30, s4
  v_and_b32 v24, 15, v20
  v_lshlrev_b32 v24, 10, v24
  v_lshrrev_b32 v21, 4, v20
  v_lshl_add_u32 v24, v21, 3, v24
  s_lshl_b32 s28, s30, 5
  v_add_u32 v24, s28, v24
  v_add_u32 v25, 0x4000, v24
  v_lshlrev_b32 v22, 9, v21
  v_bfe_u32 v21, v20, 2, 2
  v_lshl_add_u32 v22, v21, 6, v22
  v_and_b32 v21, 3, v20
  v_lshl_add_u32 v22, v21, 3, v22
  v_add_u32 v22, 32768, v22
  s_lshl_b32 s29, s6, 5
  s_add_u32 s29, s29, s30
  s_mul_i32 s29, s29, 147456
  s_add_u32 s29, s29, 118517760
  buffer_load_dwordx4 v[64:67], v1, s[8:11], s29 offen offset:0 sc1
  buffer_load_dwordx4 v[68:71], v1, s[8:11], s29 offen offset:1024 sc1
  buffer_load_dwordx4 v[72:75], v1, s[8:11], s29 offen offset:2048 sc1
  buffer_load_dwordx4 v[76:79], v1, s[8:11], s29 offen offset:3072 sc1
  s_add_u32 s29, s29, 36864
  buffer_load_dwordx4 v[80:83], v1, s[8:11], s29 offen offset:0 sc1
  buffer_load_dwordx4 v[84:87], v1, s[8:11], s29 offen offset:1024 sc1
  buffer_load_dwordx4 v[88:91], v1, s[8:11], s29 offen offset:2048 sc1
  buffer_load_dwordx4 v[92:95], v1, s[8:11], s29 offen offset:3072 sc1
  s_add_u32 s29, s29, 36864
  buffer_load_dwordx4 v[96:99], v1, s[8:11], s29 offen offset:0 sc1
  buffer_load_dwordx4 v[100:103], v1, s[8:11], s29 offen offset:1024 sc1
  buffer_load_dwordx4 v[104:107], v1, s[8:11], s29 offen offset:2048 sc1
  buffer_load_dwordx4 v[108:111], v1, s[8:11], s29 offen offset:3072 sc1
  s_add_u32 s29, s29, 36864
  buffer_load_dwordx4 v[112:115], v1, s[8:11], s29 offen offset:0 sc1
  buffer_load_dwordx4 v[116:119], v1, s[8:11], s29 offen offset:1024 sc1
  buffer_load_dwordx4 v[120:123], v1, s[8:11], s29 offen offset:2048 sc1
  buffer_load_dwordx4 v[124:127], v1, s[8:11], s29 offen offset:3072 sc1
  s_lshr_b32 s27, s5, 3
  s_mul_i32 s27, s27, 7
  s_add_u32 s36, s27, s6
  s_add_u32 s37, s36, 28
  s_add_u32 s91, s36, 56
  s_mov_b32 s92, 1
  s_cmp_eq_u32 s4, 1
  s_cbranch_scc0 L_wy_242_ok
  s_lshl_b32 s28, s92, 3
  s_add_u32 s28, s28, s6
  s_lshl_b32 s28, s28, 7
  s_add_u32 s28, s28, 372736
  s_cmp_eq_u32 s5, 0
  s_cbranch_scc0 L_wy_242_l
  s_lshl_b32 s27, s92, 10
  s_add_u32 s27, s27, 352256
L_wy_242:
  buffer_load_dwordx4 v[46:49], v1, s[8:11], s27 offen sc1
  s_waitcnt vmcnt(0)
  v_min_u32 v46, v46, v47
  v_min3_u32 v46, v46, v48, v49
  v_cmp_eq_u32 vcc, 0, v46
  s_cbranch_vccz L_wy_242_g
  s_add_u32 s39, s39, 1
  s_cmp_gt_u32 s39, 0x10000
  s_cbranch_scc1 L_abort
  s_branch L_wy_242
L_wy_242_g:
  s_mov_b64 exec, 1
  s_cmp_eq_u32 s7, 0
  s_cbranch_scc0 L_xs_243
  buffer_store_dword v46, v1, s[8:11], s28 offen
  s_branch L_xe_244
L_xs_243:
  buffer_store_dword v46, v1, s[8:11], s28 offen sc1
L_xe_244:
  s_mov_b64 exec, -1
  s_branch L_wy_242_ok
L_wy_242_l:
  v_mov_b32 v47, 0
L_wy_242_l2:
  buffer_load_dword v46, v47, s[8:11], s28 offen sc1
  s_waitcnt vmcnt(0)
  v_cmp_eq_u32 vcc, 0, v46
  s_cbranch_vccz L_wy_242_ok
  s_add_u32 s39, s39, 1
  s_cmp_gt_u32 s39, 0x10000
  s_cbranch_scc1 L_abort
  s_branch L_wy_242_l2
L_wy_242_ok:
  s_barrier
  s_lshl_b32 s29, s4, 13
  s_lshl_b32 s27, s36, 15
  s_add_u32 s27, s27, s29
  s_add_u32 s27, s27, 101711872
  s_add_u32 m0, s29, 32768
  s_add_u32 s27, s27, 0
  buffer_load_dwordx4 v1, s[8:11], s27 offen offset:0 sc1 lds
  buffer_load_dwordx4 v1, s[8:11], s27 offen offset:1024 sc1 lds
  buffer_load_dwordx4 v1, s[8:11], s27 offen offset:2048 sc1 lds
  buffer_load_dwordx4 v1, s[8:11], s27 offen offset:3072 sc1 lds
  s_add_u32 m0, s29, 36864
  s_add_u32 s27, s27, 4096
  buffer_load_dwordx4 v1, s[8:11], s27 offen offset:0 sc1 lds
  buffer_load_dwordx4 v1, s[8:11], s27 offen offset:1024 sc1 lds
  buffer_load_dwordx4 v1, s[8:11], s27 offen offset:2048 sc1 lds
  buffer_load_dwordx4 v1, s[8:11], s27 offen offset:3072 sc1 lds
  s_lshl_b32 s27, s36, 15
  s_add_u32 s27, s27, 95420416
  buffer_load_dwordx2 v[26:27], v24, s[8:11], s27 offen sc1
  buffer_load_dwordx2 v[28:29], v25, s[8:11], s27 offen sc1
  s_lshl_b32 s27, s37, 15
  s_add_u32 s27, s27, s29
  s_add_u32 s27, s27, 101711872
  s_add_u32 m0, s29, 65536
  s_add_u32 s27, s27, 0
  buffer_load_dwordx4 v1, s[8:11], s27 offen offset:0 sc1 lds
  buffer_load_dwordx4 v1, s[8:11], s27 offen offset:1024 sc1 lds
  buffer_load_dwordx4 v1, s[8:11], s27 offen offset:2048 sc1 lds
  buffer_load_dwordx4 v1, s[8:11], s27 offen offset:3072 sc1 lds
  s_add_u32 m0, s29, 69632
  s_add_u32 s27, s27, 4096
  buffer_load_dwordx4 v1, s[8:11], s27 offen offset:0 sc1 lds
  buffer_load_dwordx4 v1, s[8:11], s27 offen offset:1024 sc1 lds
  buffer_load_dwordx4 v1, s[8:11], s27 offen offset:2048 sc1 lds
  buffer_load_dwordx4 v1, s[8:11], s27 offen offset:3072 sc1 lds
  s_lshl_b32 s27, s37, 15
  s_add_u32 s27, s27, 95420416
  buffer_load_dwordx2 v[30:31], v24, s[8:11], s27 offen sc1
  buffer_load_dwordx2 v[32:33], v25, s[8:11], s27 offen sc1
  s_cmp_lt_u32 s91, 64
  s_cbranch_scc0 W_f2
  s_lshl_b32 s27, s91, 15
  s_add_u32 s27, s27, s29
  s_add_u32 s27, s27, 101711872
  s_add_u32 m0, s29, 98304
  s_add_u32 s27, s27, 0
  buffer_load_dwordx4 v1, s[8:11], s27 offen offset:0 sc1 lds
  buffer_load_dwordx4 v1, s[8:11], s27 offen offset:1024 sc1 lds
  buffer_load_dwordx4 v1, s[8:11], s27 offen offset:2048 sc1 lds
  buffer_load_dwordx4 v1, s[8:11], s27 offen offset:3072 sc1 lds
  s_add_u32 m0, s29, 102400
  s_add_u32 s27, s27, 4096
  buffer_load_dwordx4 v1, s[8:11], s27 offen offset:0 sc1 lds
  buffer_load_dwordx4 v1, s[8:11], s27 offen offset:1024 sc1 lds
  buffer_load_dwordx4 v1, s[8:11], s27 offen offset:2048 sc1 lds
  buffer_load_dwordx4 v1, s[8:11], s27 offen offset:3072 sc1 lds
  s_lshl_b32 s27, s91, 15
  s_add_u32 s27, s27, 95420416
  buffer_load_dwordx2 v[34:35], v24, s[8:11], s27 offen sc1
  buffer_load_dwordx2 v[36:37], v25, s[8:11], s27 offen sc1
  s_waitcnt vmcnt(20)
  s_branch W_f3
W_f2:
  s_waitcnt vmcnt(10)
W_f3:
  s_mov_b32 s30, 0
W_fr0:
  s_barrier
  ds_read_b64_tr_b16 v[46:47], v22 offset:0
  ds_read_b64_tr_b16 v[48:49], v22 offset:256
  ds_read_b64_tr_b16 v[50:51], v22 offset:32
  ds_read_b64_tr_b16 v[52:53], v22 offset:288
  ds_read_b64_tr_b16 v[54:55], v22 offset:2048
  ds_read_b64_tr_b16 v[56:57], v22 offset:2304
  ds_read_b64_tr_b16 v[58:59], v22 offset:2080
  ds_read_b64_tr_b16 v[60:61], v22 offset:2336
  s_waitcnt lgkmcnt(6)
  v_mfma_f32_16x16x32_bf16 v[38:41], v[64:67], v[46:49], 0
  ds_read_b64_tr_b16 v[46:47], v22 offset:4096
  ds_read_b64_tr_b16 v[48:49], v22 offset:4352
  s_waitcnt lgkmcnt(6)
  v_mfma_f32_16x16x32_bf16 v[42:45], v[64:67], v[50:53], 0
  ds_read_b64_tr_b16 v[50:51], v22 offset:4128
  ds_read_b64_tr_b16 v[52:53], v22 offset:4384
  s_waitcnt lgkmcnt(6)
  v_mfma_f32_16x16x32_bf16 v[38:41], v[68:71], v[54:57], v[38:41]
  ds_read_b64_tr_b16 v[54:55], v22 offset:6144
  ds_read_b64_tr_b16 v[56:57], v22 offset:6400
  s_waitcnt lgkmcnt(6)
  v_mfma_f32_16x16x32_bf16 v[42:45], v[68:71], v[58:61], v[42:45]
  ds_read_b64_tr_b16 v[58:59], v22 offset:6176
  ds_read_b64_tr_b16 v[60:61], v22 offset:6432
  s_waitcnt lgkmcnt(6)
  v_mfma_f32_16x16x32_bf16 v[38:41], v[72:75], v[46:49], v[38:41]
  ds_read_b64_tr_b16 v[46:47], v22 offset:8192
  ds_read_b64_tr_b16 v[48:49], v22 offset:8448
  s_waitcnt lgkmcnt(6)
  v_mfma_f32_16x16x32_bf16 v[42:45], v[72:75], v[50:53], v[42:45]
  ds_read_b64_tr_b16 v[50:51], v22 offset:8224
  ds_read_b64_tr_b16 v[52:53], v22 offset:8480
  s_waitcnt lgkmcnt(6)
  v_mfma_f32_16x16x32_bf16 v[38:41], v[76:79], v[54:57], v[38:41]
  ds_read_b64_tr_b16 v[54:55], v22 offset:10240
  ds_read_b64_tr_b16 v[56:57], v22 offset:10496
  s_waitcnt lgkmcnt(6)
  v_mfma_f32_16x16x32_bf16 v[42:45], v[76:79], v[58:61], v[42:45]
  ds_read_b64_tr_b16 v[58:59], v22 offset:10272
  ds_read_b64_tr_b16 v[60:61], v22 offset:10528
  s_waitcnt lgkmcnt(6)
  v_mfma_f32_16x16x32_bf16 v[38:41], v[80:83], v[46:49], v[38:41]
  ds_read_b64_tr_b16 v[46:47], v22 offset:12288
  ds_read_b64_tr_b16 v[48:49], v22 offset:12544
  s_waitcnt lgkmcnt(6)
  v_mfma_f32_16x16x32_bf16 v[42:45], v[80:83], v[50:53], v[42:45]
  ds_read_b64_tr_b16 v[50:51], v22 offset:12320
  ds_read_b64_tr_b16 v[52:53], v22 offset:12576
  s_waitcnt lgkmcnt(6)
  v_mfma_f32_16x16x32_bf16 v[38:41], v[84:87], v[54:57], v[38:41]
  ds_read_b64_tr_b16 v[54:55], v22 offset:14336
  ds_read_b64_tr_b16 v[56:57], v22 offset:14592
  s_waitcnt lgkmcnt(6)
  v_mfma_f32_16x16x32_bf16 v[42:45], v[84:87], v[58:61], v[42:45]
  ds_read_b64_tr_b16 v[58:59], v22 offset:14368
  ds_read_b64_tr_b16 v[60:61], v22 offset:14624
  s_waitcnt lgkmcnt(6)
  v_mfma_f32_16x16x32_bf16 v[38:41], v[88:91], v[46:49], v[38:41]
  ds_read_b64_tr_b16 v[46:47], v22 offset:16384
  ds_read_b64_tr_b16 v[48:49], v22 offset:16640
  s_waitcnt lgkmcnt(6)
  v_mfma_f32_16x16x32_bf16 v[42:45], v[88:91], v[50:53], v[42:45]
  ds_read_b64_tr_b16 v[50:51], v22 offset:16416
  ds_read_b64_tr_b16 v[52:53], v22 offset:16672
  s_waitcnt lgkmcnt(6)
  v_mfma_f32_16x16x32_bf16 v[38:41], v[92:95], v[54:57], v[38:41]
  ds_read_b64_tr_b16 v[54:55], v22 offset:18432
  ds_read_b64_tr_b16 v[56:57], v22 offset:18688
  s_waitcnt lgkmcnt(6)
  v_mfma_f32_16x16x32_bf16 v[42:45], v[92:95], v[58:61], v[42:45]
  ds_read_b64_tr_b16 v[58:59], v22 offset:18464
  ds_read_b64_tr_b16 v[60:61], v22 offset:18720
  s_waitcnt lgkmcnt(6)
  v_mfma_f32_16x16x32_bf16 v[38:41], v[96:99], v[46:49], v[38:41]
  ds_read_b64_tr_b16 v[46:47], v22 offset:20480
  ds_read_b64_tr_b16 v[48:49], v22 offset:20736
  s_waitcnt lgkmcnt(6)
  v_mfma_f32_16x16x32_bf16 v[42:45], v[96:99], v[50:53], v[42:45]
  ds_read_b64_tr_b16 v[50:51], v22 offset:20512
  ds_read_b64_tr_b16 v[52:53], v22 offset:20768
  s_waitcnt lgkmcnt(6)
  v_mfma_f32_16x16x32_bf16 v[38:41], v[100:103], v[54:57], v[38:41]
  ds_read_b64_tr_b16 v[54:55], v22 offset:22528
  ds_read_b64_tr_b16 v[56:57], v22 offset:22784
  s_waitcnt lgkmcnt(6)
  v_mfma_f32_16x16x32_bf16 v[42:45], v[100:103], v[58:61], v[42:45]
  ds_read_b64_tr_b16 v[58:59], v22 offset:22560
  ds_read_b64_tr_b16 v[60:61], v22 offset:22816
  s_waitcnt lgkmcnt(6)
  v_mfma_f32_16x16x32_bf16 v[38:41], v[104:107], v[46:49], v[38:41]
  ds_read_b64_tr_b16 v[46:47], v22 offset:24576
  ds_read_b64_tr_b16 v[48:49], v22 offset:24832
  s_waitcnt lgkmcnt(6)
  v_mfma_f32_16x16x32_bf16 v[42:45], v[104:107], v[50:53], v[42:45]
  ds_read_b64_tr_b16 v[50:51], v22 offset:24608
  ds_read_b64_tr_b16 v[52:53], v22 offset:24864
  s_waitcnt lgkmcnt(6)
  v_mfma_f32_16x16x32_bf16 v[38:41], v[108:111], v[54:57], v[38:41]
  ds_read_b64_tr_b16 v[54:55], v22 offset:26624
  ds_read_b64_tr_b16 v[56:57], v22 offset:26880
  s_waitcnt lgkmcnt(6)
  v_mfma_f32_16x16x32_bf16 v[42:45], v[108:111], v[58:61], v[42:45]
  ds_read_b64_tr_b16 v[58:59], v22 offset:26656
  ds_read_b64_tr_b16 v[60:61], v22 offset:26912
  s_waitcnt lgkmcnt(6)
  v_mfma_f32_16x16x32_bf16 v[38:41], v[112:115], v[46:49], v[38:41]
  ds_read_b64_tr_b16 v[46:47], v22 offset:28672
  ds_read_b64_tr_b16 v[48:49], v22 offset:28928
  s_waitcnt lgkmcnt(6)
  v_mfma_f32_16x16x32_bf16 v[42:45], v[112:115], v[50:53], v[42:45]
  ds_read_b64_tr_b16 v[50:51], v22 offset:28704
  ds_read_b64_tr_b16 v[52:53], v22 offset:28960
  s_waitcnt lgkmcnt(6)
  v_mfma_f32_16x16x32_bf16 v[38:41], v[116:119], v[54:57], v[38:41]
  ds_read_b64_tr_b16 v[54:55], v22 offset:30720
  ds_read_b64_tr_b16 v[56:57], v22 offset:30976
  s_waitcnt lgkmcnt(6)
  v_mfma_f32_16x16x32_bf16 v[42:45], v[116:119], v[58:61], v[42:45]
  ds_read_b64_tr_b16 v[58:59], v22 offset:30752
  ds_read_b64_tr_b16 v[60:61], v22 offset:31008
  s_waitcnt lgkmcnt(6)
  v_mfma_f32_16x16x32_bf16 v[38:41], v[120:123], v[46:49], v[38:41]
  s_waitcnt lgkmcnt(4)
  v_mfma_f32_16x16x32_bf16 v[42:45], v[120:123], v[50:53], v[42:45]
  s_waitcnt lgkmcnt(2)
  v_mfma_f32_16x16x32_bf16 v[38:41], v[124:127], v[54:57], v[38:41]
  s_waitcnt lgkmcnt(0)
  v_mfma_f32_16x16x32_bf16 v[42:45], v[124:127], v[58:61], v[42:45]
  s_lshl_b32 s28, s36, 15
  s_nop 6
  v_cmp_u_f32 vcc, v38, v42
  s_cbranch_vccz W_fo0
  s_add_u32 s30, s30, 1
  s_cmp_lt_u32 s30, 200
  s_cbranch_scc0 W_fo0
  s_barrier
  s_add_u32 s27, s28, s29
  s_add_u32 s27, s27, 101711872
  s_add_u32 m0, s29, 32768
  s_add_u32 s27, s27, 0
  buffer_load_dwordx4 v1, s[8:11], s27 offen offset:0 sc1 lds
  buffer_load_dwordx4 v1, s[8:11], s27 offen offset:1024 sc1 lds
  buffer_load_dwordx4 v1, s[8:11], s27 offen offset:2048 sc1 lds
  buffer_load_dwordx4 v1, s[8:11], s27 offen offset:3072 sc1 lds
  s_add_u32 m0, s29, 36864
  s_add_u32 s27, s27, 4096
  buffer_load_dwordx4 v1, s[8:11], s27 offen offset:0 sc1 lds
  buffer_load_dwordx4 v1, s[8:11], s27 offen offset:1024 sc1 lds
  buffer_load_dwordx4 v1, s[8:11], s27 offen offset:2048 sc1 lds
  buffer_load_dwordx4 v1, s[8:11], s27 offen offset:3072 sc1 lds
  s_waitcnt vmcnt(0)
  s_branch W_fr0
W_fo0:
  v_lshlrev_b32 v46, 16, v26
  v_and_b32 v47, 0xffff0000, v26
  v_lshlrev_b32 v48, 16, v27
  v_and_b32 v49, 0xffff0000, v27
  v_cvt_pk_bf16_f32 v38, v38, v39
  v_cvt_pk_bf16_f32 v39, v40, v41
  v_and_b32 v41, 0xffff0000, v39
  v_lshlrev_b32 v40, 16, v39
  v_and_b32 v39, 0xffff0000, v38
  v_lshlrev_b32 v38, 16, v38
  v_add_f32 v38, v38, v46
  v_add_f32 v39, v39, v47
  v_add_f32 v40, v40, v48
  v_add_f32 v41, v41, v49
  v_cvt_pk_bf16_f32 v26, v38, v39
  v_cvt_pk_bf16_f32 v27, v40, v41
  buffer_store_dwordx2 v[26:27], v24, s[16:19], s28 offen
  v_lshlrev_b32 v46, 16, v28
  v_and_b32 v47, 0xffff0000, v28
  v_lshlrev_b32 v48, 16, v29
  v_and_b32 v49, 0xffff0000, v29
  v_cvt_pk_bf16_f32 v42, v42, v43
  v_cvt_pk_bf16_f32 v43, v44, v45
  v_and_b32 v45, 0xffff0000, v43
  v_lshlrev_b32 v44, 16, v43
  v_and_b32 v43, 0xffff0000, v42
  v_lshlrev_b32 v42, 16, v42
  v_add_f32 v42, v42, v46
  v_add_f32 v43, v43, v47
  v_add_f32 v44, v44, v48
  v_add_f32 v45, v45, v49
  v_cvt_pk_bf16_f32 v28, v42, v43
  v_cvt_pk_bf16_f32 v29, v44, v45
  buffer_store_dwordx2 v[28:29], v25, s[16:19], s28 offen
  s_cmp_lt_u32 s91, 64
  s_cbranch_scc1 W_f4
  s_waitcnt vmcnt(2)
  s_branch W_f5
W_f4:
  s_waitcnt vmcnt(12)
W_f5:
  s_mov_b32 s30, 0
W_fr1:
  s_barrier
  ds_read_b64_tr_b16 v[46:47], v22 offset:32768
  ds_read_b64_tr_b16 v[48:49], v22 offset:33024
  ds_read_b64_tr_b16 v[50:51], v22 offset:32800
  ds_read_b64_tr_b16 v[52:53], v22 offset:33056
  ds_read_b64_tr_b16 v[54:55], v22 offset:34816
  ds_read_b64_tr_b16 v[56:57], v22 offset:35072
  ds_read_b64_tr_b16 v[58:59], v22 offset:34848
  ds_read_b64_tr_b16 v[60:61], v22 offset:35104
  s_waitcnt lgkmcnt(6)
  v_mfma_f32_16x16x32_bf16 v[38:41], v[64:67], v[46:49], 0
  ds_read_b64_tr_b16 v[46:47], v22 offset:36864
  ds_read_b64_tr_b16 v[48:49], v22 offset:37120
  s_waitcnt lgkmcnt(6)
  v_mfma_f32_16x16x32_bf16 v[42:45], v[64:67], v[50:53], 0
  ds_read_b64_tr_b16 v[50:51], v22 offset:36896
  ds_read_b64_tr_b16 v[52:53], v22 offset:37152
  s_waitcnt lgkmcnt(6)
  v_mfma_f32_16x16x32_bf16 v[38:41], v[68:71], v[54:57], v[38:41]
  ds_read_b64_tr_b16 v[54:55], v22 offset:38912
  ds_read_b64_tr_b16 v[56:57], v22 offset:39168
  s_waitcnt lgkmcnt(6)
  v_mfma_f32_16x16x32_bf16 v[42:45], v[68:71], v[58:61], v[42:45]
  ds_read_b64_tr_b16 v[58:59], v22 offset:38944
  ds_read_b64_tr_b16 v[60:61], v22 offset:39200
  s_waitcnt lgkmcnt(6)
  v_mfma_f32_16x16x32_bf16 v[38:41], v[72:75], v[46:49], v[38:41]
  ds_read_b64_tr_b16 v[46:47], v22 offset:40960
  ds_read_b64_tr_b16 v[48:49], v22 offset:41216
  s_waitcnt lgkmcnt(6)
  v_mfma_f32_16x16x32_bf16 v[42:45], v[72:75], v[50:53], v[42:45]
  ds_read_b64_tr_b16 v[50:51], v22 offset:40992
  ds_read_b64_tr_b16 v[52:53], v22 offset:41248
  s_waitcnt lgkmcnt(6)
  v_mfma_f32_16x16x32_bf16 v[38:41], v[76:79], v[54:57], v[38:41]
  ds_read_b64_tr_b16 v[54:55], v22 offset:43008
  ds_read_b64_tr_b16 v[56:57], v22 offset:43264
  s_waitcnt lgkmcnt(6)
  v_mfma_f32_16x16x32_bf16 v[42:45], v[76:79], v[58:61], v[42:45]
  ds_read_b64_tr_b16 v[58:59], v22 offset:43040
  ds_read_b64_tr_b16 v[60:61], v22 offset:43296
  s_waitcnt lgkmcnt(6)
  v_mfma_f32_16x16x32_bf16 v[38:41], v[80:83], v[46:49], v[38:41]
  ds_read_b64_tr_b16 v[46:47], v22 offset:45056
  ds_read_b64_tr_b16 v[48:49], v22 offset:45312
  s_waitcnt lgkmcnt(6)
  v_mfma_f32_16x16x32_bf16 v[42:45], v[80:83], v[50:53], v[42:45]
  ds_read_b64_tr_b16 v[50:51], v22 offset:45088
  ds_read_b64_tr_b16 v[52:53], v22 offset:45344
  s_waitcnt lgkmcnt(6)
  v_mfma_f32_16x16x32_bf16 v[38:41], v[84:87], v[54:57], v[38:41]
  ds_read_b64_tr_b16 v[54:55], v22 offset:47104
  ds_read_b64_tr_b16 v[56:57], v22 offset:47360
  s_waitcnt lgkmcnt(6)
  v_mfma_f32_16x16x32_bf16 v[42:45], v[84:87], v[58:61], v[42:45]
  ds_read_b64_tr_b16 v[58:59], v22 offset:47136
  ds_read_b64_tr_b16 v[60:61], v22 offset:47392
  s_waitcnt lgkmcnt(6)
  v_mfma_f32_16x16x32_bf16 v[38:41], v[88:91], v[46:49], v[38:41]
  ds_read_b64_tr_b16 v[46:47], v22 offset:49152
  ds_read_b64_tr_b16 v[48:49], v22 offset:49408
  s_waitcnt lgkmcnt(6)
  v_mfma_f32_16x16x32_bf16 v[42:45], v[88:91], v[50:53], v[42:45]
  ds_read_b64_tr_b16 v[50:51], v22 offset:49184
  ds_read_b64_tr_b16 v[52:53], v22 offset:49440
  s_waitcnt lgkmcnt(6)
  v_mfma_f32_16x16x32_bf16 v[38:41], v[92:95], v[54:57], v[38:41]
  ds_read_b64_tr_b16 v[54:55], v22 offset:51200
  ds_read_b64_tr_b16 v[56:57], v22 offset:51456
  s_waitcnt lgkmcnt(6)
  v_mfma_f32_16x16x32_bf16 v[42:45], v[92:95], v[58:61], v[42:45]
  ds_read_b64_tr_b16 v[58:59], v22 offset:51232
  ds_read_b64_tr_b16 v[60:61], v22 offset:51488
  s_waitcnt lgkmcnt(6)
  v_mfma_f32_16x16x32_bf16 v[38:41], v[96:99], v[46:49], v[38:41]
  ds_read_b64_tr_b16 v[46:47], v22 offset:53248
  ds_read_b64_tr_b16 v[48:49], v22 offset:53504
  s_waitcnt lgkmcnt(6)
  v_mfma_f32_16x16x32_bf16 v[42:45], v[96:99], v[50:53], v[42:45]
  ds_read_b64_tr_b16 v[50:51], v22 offset:53280
  ds_read_b64_tr_b16 v[52:53], v22 offset:53536
  s_waitcnt lgkmcnt(6)
  v_mfma_f32_16x16x32_bf16 v[38:41], v[100:103], v[54:57], v[38:41]
  ds_read_b64_tr_b16 v[54:55], v22 offset:55296
  ds_read_b64_tr_b16 v[56:57], v22 offset:55552
  s_waitcnt lgkmcnt(6)
  v_mfma_f32_16x16x32_bf16 v[42:45], v[100:103], v[58:61], v[42:45]
  ds_read_b64_tr_b16 v[58:59], v22 offset:55328
  ds_read_b64_tr_b16 v[60:61], v22 offset:55584
  s_waitcnt lgkmcnt(6)
  v_mfma_f32_16x16x32_bf16 v[38:41], v[104:107], v[46:49], v[38:41]
  ds_read_b64_tr_b16 v[46:47], v22 offset:57344
  ds_read_b64_tr_b16 v[48:49], v22 offset:57600
  s_waitcnt lgkmcnt(6)
  v_mfma_f32_16x16x32_bf16 v[42:45], v[104:107], v[50:53], v[42:45]
  ds_read_b64_tr_b16 v[50:51], v22 offset:57376
  ds_read_b64_tr_b16 v[52:53], v22 offset:57632
  s_waitcnt lgkmcnt(6)
  v_mfma_f32_16x16x32_bf16 v[38:41], v[108:111], v[54:57], v[38:41]
  ds_read_b64_tr_b16 v[54:55], v22 offset:59392
  ds_read_b64_tr_b16 v[56:57], v22 offset:59648
  s_waitcnt lgkmcnt(6)
  v_mfma_f32_16x16x32_bf16 v[42:45], v[108:111], v[58:61], v[42:45]
  ds_read_b64_tr_b16 v[58:59], v22 offset:59424
  ds_read_b64_tr_b16 v[60:61], v22 offset:59680
  s_waitcnt lgkmcnt(6)
  v_mfma_f32_16x16x32_bf16 v[38:41], v[112:115], v[46:49], v[38:41]
  ds_read_b64_tr_b16 v[46:47], v22 offset:61440
  ds_read_b64_tr_b16 v[48:49], v22 offset:61696
  s_waitcnt lgkmcnt(6)
  v_mfma_f32_16x16x32_bf16 v[42:45], v[112:115], v[50:53], v[42:45]
  ds_read_b64_tr_b16 v[50:51], v22 offset:61472
  ds_read_b64_tr_b16 v[52:53], v22 offset:61728
  s_waitcnt lgkmcnt(6)
  v_mfma_f32_16x16x32_bf16 v[38:41], v[116:119], v[54:57], v[38:41]
  ds_read_b64_tr_b16 v[54:55], v22 offset:63488
  ds_read_b64_tr_b16 v[56:57], v22 offset:63744
  s_waitcnt lgkmcnt(6)
  v_mfma_f32_16x16x32_bf16 v[42:45], v[116:119], v[58:61], v[42:45]
  ds_read_b64_tr_b16 v[58:59], v22 offset:63520
  ds_read_b64_tr_b16 v[60:61], v22 offset:63776
  s_waitcnt lgkmcnt(6)
  v_mfma_f32_16x16x32_bf16 v[38:41], v[120:123], v[46:49], v[38:41]
  s_waitcnt lgkmcnt(4)
  v_mfma_f32_16x16x32_bf16 v[42:45], v[120:123], v[50:53], v[42:45]
  s_waitcnt lgkmcnt(2)
  v_mfma_f32_16x16x32_bf16 v[38:41], v[124:127], v[54:57], v[38:41]
  s_waitcnt lgkmcnt(0)
  v_mfma_f32_16x16x32_bf16 v[42:45], v[124:127], v[58:61], v[42:45]
  s_lshl_b32 s28, s37, 15
  s_nop 6
  v_cmp_u_f32 vcc, v38, v42
  s_cbranch_vccz W_fo1
  s_add_u32 s30, s30, 1
  s_cmp_lt_u32 s30, 200
  s_cbranch_scc0 W_fo1
  s_barrier
  s_add_u32 s27, s28, s29
  s_add_u32 s27, s27, 101711872
  s_add_u32 m0, s29, 65536
  s_add_u32 s27, s27, 0
  buffer_load_dwordx4 v1, s[8:11], s27 offen offset:0 sc1 lds
  buffer_load_dwordx4 v1, s[8:11], s27 offen offset:1024 sc1 lds
  buffer_load_dwordx4 v1, s[8:11], s27 offen offset:2048 sc1 lds
  buffer_load_dwordx4 v1, s[8:11], s27 offen offset:3072 sc1 lds
  s_add_u32 m0, s29, 69632
  s_add_u32 s27, s27, 4096
  buffer_load_dwordx4 v1, s[8:11], s27 offen offset:0 sc1 lds
  buffer_load_dwordx4 v1, s[8:11], s27 offen offset:1024 sc1 lds
  buffer_load_dwordx4 v1, s[8:11], s27 offen offset:2048 sc1 lds
  buffer_load_dwordx4 v1, s[8:11], s27 offen offset:3072 sc1 lds
  s_waitcnt vmcnt(0)
  s_branch W_fr1
W_fo1:
  v_lshlrev_b32 v46, 16, v30
  v_and_b32 v47, 0xffff0000, v30
  v_lshlrev_b32 v48, 16, v31
  v_and_b32 v49, 0xffff0000, v31
  v_cvt_pk_bf16_f32 v38, v38, v39
  v_cvt_pk_bf16_f32 v39, v40, v41
  v_and_b32 v41, 0xffff0000, v39
  v_lshlrev_b32 v40, 16, v39
  v_and_b32 v39, 0xffff0000, v38
  v_lshlrev_b32 v38, 16, v38
  v_add_f32 v38, v38, v46
  v_add_f32 v39, v39, v47
  v_add_f32 v40, v40, v48
  v_add_f32 v41, v41, v49
  v_cvt_pk_bf16_f32 v30, v38, v39
  v_cvt_pk_bf16_f32 v31, v40, v41
  buffer_store_dwordx2 v[30:31], v24, s[16:19], s28 offen
  v_lshlrev_b32 v46, 16, v32
  v_and_b32 v47, 0xffff0000, v32
  v_lshlrev_b32 v48, 16, v33
  v_and_b32 v49, 0xffff0000, v33
  v_cvt_pk_bf16_f32 v42, v42, v43
  v_cvt_pk_bf16_f32 v43, v44, v45
  v_and_b32 v45, 0xffff0000, v43
  v_lshlrev_b32 v44, 16, v43
  v_and_b32 v43, 0xffff0000, v42
  v_lshlrev_b32 v42, 16, v42
  v_add_f32 v42, v42, v46
  v_add_f32 v43, v43, v47
  v_add_f32 v44, v44, v48
  v_add_f32 v45, v45, v49
  v_cvt_pk_bf16_f32 v32, v42, v43
  v_cvt_pk_bf16_f32 v33, v44, v45
  buffer_store_dwordx2 v[32:33], v25, s[16:19], s28 offen
  s_cmp_lt_u32 s91, 64
  s_cbranch_scc0 L_abort
  s_waitcnt vmcnt(4)
  v_add_u32 v22, 0x10000, v22
  s_mov_b32 s30, 0
W_fr2:
  s_barrier
  ds_read_b64_tr_b16 v[46:47], v22 offset:0
  ds_read_b64_tr_b16 v[48:49], v22 offset:256
  ds_read_b64_tr_b16 v[50:51], v22 offset:32
  ds_read_b64_tr_b16 v[52:53], v22 offset:288
  ds_read_b64_tr_b16 v[54:55], v22 offset:2048
  ds_read_b64_tr_b16 v[56:57], v22 offset:2304
  ds_read_b64_tr_b16 v[58:59], v22 offset:2080
  ds_read_b64_tr_b16 v[60:61], v22 offset:2336
  s_waitcnt lgkmcnt(6)
  v_mfma_f32_16x16x32_bf16 v[38:41], v[64:67], v[46:49], 0
  ds_read_b64_tr_b16 v[46:47], v22 offset:4096
  ds_read_b64_tr_b16 v[48:49], v22 offset:4352
  s_waitcnt lgkmcnt(6)
  v_mfma_f32_16x16x32_bf16 v[42:45], v[64:67], v[50:53], 0
  ds_read_b64_tr_b16 v[50:51], v22 offset:4128
  ds_read_b64_tr_b16 v[52:53], v22 offset:4384
  s_waitcnt lgkmcnt(6)
  v_mfma_f32_16x16x32_bf16 v[38:41], v[68:71], v[54:57], v[38:41]
  ds_read_b64_tr_b16 v[54:55], v22 offset:6144
  ds_read_b64_tr_b16 v[56:57], v22 offset:6400
  s_waitcnt lgkmcnt(6)
  v_mfma_f32_16x16x32_bf16 v[42:45], v[68:71], v[58:61], v[42:45]
  ds_read_b64_tr_b16 v[58:59], v22 offset:6176
  ds_read_b64_tr_b16 v[60:61], v22 offset:6432
  s_waitcnt lgkmcnt(6)
  v_mfma_f32_16x16x32_bf16 v[38:41], v[72:75], v[46:49], v[38:41]
  ds_read_b64_tr_b16 v[46:47], v22 offset:8192
  ds_read_b64_tr_b16 v[48:49], v22 offset:8448
  s_waitcnt lgkmcnt(6)
  v_mfma_f32_16x16x32_bf16 v[42:45], v[72:75], v[50:53], v[42:45]
  ds_read_b64_tr_b16 v[50:51], v22 offset:8224
  ds_read_b64_tr_b16 v[52:53], v22 offset:8480
  s_waitcnt lgkmcnt(6)
  v_mfma_f32_16x16x32_bf16 v[38:41], v[76:79], v[54:57], v[38:41]
  ds_read_b64_tr_b16 v[54:55], v22 offset:10240
  ds_read_b64_tr_b16 v[56:57], v22 offset:10496
  s_waitcnt lgkmcnt(6)
  v_mfma_f32_16x16x32_bf16 v[42:45], v[76:79], v[58:61], v[42:45]
  ds_read_b64_tr_b16 v[58:59], v22 offset:10272
  ds_read_b64_tr_b16 v[60:61], v22 offset:10528
  s_waitcnt lgkmcnt(6)
  v_mfma_f32_16x16x32_bf16 v[38:41], v[80:83], v[46:49], v[38:41]
  ds_read_b64_tr_b16 v[46:47], v22 offset:12288
  ds_read_b64_tr_b16 v[48:49], v22 offset:12544
  s_waitcnt lgkmcnt(6)
  v_mfma_f32_16x16x32_bf16 v[42:45], v[80:83], v[50:53], v[42:45]
  ds_read_b64_tr_b16 v[50:51], v22 offset:12320
  ds_read_b64_tr_b16 v[52:53], v22 offset:12576
  s_waitcnt lgkmcnt(6)
  v_mfma_f32_16x16x32_bf16 v[38:41], v[84:87], v[54:57], v[38:41]
  ds_read_b64_tr_b16 v[54:55], v22 offset:14336
  ds_read_b64_tr_b16 v[56:57], v22 offset:14592
  s_waitcnt lgkmcnt(6)
  v_mfma_f32_16x16x32_bf16 v[42:45], v[84:87], v[58:61], v[42:45]
  ds_read_b64_tr_b16 v[58:59], v22 offset:14368
  ds_read_b64_tr_b16 v[60:61], v22 offset:14624
  s_waitcnt lgkmcnt(6)
  v_mfma_f32_16x16x32_bf16 v[38:41], v[88:91], v[46:49], v[38:41]
  ds_read_b64_tr_b16 v[46:47], v22 offset:16384
  ds_read_b64_tr_b16 v[48:49], v22 offset:16640
  s_waitcnt lgkmcnt(6)
  v_mfma_f32_16x16x32_bf16 v[42:45], v[88:91], v[50:53], v[42:45]
  ds_read_b64_tr_b16 v[50:51], v22 offset:16416
  ds_read_b64_tr_b16 v[52:53], v22 offset:16672
  s_waitcnt lgkmcnt(6)
  v_mfma_f32_16x16x32_bf16 v[38:41], v[92:95], v[54:57], v[38:41]
  ds_read_b64_tr_b16 v[54:55], v22 offset:18432
  ds_read_b64_tr_b16 v[56:57], v22 offset:18688
  s_waitcnt lgkmcnt(6)
  v_mfma_f32_16x16x32_bf16 v[42:45], v[92:95], v[58:61], v[42:45]
  ds_read_b64_tr_b16 v[58:59], v22 offset:18464
  ds_read_b64_tr_b16 v[60:61], v22 offset:18720
  s_waitcnt lgkmcnt(6)
  v_mfma_f32_16x16x32_bf16 v[38:41], v[96:99], v[46:49], v[38:41]
  ds_read_b64_tr_b16 v[46:47], v22 offset:20480
  ds_read_b64_tr_b16 v[48:49], v22 offset:20736
  s_waitcnt lgkmcnt(6)
  v_mfma_f32_16x16x32_bf16 v[42:45], v[96:99], v[50:53], v[42:45]
  ds_read_b64_tr_b16 v[50:51], v22 offset:20512
  ds_read_b64_tr_b16 v[52:53], v22 offset:20768
  s_waitcnt lgkmcnt(6)
  v_mfma_f32_16x16x32_bf16 v[38:41], v[100:103], v[54:57], v[38:41]
  ds_read_b64_tr_b16 v[54:55], v22 offset:22528
  ds_read_b64_tr_b16 v[56:57], v22 offset:22784
  s_waitcnt lgkmcnt(6)
  v_mfma_f32_16x16x32_bf16 v[42:45], v[100:103], v[58:61], v[42:45]
  ds_read_b64_tr_b16 v[58:59], v22 offset:22560
  ds_read_b64_tr_b16 v[60:61], v22 offset:22816
  s_waitcnt lgkmcnt(6)
  v_mfma_f32_16x16x32_bf16 v[38:41], v[104:107], v[46:49], v[38:41]
  ds_read_b64_tr_b16 v[46:47], v22 offset:24576
  ds_read_b64_tr_b16 v[48:49], v22 offset:24832
  s_waitcnt lgkmcnt(6)
  v_mfma_f32_16x16x32_bf16 v[42:45], v[104:107], v[50:53], v[42:45]
  ds_read_b64_tr_b16 v[50:51], v22 offset:24608
  ds_read_b64_tr_b16 v[52:53], v22 offset:24864
  s_waitcnt lgkmcnt(6)
  v_mfma_f32_16x16x32_bf16 v[38:41], v[108:111], v[54:57], v[38:41]
  ds_read_b64_tr_b16 v[54:55], v22 offset:26624
  ds_read_b64_tr_b16 v[56:57], v22 offset:26880
  s_waitcnt lgkmcnt(6)
  v_mfma_f32_16x16x32_bf16 v[42:45], v[108:111], v[58:61], v[42:45]
  ds_read_b64_tr_b16 v[58:59], v22 offset:26656
  ds_read_b64_tr_b16 v[60:61], v22 offset:26912
  s_waitcnt lgkmcnt(6)
  v_mfma_f32_16x16x32_bf16 v[38:41], v[112:115], v[46:49], v[38:41]
  ds_read_b64_tr_b16 v[46:47], v22 offset:28672
  ds_read_b64_tr_b16 v[48:49], v22 offset:28928
  s_waitcnt lgkmcnt(6)
  v_mfma_f32_16x16x32_bf16 v[42:45], v[112:115], v[50:53], v[42:45]
  ds_read_b64_tr_b16 v[50:51], v22 offset:28704
  ds_read_b64_tr_b16 v[52:53], v22 offset:28960
  s_waitcnt lgkmcnt(6)
  v_mfma_f32_16x16x32_bf16 v[38:41], v[116:119], v[54:57], v[38:41]
  ds_read_b64_tr_b16 v[54:55], v22 offset:30720
  ds_read_b64_tr_b16 v[56:57], v22 offset:30976
  s_waitcnt lgkmcnt(6)
  v_mfma_f32_16x16x32_bf16 v[42:45], v[116:119], v[58:61], v[42:45]
  ds_read_b64_tr_b16 v[58:59], v22 offset:30752
  ds_read_b64_tr_b16 v[60:61], v22 offset:31008
  s_waitcnt lgkmcnt(6)
  v_mfma_f32_16x16x32_bf16 v[38:41], v[120:123], v[46:49], v[38:41]
  s_waitcnt lgkmcnt(4)
  v_mfma_f32_16x16x32_bf16 v[42:45], v[120:123], v[50:53], v[42:45]
  s_waitcnt lgkmcnt(2)
  v_mfma_f32_16x16x32_bf16 v[38:41], v[124:127], v[54:57], v[38:41]
  s_waitcnt lgkmcnt(0)
  v_mfma_f32_16x16x32_bf16 v[42:45], v[124:127], v[58:61], v[42:45]
  s_lshl_b32 s28, s91, 15
  s_nop 6
  v_cmp_u_f32 vcc, v38, v42
  s_cbranch_vccz W_fo2
  s_add_u32 s30, s30, 1
  s_cmp_lt_u32 s30, 200
  s_cbranch_scc0 W_fo2
  s_barrier
  s_add_u32 s27, s28, s29
  s_add_u32 s27, s27, 101711872
  s_add_u32 m0, s29, 98304
  s_add_u32 s27, s27, 0
  buffer_load_dwordx4 v1, s[8:11], s27 offen offset:0 sc1 lds
  buffer_load_dwordx4 v1, s[8:11], s27 offen offset:1024 sc1 lds
  buffer_load_dwordx4 v1, s[8:11], s27 offen offset:2048 sc1 lds
  buffer_load_dwordx4 v1, s[8:11], s27 offen offset:3072 sc1 lds
  s_add_u32 m0, s29, 102400
  s_add_u32 s27, s27, 4096
  buffer_load_dwordx4 v1, s[8:11], s27 offen offset:0 sc1 lds
  buffer_load_dwordx4 v1, s[8:11], s27 offen offset:1024 sc1 lds
  buffer_load_dwordx4 v1, s[8:11], s27 offen offset:2048 sc1 lds
  buffer_load_dwordx4 v1, s[8:11], s27 offen offset:3072 sc1 lds
  s_waitcnt vmcnt(0)
  s_branch W_fr2
W_fo2:
  v_lshlrev_b32 v46, 16, v34
  v_and_b32 v47, 0xffff0000, v34
  v_lshlrev_b32 v48, 16, v35
  v_and_b32 v49, 0xffff0000, v35
  v_cvt_pk_bf16_f32 v38, v38, v39
  v_cvt_pk_bf16_f32 v39, v40, v41
  v_and_b32 v41, 0xffff0000, v39
  v_lshlrev_b32 v40, 16, v39
  v_and_b32 v39, 0xffff0000, v38
  v_lshlrev_b32 v38, 16, v38
  v_add_f32 v38, v38, v46
  v_add_f32 v39, v39, v47
  v_add_f32 v40, v40, v48
  v_add_f32 v41, v41, v49
  v_cvt_pk_bf16_f32 v34, v38, v39
  v_cvt_pk_bf16_f32 v35, v40, v41
  buffer_store_dwordx2 v[34:35], v24, s[16:19], s28 offen
  v_lshlrev_b32 v46, 16, v36
  v_and_b32 v47, 0xffff0000, v36
  v_lshlrev_b32 v48, 16, v37
  v_and_b32 v49, 0xffff0000, v37
  v_cvt_pk_bf16_f32 v42, v42, v43
  v_cvt_pk_bf16_f32 v43, v44, v45
  v_and_b32 v45, 0xffff0000, v43
  v_lshlrev_b32 v44, 16, v43
  v_and_b32 v43, 0xffff0000, v42
  v_lshlrev_b32 v42, 16, v42
  v_add_f32 v42, v42, v46
  v_add_f32 v43, v43, v47
  v_add_f32 v44, v44, v48
  v_add_f32 v45, v45, v49
  v_cvt_pk_bf16_f32 v36, v42, v43
  v_cvt_pk_bf16_f32 v37, v44, v45
  buffer_store_dwordx2 v[36:37], v25, s[16:19], s28 offen
L_abort:
  s_waitcnt vmcnt(0)
L_end:
s_endpgm
.section .rodata,"a"
.p2align 6
.amdhsa_kernel interleave_layers__memory_aug_recurrent_mem_tr__spectral_gfnet__prompt_kernel
  .amdhsa_next_free_vgpr 512
  .amdhsa_next_free_sgpr 102
  .amdhsa_accum_offset 256
  .amdhsa_group_segment_fixed_size 0
  .amdhsa_kernarg_size 104
  .amdhsa_user_sgpr_count 2
  .amdhsa_user_sgpr_kernarg_segment_ptr 1
  .amdhsa_system_sgpr_workgroup_id_x 1
.end_amdhsa_kernel
```
